```python
import torch

def _softmax(x, axis=-1):
    return torch.softmax(x, dim=axis)

def _gelu(x):
    return torch.nn.functional.gelu(x, approximate='tanh')

def _silu(x):
    return torch.nn.functional.silu(x)

def _sigmoid(x):
    return torch.sigmoid(x)

def _layernorm(x, axis=-1, eps=1e-05):
    m = x.mean(dim=axis, keepdim=True)
    v = x.var(dim=axis, keepdim=True, unbiased=False)
    return (x - m) / torch.sqrt(v + eps)

def _scatter_add(tgt, idx, src, axis=0):
    return tgt.clone().index_add_(axis, idx, src)

def _segment_sum(src, seg, n):
    out = torch.zeros((n,) + src.shape[1:], dtype=src.dtype)
    return out.index_add_(0, seg, src)

def _pad(x, pw):
    flat = tuple((v for pair in reversed(pw) for v in pair))
    return torch.nn.functional.pad(x, flat)
kernel_name = 'adaLN_cond__memory_aug_recurrent_mem_tr__swiglu_ffn__prompt'

def setup_inputs():

    _w = lambda a: (lambda t: t.to(torch.bfloat16) if t.is_floating_point() else t)(torch.as_tensor(a))

    def _A_setup():
        B, S, Dm = (1, 2048, 512)
        H, Dh = (32, 128)
        M, seg = (8, 32)
        seg = min(seg, S)
        S = S // seg * seg
        return {'x': _w((lambda *s: torch.randn(*s, dtype=torch.bfloat16) * 0.05)(B, S, Dm)), 'mem0': _w((lambda *s: torch.randn(*s, dtype=torch.bfloat16) * 0.4)(B, M, Dm)), 'Wq': _w((lambda *s: torch.randn(*s, dtype=torch.bfloat16) * 3.2)(Dm, H, Dh) * Dm ** (-0.5)), 'Wk': _w((lambda *s: torch.randn(*s, dtype=torch.bfloat16) * 3.2)(Dm, H, Dh) * Dm ** (-0.5)), 'Wv': _w((lambda *s: torch.randn(*s, dtype=torch.bfloat16) * 0.4)(Dm, H, Dh) * Dm ** (-0.5)), 'Wo': _w((lambda *s: torch.randn(*s, dtype=torch.bfloat16) * 0.4)(H, Dh, Dm) * (H * Dh) ** (-0.5)), 'seg_len': seg}
    _A_in = _A_setup()

    def _B_setup():
        B, S, D, F = (1, 2048, 512, 1792)
        return {'x': _w((lambda *s: torch.randn(*s, dtype=torch.bfloat16) * 0.05)(B, S, D)), 'w_gate': _w((lambda *s: torch.randn(*s, dtype=torch.bfloat16) * 0.05)(D, F)), 'w_up': _w((lambda *s: torch.randn(*s, dtype=torch.bfloat16) * 0.05)(D, F)), 'w_down': _w((lambda *s: torch.randn(*s, dtype=torch.bfloat16) * 0.05)(F, D))}
    _B_in = _B_setup()
    return {'A_x': _A_in['x'], 'A_mem0': _A_in['mem0'], 'A_Wq': _A_in['Wq'], 'A_Wk': _A_in['Wk'], 'A_Wv': _A_in['Wv'], 'A_Wo': _A_in['Wo'], 'A_seg_len': _A_in['seg_len'], 'B_x': _B_in['x'], 'B_w_gate': _B_in['w_gate'], 'B_w_up': _B_in['w_up'], 'B_w_down': _B_in['w_down'], 'c': _w((lambda *s: torch.randn(*s, dtype=torch.bfloat16) * 0.1)(1, 512) * 8.0), 'w_mod': _w((lambda *s: torch.randn(*s, dtype=torch.bfloat16) * 0.1)(512, 6 * 512) * 512 ** (-0.5) * 8.0)}

def reference(A_x, A_mem0, A_Wq, A_Wk, A_Wv, A_Wo, A_seg_len, B_x, B_w_gate, B_w_up, B_w_down, c, w_mod):

    def _A_ref(x, mem0, Wq, Wk, Wv, Wo, seg_len):
        B, S, Dm = x.shape
        H, Dh = (Wq.shape[1], Wq.shape[2])
        M = mem0.shape[1]
        scale = Dh ** (-0.5)
        n_seg = S // seg_len
        L = M + seg_len
        idx = torch.arange(L)
        mask = (idx[:, None] < M) | (idx[:, None] >= idx[None, :])
        mem = mem0
        outs = []
        for s in range(n_seg):
            xs = x[:, s * seg_len:(s + 1) * seg_len, :].clone()
            h = torch.concatenate([mem, xs], axis=1)
            q = torch.einsum('btd,dhe->bhte', h, Wq)
            k = torch.einsum('btd,dhe->bhte', h, Wk)
            v = torch.einsum('btd,dhe->bhte', h, Wv)
            scores = torch.einsum('bhqe,bhke->bhqk', q, k) * scale
            scores = torch.where(mask[None, None], scores, -1000000000.0)
            p = _softmax(scores, axis=-1)
            o = torch.einsum('bhqk,bhke->bhqe', p, v)
            o = torch.einsum('bhte,hed->btd', o, Wo)
            mem = o[:, :M, :].clone()
            outs.append(o[:, M:, :])
        return torch.concatenate(outs, axis=1)

    def _B_ref(x, w_gate, w_up, w_down):
        g = _silu(x @ w_gate)
        u = x @ w_up
        return g * u @ w_down
    x = A_x
    mod = (_silu(c) @ w_mod).reshape(c.shape[0], 6, 1, -1)
    sa, ca, ga, sb, cb, gb = (mod[:, 0].clone(), mod[:, 1].clone(), mod[:, 2].clone(), mod[:, 3].clone(), mod[:, 4].clone(), mod[:, 5].clone())
    h = _layernorm(x, axis=-1) * (1 + ca) + sa
    x = x + ga * _A_ref(h, A_mem0, A_Wq, A_Wk, A_Wv, A_Wo, A_seg_len)
    h = _layernorm(x, axis=-1) * (1 + cb) + sb
    x = x + gb * _B_ref(h, B_w_gate, B_w_up, B_w_down)
    return x
```

```asm
; @launch kernel=main_kernel grid=(256,1,1) block=(256,1,1) lds=163840
.amdgcn_target "amdgcn-amd-amdhsa--gfx950"
.text
.globl main_kernel
.p2align 8
.type main_kernel,@function
main_kernel:
    s_cmp_ge_u32 s2, 256
    s_cbranch_scc1 Lend_1
    s_load_dwordx16 s[4:19], s[0:1], 0
    s_load_dwordx16 s[20:35], s[0:1], 64
    v_lshrrev_b32 v1, 6, v0
    s_nop 0
    v_readfirstlane_b32 s57, v1
    v_and_b32 v0, 63, v0
    v_lshlrev_b32 v1, 4, v0
    s_mov_b32 s66, 0x05040100
    s_mov_b32 s67, 0x07060302
    s_mov_b32 s68, 0xffff0000
    s_mov_b32 s69, 0x3fb8aa3b
    s_mov_b32 s70, 0x3db504f3
    s_waitcnt lgkmcnt(0)
    s_mov_b32 s36, s34
    s_and_b32 s37, s35, 0xffff
    s_mov_b32 s38, 0x10000000
    s_mov_b32 s39, 0x20000
    s_mov_b32 s40, s34
    s_and_b32 s41, s35, 0xffff
    s_mov_b32 s42, 0x10000000
    s_mov_b32 s43, 0x20000
    s_mov_b32 s44, s34
    s_and_b32 s45, s35, 0xffff
    s_mov_b32 s46, 0x10000000
    s_mov_b32 s47, 0x20000
    s_mov_b32 s48, s34
    s_and_b32 s49, s35, 0xffff
    s_mov_b32 s50, 0x10000000
    s_mov_b32 s51, 0x20000
    s_mov_b32 s52, s34
    s_and_b32 s53, s35, 0xffff
    s_mov_b32 s54, 0x10000000
    s_mov_b32 s55, 0x20000
    s_getreg_b32 s62, hwreg(HW_REG_XCC_ID, 0, 4)
    s_and_b32 s62, s62, 7
    v_mov_b32 v2, 163584
    s_cmp_lg_u32 s57, 0
    s_cbranch_scc1 Ltk_2
    v_mov_b32 v3, 1
    s_mov_b64 exec, 1
    s_lshl_b32 s59, s62, 5
    v_mov_b32 v4, s59
    global_atomic_add v3, v4, v3, s[32:33] sc0
    s_waitcnt vmcnt(0)
    ds_write_b32 v2, v3
    s_mov_b64 exec, -1
    s_waitcnt lgkmcnt(0)
Ltk_2:
    s_barrier
    ds_read_b32 v3, v2
    s_waitcnt lgkmcnt(0)
    v_readfirstlane_b32 s63, v3
    s_nop 0
    s_cmp_ge_u32 s63, 32
    s_nop 1
    s_cbranch_scc1 Lend_1
    s_mov_b32 s56, s63
    s_cmp_eq_u32 s62, 1
    s_cbranch_scc1 Lx1_4
    s_cmp_eq_u32 s62, 2
    s_cbranch_scc1 Lx2_5
    s_cmp_eq_u32 s62, 3
    s_cbranch_scc1 Lx3_6
    s_cmp_eq_u32 s62, 4
    s_cbranch_scc1 Lx4_7
    s_cmp_eq_u32 s62, 5
    s_cbranch_scc1 Lx5_8
    s_cmp_eq_u32 s62, 6
    s_cbranch_scc1 Lx6_9
    s_cmp_eq_u32 s62, 7
    s_cbranch_scc1 Lx7_10
    s_mov_b32 s40, s8
    s_and_b32 s41, s9, 0xffff
    s_mov_b32 s42, 0x400000
    s_mov_b32 s43, 0x20000
    s_mov_b32 s44, s10
    s_and_b32 s45, s11, 0xffff
    s_mov_b32 s46, 0x400000
    s_mov_b32 s47, 0x20000
    s_mov_b32 s48, s12
    s_and_b32 s49, s13, 0xffff
    s_mov_b32 s50, 0x400000
    s_mov_b32 s51, 0x20000
    s_mov_b32 s52, s14
    s_and_b32 s53, s15, 0xffff
    s_mov_b32 s54, 0x400000
    s_mov_b32 s55, 0x20000
    v_mov_b32 v34, v0
    v_lshrrev_b32 v16, 4, v0
    v_and_b32 v17, 15, v0
    v_and_b32 v18, 1, v16
    v_lshrrev_b32 v19, 5, v0
    v_lshlrev_b32 v0, 3, v1
    s_cmp_lt_u32 s57, 2
    s_cselect_b32 s59, -1, 0
    v_and_b32 v0, s59, v0
    s_lshl_b32 s59, s57, 15
    v_add_u32 v2, s59, v1
    v_add_u32 v3, 131072, v1
    s_lshl_b32 s59, s57, 11
    v_add_u32 v14, s59, v3
    v_lshlrev_b32 v4, 9, v16
    v_lshl_add_u32 v4, v17, 4, v4
    v_add_u32 v4, 139264, v4
    s_mov_b32 s84, 0xff00ff00
    s_mov_b32 s85, 0xff00ff00
    s_mov_b32 s86, 0x00ff00ff
    s_mov_b32 s87, 0x00ff00ff
    s_mov_b32 s90, 0x3db504f3
    s_mov_b32 s91, 0x3db504f3
    s_cmp_eq_u32 s57, 3
    s_cselect_b32 s88, 1, 0
    s_mov_b32 s89, 0
    v_mov_b32 v5, 0x4444
    v_mov_b32 v20, 0xeeee
    v_cndmask_b32 v5, v5, v20, s[84:85]
    v_lshlrev_b32 v20, 1, v18
    v_add_u32 v20, v20, v19
    v_mul_u32_u24 v6, 576, v20
    v_lshl_add_u32 v6, v17, 2, v6
    s_lshl_b32 s59, s57, 6
    s_add_u32 s59, s59, 157696
    v_add_u32 v6, s59, v6
    v_lshrrev_b32 v8, 1, v17
    v_lshlrev_b32 v8, 13, v8
    v_lshl_add_u32 v8, v16, 4, v8
    v_and_b32 v21, 1, v17
    v_lshl_add_u32 v8, v21, 6, v8
    s_lshl_b32 s59, s57, 16
    s_lshl_b32 s60, s56, 7
    s_add_u32 s59, s59, s60
    v_add_u32 v8, s59, v8
    v_lshlrev_b32 v11, 8, v19
    v_lshl_add_u32 v11, v17, 4, v11
    v_lshl_add_u32 v11, v18, 3, v11
    s_lshl_b32 s59, s57, 9
    s_add_u32 s59, s59, 157696
    v_add_u32 v11, s59, v11
    v_and_b32 v20, 7, v17
    v_mul_u32_u24 v7, 288, v20
    v_lshl_add_u32 v7, v16, 4, v7
    v_add_u32 v7, 157696, v7
    v_lshlrev_b32 v12, 7, v16
    v_lshl_add_u32 v12, v20, 4, v12
    v_add_u32 v12, 155648, v12
    s_lshl_b32 s59, s57, 9
    v_add_u32 v13, s59, v12
    v_lshlrev_b32 v9, 6, v21
    v_lshl_add_u32 v9, v16, 4, v9
    v_bfe_u32 v20, v17, 1, 2
    v_lshl_add_u32 v9, v20, 2, v9
    s_lshl_b32 s59, s56, 7
    s_and_b32 s60, s57, 1
    s_lshl_b32 s61, s60, 12
    s_add_u32 s59, s59, s61
    v_add_u32 v9, s59, v9
    v_mov_b32 v10, 0
    s_lshl_b32 s82, s56, 13
    s_lshl_b32 s61, s60, 12
    s_add_u32 s82, s82, s61
    s_lshl_b32 s59, s56, 7
    s_add_u32 s76, s59, 0x628000
    s_mov_b32 s20, s76
    s_add_u32 s75, s59, 0x614800
    s_lshl_b32 s59, s56, 11
    s_lshr_b32 s61, s57, 1
    s_lshl_b32 s61, s61, 22
    s_add_u32 s78, s59, s61
    s_lshl_b32 s61, s60, 10
    s_add_u32 s78, s78, s61
    s_add_u32 s78, s78, 0x800000
    s_lshl_b32 s59, s56, 13
    s_lshl_b32 s61, s57, 11
    s_add_u32 s81, s59, s61
    s_add_u32 s79, s81, 0x1000000
    s_add_u32 s80, s61, 139264
    s_lshl_b32 s97, s60, 24
    s_sub_u32 s97, s97, s61
    s_mov_b32 s77, 0
    s_cmp_eq_u32 s57, 2
    s_cselect_b32 s94, 0xffff, 0
    s_mov_b32 s95, 0
    v_lshlrev_b32 v20, 1, v18
    v_add_u32 v20, v20, v19
    v_lshlrev_b32 v10, 9, v20
    v_lshl_add_u32 v10, v17, 3, v10
    s_lshl_b32 s59, s57, 7
    v_add_u32 v10, s59, v10
    v_add_u32 v11, 0x3d9800, v11
    s_lshl_b32 s78, s56, 11
    s_add_u32 s78, s78, 0x7f0000
    s_cmp_eq_u32 s57, 2
    s_cselect_b32 s59, 16, 0
    s_cmp_eq_u32 s57, 3
    s_cselect_b32 s59, 1, s59
    s_cselect_b32 s17, s75, 0x80000000
    v_cmp_gt_u32 vcc, s59, v34
    v_mov_b32 v12, 0x40000000
    v_and_b32 v36, 7, v34
    v_lshlrev_b32 v36, 4, v36
    v_bfe_u32 v20, v34, 3, 1
    v_lshl_add_u32 v36, v20, 12, v36
    v_cndmask_b32 v12, v12, v36, vcc
    v_mov_b32 v24, 0
    v_cmp_eq_u32 vcc, 0, v17
    v_mov_b32 v20, 0x3f80
    s_nop 0
    v_cndmask_b32 v24, v24, v20, vcc
    v_cmp_eq_u32 vcc, 1, v17
    v_mov_b32 v20, 0x3f800000
    s_nop 0
    v_cndmask_b32 v24, v24, v20, vcc
    v_mov_b32 v25, 0
    v_cmp_eq_u32 vcc, 4, v17
    v_mov_b32 v20, 0x3f80
    s_nop 0
    v_cndmask_b32 v25, v25, v20, vcc
    v_cmp_eq_u32 vcc, 5, v17
    v_mov_b32 v20, 0x3f800000
    s_nop 0
    v_cndmask_b32 v25, v25, v20, vcc
    v_mov_b32 v26, 0
    v_cmp_eq_u32 vcc, 8, v17
    v_mov_b32 v20, 0x3f80
    s_nop 0
    v_cndmask_b32 v26, v26, v20, vcc
    v_cmp_eq_u32 vcc, 9, v17
    v_mov_b32 v20, 0x3f800000
    s_nop 0
    v_cndmask_b32 v26, v26, v20, vcc
    v_mov_b32 v27, 0
    v_cmp_eq_u32 vcc, 12, v17
    v_mov_b32 v20, 0x3f80
    s_nop 0
    v_cndmask_b32 v27, v27, v20, vcc
    v_cmp_eq_u32 vcc, 13, v17
    v_mov_b32 v20, 0x3f800000
    s_nop 0
    v_cndmask_b32 v27, v27, v20, vcc
    ds_write_b128 v3, v[24:27] offset:31296
    v_mov_b32 v24, -1
    v_mov_b32 v25, -1
    v_mov_b32 v26, -1
    v_mov_b32 v27, -1
    s_add_u32 s59, s81, 0x700000
    buffer_store_dwordx4 v[24:27], v1, s[36:39], s59 offen offset:0
    buffer_store_dwordx4 v[24:27], v1, s[36:39], s59 offen offset:1024
    s_lshl_b32 s59, s57, 13
    s_lshl_b32 s60, s56, 7
    s_add_u32 s59, s59, s60
    s_add_u32 s59, s59, 0x6f8000
    s_mov_b64 exec, 0xffff
    buffer_store_dwordx4 v[24:27], v36, s[36:39], s59 offen
    s_mov_b64 exec, -1
    v_lshrrev_b32 v20, 1, v16
    v_lshlrev_b32 v32, 18, v20
    v_lshl_add_u32 v32, v18, 16, v32
    v_lshl_add_u32 v32, v17, 2, v32
    v_lshlrev_b32 v33, 12, v16
    v_lshl_add_u32 v33, v17, 4, v33
    s_lshl_b32 s63, s56, 8
    s_lshl_b32 s59, s57, 6
    s_add_u32 s63, s63, s59
    s_lshl_b32 s64, s56, 17
    s_lshl_b32 s59, s57, 8
    s_add_u32 s64, s64, s59
    s_mov_b32 s12, s6
    s_mov_b32 s13, s7
    s_xor_b32 s59, s57, 0
    s_lshl_b32 s60, s59, 20
    s_add_u32 s4, s63, s60
    s_lshl_b32 s60, s59, 15
    s_add_u32 s8, s64, s60
    s_xor_b32 s59, s57, 1
    s_lshl_b32 s60, s59, 20
    s_add_u32 s5, s63, s60
    s_lshl_b32 s60, s59, 15
    s_add_u32 s9, s64, s60
    s_xor_b32 s59, s57, 2
    s_lshl_b32 s60, s59, 20
    s_add_u32 s6, s63, s60
    s_lshl_b32 s60, s59, 15
    s_add_u32 s10, s64, s60
    s_xor_b32 s59, s57, 3
    s_lshl_b32 s60, s59, 20
    s_add_u32 s7, s63, s60
    s_lshl_b32 s60, s59, 15
    s_add_u32 s11, s64, s60
    v_lshlrev_b32 v35, 3, v1
    s_lshl_b32 s15, s56, 17
    s_lshl_b32 s59, s57, 15
    s_add_u32 s15, s15, s59
    s_add_u32 s59, s8, 0x0
    buffer_load_dwordx4 v[48:51], v33, s[52:55], s59 offen
    s_add_u32 s59, s8, 0x400
    buffer_load_dwordx4 v[52:55], v33, s[52:55], s59 offen
    s_add_u32 s59, s8, 0x800
    buffer_load_dwordx4 v[56:59], v33, s[52:55], s59 offen
    s_add_u32 s59, s8, 0xc00
    buffer_load_dwordx4 v[60:63], v33, s[52:55], s59 offen
    s_add_u32 s59, s8, 0x4000
    buffer_load_dwordx4 v[64:67], v33, s[52:55], s59 offen
    s_add_u32 s59, s8, 0x4400
    buffer_load_dwordx4 v[68:71], v33, s[52:55], s59 offen
    s_add_u32 s59, s8, 0x4800
    buffer_load_dwordx4 v[72:75], v33, s[52:55], s59 offen
    s_add_u32 s59, s8, 0x4c00
    buffer_load_dwordx4 v[76:79], v33, s[52:55], s59 offen
    s_add_u32 s59, s9, 0x0
    buffer_load_dwordx4 v[80:83], v33, s[52:55], s59 offen
    s_add_u32 s59, s9, 0x400
    buffer_load_dwordx4 v[84:87], v33, s[52:55], s59 offen
    s_add_u32 s59, s9, 0x800
    buffer_load_dwordx4 v[88:91], v33, s[52:55], s59 offen
    s_add_u32 s59, s9, 0xc00
    buffer_load_dwordx4 v[92:95], v33, s[52:55], s59 offen
    s_add_u32 s59, s9, 0x4000
    buffer_load_dwordx4 v[96:99], v33, s[52:55], s59 offen
    s_add_u32 s59, s9, 0x4400
    buffer_load_dwordx4 v[100:103], v33, s[52:55], s59 offen
    s_add_u32 s59, s9, 0x4800
    buffer_load_dwordx4 v[104:107], v33, s[52:55], s59 offen
    s_add_u32 s59, s9, 0x4c00
    buffer_load_dwordx4 v[108:111], v33, s[52:55], s59 offen
    s_waitcnt vmcnt(14)
    v_perm_b32 v22, v52, v48, s66
    v_accvgpr_write_b32 a128, v22
    v_perm_b32 v23, v54, v50, s66
    v_accvgpr_write_b32 a129, v23
    v_perm_b32 v22, v52, v48, s67
    v_accvgpr_write_b32 a136, v22
    v_perm_b32 v23, v54, v50, s67
    v_accvgpr_write_b32 a137, v23
    v_perm_b32 v22, v53, v49, s66
    v_accvgpr_write_b32 a144, v22
    v_perm_b32 v23, v55, v51, s66
    v_accvgpr_write_b32 a145, v23
    v_perm_b32 v22, v53, v49, s67
    v_accvgpr_write_b32 a152, v22
    v_perm_b32 v23, v55, v51, s67
    v_accvgpr_write_b32 a153, v23
    s_add_u32 s59, s10, 0x0
    buffer_load_dwordx4 v[48:51], v33, s[52:55], s59 offen
    s_add_u32 s59, s10, 0x400
    buffer_load_dwordx4 v[52:55], v33, s[52:55], s59 offen
    s_waitcnt vmcnt(14)
    v_perm_b32 v22, v60, v56, s66
    v_accvgpr_write_b32 a130, v22
    v_perm_b32 v23, v62, v58, s66
    v_accvgpr_write_b32 a131, v23
    v_perm_b32 v22, v60, v56, s67
    v_accvgpr_write_b32 a138, v22
    v_perm_b32 v23, v62, v58, s67
    v_accvgpr_write_b32 a139, v23
    v_perm_b32 v22, v61, v57, s66
    v_accvgpr_write_b32 a146, v22
    v_perm_b32 v23, v63, v59, s66
    v_accvgpr_write_b32 a147, v23
    v_perm_b32 v22, v61, v57, s67
    v_accvgpr_write_b32 a154, v22
    v_perm_b32 v23, v63, v59, s67
    v_accvgpr_write_b32 a155, v23
    s_add_u32 s59, s10, 0x800
    buffer_load_dwordx4 v[56:59], v33, s[52:55], s59 offen
    s_add_u32 s59, s10, 0xc00
    buffer_load_dwordx4 v[60:63], v33, s[52:55], s59 offen
    s_waitcnt vmcnt(14)
    v_perm_b32 v22, v68, v64, s66
    v_accvgpr_write_b32 a132, v22
    v_perm_b32 v23, v70, v66, s66
    v_accvgpr_write_b32 a133, v23
    v_perm_b32 v22, v68, v64, s67
    v_accvgpr_write_b32 a140, v22
    v_perm_b32 v23, v70, v66, s67
    v_accvgpr_write_b32 a141, v23
    v_perm_b32 v22, v69, v65, s66
    v_accvgpr_write_b32 a148, v22
    v_perm_b32 v23, v71, v67, s66
    v_accvgpr_write_b32 a149, v23
    v_perm_b32 v22, v69, v65, s67
    v_accvgpr_write_b32 a156, v22
    v_perm_b32 v23, v71, v67, s67
    v_accvgpr_write_b32 a157, v23
    s_add_u32 s59, s10, 0x4000
    buffer_load_dwordx4 v[64:67], v33, s[52:55], s59 offen
    s_add_u32 s59, s10, 0x4400
    buffer_load_dwordx4 v[68:71], v33, s[52:55], s59 offen
    s_waitcnt vmcnt(14)
    v_perm_b32 v22, v76, v72, s66
    v_accvgpr_write_b32 a134, v22
    v_perm_b32 v23, v78, v74, s66
    v_accvgpr_write_b32 a135, v23
    v_perm_b32 v22, v76, v72, s67
    v_accvgpr_write_b32 a142, v22
    v_perm_b32 v23, v78, v74, s67
    v_accvgpr_write_b32 a143, v23
    v_perm_b32 v22, v77, v73, s66
    v_accvgpr_write_b32 a150, v22
    v_perm_b32 v23, v79, v75, s66
    v_accvgpr_write_b32 a151, v23
    v_perm_b32 v22, v77, v73, s67
    v_accvgpr_write_b32 a158, v22
    v_perm_b32 v23, v79, v75, s67
    v_accvgpr_write_b32 a159, v23
    s_add_u32 s59, s10, 0x4800
    buffer_load_dwordx4 v[72:75], v33, s[52:55], s59 offen
    s_add_u32 s59, s10, 0x4c00
    buffer_load_dwordx4 v[76:79], v33, s[52:55], s59 offen
    s_waitcnt vmcnt(14)
    v_perm_b32 v22, v84, v80, s66
    v_accvgpr_write_b32 a160, v22
    v_perm_b32 v23, v86, v82, s66
    v_accvgpr_write_b32 a161, v23
    v_perm_b32 v192, v84, v80, s67
    v_perm_b32 v193, v86, v82, s67
    v_perm_b32 v232, v85, v81, s66
    v_perm_b32 v233, v87, v83, s66
    v_perm_b32 v240, v85, v81, s67
    v_perm_b32 v241, v87, v83, s67
    s_add_u32 s59, s11, 0x0
    buffer_load_dwordx4 v[80:83], v33, s[52:55], s59 offen
    s_add_u32 s59, s11, 0x400
    buffer_load_dwordx4 v[84:87], v33, s[52:55], s59 offen
    s_waitcnt vmcnt(14)
    v_perm_b32 v22, v92, v88, s66
    v_accvgpr_write_b32 a162, v22
    v_perm_b32 v23, v94, v90, s66
    v_accvgpr_write_b32 a163, v23
    v_perm_b32 v194, v92, v88, s67
    v_perm_b32 v195, v94, v90, s67
    v_perm_b32 v234, v93, v89, s66
    v_perm_b32 v235, v95, v91, s66
    v_perm_b32 v242, v93, v89, s67
    v_perm_b32 v243, v95, v91, s67
    s_add_u32 s59, s11, 0x800
    buffer_load_dwordx4 v[88:91], v33, s[52:55], s59 offen
    s_add_u32 s59, s11, 0xc00
    buffer_load_dwordx4 v[92:95], v33, s[52:55], s59 offen
    s_waitcnt vmcnt(14)
    v_perm_b32 v22, v100, v96, s66
    v_accvgpr_write_b32 a164, v22
    v_perm_b32 v23, v102, v98, s66
    v_accvgpr_write_b32 a165, v23
    v_perm_b32 v196, v100, v96, s67
    v_perm_b32 v197, v102, v98, s67
    v_perm_b32 v236, v101, v97, s66
    v_perm_b32 v237, v103, v99, s66
    v_perm_b32 v244, v101, v97, s67
    v_perm_b32 v245, v103, v99, s67
    s_add_u32 s59, s11, 0x4000
    buffer_load_dwordx4 v[96:99], v33, s[52:55], s59 offen
    s_add_u32 s59, s11, 0x4400
    buffer_load_dwordx4 v[100:103], v33, s[52:55], s59 offen
    s_waitcnt vmcnt(14)
    v_perm_b32 v22, v108, v104, s66
    v_accvgpr_write_b32 a166, v22
    v_perm_b32 v23, v110, v106, s66
    v_accvgpr_write_b32 a167, v23
    v_perm_b32 v198, v108, v104, s67
    v_perm_b32 v199, v110, v106, s67
    v_perm_b32 v238, v109, v105, s66
    v_perm_b32 v239, v111, v107, s66
    v_perm_b32 v246, v109, v105, s67
    v_perm_b32 v247, v111, v107, s67
    s_add_u32 s59, s11, 0x4800
    buffer_load_dwordx4 v[104:107], v33, s[52:55], s59 offen
    s_add_u32 s59, s11, 0x4c00
    buffer_load_dwordx4 v[108:111], v33, s[52:55], s59 offen
    s_waitcnt vmcnt(14)
    v_perm_b32 v200, v52, v48, s66
    v_perm_b32 v201, v54, v50, s66
    v_perm_b32 v208, v52, v48, s67
    v_perm_b32 v209, v54, v50, s67
    v_perm_b32 v248, v53, v49, s66
    v_perm_b32 v249, v55, v51, s66
    v_perm_b32 v22, v53, v49, s67
    v_accvgpr_write_b32 a168, v22
    v_perm_b32 v23, v55, v51, s67
    v_accvgpr_write_b32 a169, v23
    s_add_u32 s59, s4, 0x0
    buffer_load_dword v48, v32, s[40:43], s59 offen
    s_add_u32 s59, s4, 0x2000
    buffer_load_dword v49, v32, s[40:43], s59 offen
    s_add_u32 s59, s4, 0x20000
    buffer_load_dword v50, v32, s[40:43], s59 offen
    s_add_u32 s59, s4, 0x22000
    buffer_load_dword v51, v32, s[40:43], s59 offen
    s_add_u32 s59, s4, 0x8000
    buffer_load_dword v52, v32, s[40:43], s59 offen
    s_add_u32 s59, s4, 0xa000
    buffer_load_dword v53, v32, s[40:43], s59 offen
    s_add_u32 s59, s4, 0x28000
    buffer_load_dword v54, v32, s[40:43], s59 offen
    s_add_u32 s59, s4, 0x2a000
    buffer_load_dword v55, v32, s[40:43], s59 offen
    s_waitcnt vmcnt(20)
    v_perm_b32 v202, v60, v56, s66
    v_perm_b32 v203, v62, v58, s66
    v_perm_b32 v210, v60, v56, s67
    v_perm_b32 v211, v62, v58, s67
    v_perm_b32 v250, v61, v57, s66
    v_perm_b32 v251, v63, v59, s66
    v_perm_b32 v22, v61, v57, s67
    v_accvgpr_write_b32 a170, v22
    v_perm_b32 v23, v63, v59, s67
    v_accvgpr_write_b32 a171, v23
    s_add_u32 s59, s4, 0x80000
    buffer_load_dword v56, v32, s[40:43], s59 offen
    s_add_u32 s59, s4, 0x82000
    buffer_load_dword v57, v32, s[40:43], s59 offen
    s_add_u32 s59, s4, 0xa0000
    buffer_load_dword v58, v32, s[40:43], s59 offen
    s_add_u32 s59, s4, 0xa2000
    buffer_load_dword v59, v32, s[40:43], s59 offen
    s_add_u32 s59, s4, 0x88000
    buffer_load_dword v60, v32, s[40:43], s59 offen
    s_add_u32 s59, s4, 0x8a000
    buffer_load_dword v61, v32, s[40:43], s59 offen
    s_add_u32 s59, s4, 0xa8000
    buffer_load_dword v62, v32, s[40:43], s59 offen
    s_add_u32 s59, s4, 0xaa000
    buffer_load_dword v63, v32, s[40:43], s59 offen
    s_waitcnt vmcnt(26)
    v_perm_b32 v204, v68, v64, s66
    v_perm_b32 v205, v70, v66, s66
    v_perm_b32 v212, v68, v64, s67
    v_perm_b32 v213, v70, v66, s67
    v_perm_b32 v252, v69, v65, s66
    v_perm_b32 v253, v71, v67, s66
    v_perm_b32 v22, v69, v65, s67
    v_accvgpr_write_b32 a172, v22
    v_perm_b32 v23, v71, v67, s67
    v_accvgpr_write_b32 a173, v23
    s_add_u32 s59, s4, 0x4000
    buffer_load_dword v64, v32, s[40:43], s59 offen
    s_add_u32 s59, s4, 0x6000
    buffer_load_dword v65, v32, s[40:43], s59 offen
    s_add_u32 s59, s4, 0x24000
    buffer_load_dword v66, v32, s[40:43], s59 offen
    s_add_u32 s59, s4, 0x26000
    buffer_load_dword v67, v32, s[40:43], s59 offen
    s_add_u32 s59, s4, 0xc000
    buffer_load_dword v68, v32, s[40:43], s59 offen
    s_add_u32 s59, s4, 0xe000
    buffer_load_dword v69, v32, s[40:43], s59 offen
    s_add_u32 s59, s4, 0x2c000
    buffer_load_dword v70, v32, s[40:43], s59 offen
    s_add_u32 s59, s4, 0x2e000
    buffer_load_dword v71, v32, s[40:43], s59 offen
    s_waitcnt vmcnt(32)
    v_perm_b32 v206, v76, v72, s66
    v_perm_b32 v207, v78, v74, s66
    v_perm_b32 v214, v76, v72, s67
    v_perm_b32 v215, v78, v74, s67
    v_perm_b32 v254, v77, v73, s66
    v_perm_b32 v255, v79, v75, s66
    v_perm_b32 v22, v77, v73, s67
    v_accvgpr_write_b32 a174, v22
    v_perm_b32 v23, v79, v75, s67
    v_accvgpr_write_b32 a175, v23
    s_add_u32 s59, s4, 0x84000
    buffer_load_dword v72, v32, s[40:43], s59 offen
    s_add_u32 s59, s4, 0x86000
    buffer_load_dword v73, v32, s[40:43], s59 offen
    s_add_u32 s59, s4, 0xa4000
    buffer_load_dword v74, v32, s[40:43], s59 offen
    s_add_u32 s59, s4, 0xa6000
    buffer_load_dword v75, v32, s[40:43], s59 offen
    s_add_u32 s59, s4, 0x8c000
    buffer_load_dword v76, v32, s[40:43], s59 offen
    s_add_u32 s59, s4, 0x8e000
    buffer_load_dword v77, v32, s[40:43], s59 offen
    s_add_u32 s59, s4, 0xac000
    buffer_load_dword v78, v32, s[40:43], s59 offen
    s_add_u32 s59, s4, 0xae000
    buffer_load_dword v79, v32, s[40:43], s59 offen
    s_waitcnt vmcnt(38)
    v_perm_b32 v216, v84, v80, s66
    v_perm_b32 v217, v86, v82, s66
    v_perm_b32 v224, v84, v80, s67
    v_perm_b32 v225, v86, v82, s67
    v_perm_b32 v22, v85, v81, s66
    v_accvgpr_write_b32 a176, v22
    v_perm_b32 v23, v87, v83, s66
    v_accvgpr_write_b32 a177, v23
    v_perm_b32 v22, v85, v81, s67
    v_accvgpr_write_b32 a184, v22
    v_perm_b32 v23, v87, v83, s67
    v_accvgpr_write_b32 a185, v23
    s_add_u32 s59, s5, 0x0
    buffer_load_dword v80, v32, s[40:43], s59 offen
    s_add_u32 s59, s5, 0x2000
    buffer_load_dword v81, v32, s[40:43], s59 offen
    s_add_u32 s59, s5, 0x20000
    buffer_load_dword v82, v32, s[40:43], s59 offen
    s_add_u32 s59, s5, 0x22000
    buffer_load_dword v83, v32, s[40:43], s59 offen
    s_add_u32 s59, s5, 0x8000
    buffer_load_dword v84, v32, s[40:43], s59 offen
    s_add_u32 s59, s5, 0xa000
    buffer_load_dword v85, v32, s[40:43], s59 offen
    s_add_u32 s59, s5, 0x28000
    buffer_load_dword v86, v32, s[40:43], s59 offen
    s_add_u32 s59, s5, 0x2a000
    buffer_load_dword v87, v32, s[40:43], s59 offen
    s_waitcnt vmcnt(44)
    v_perm_b32 v218, v92, v88, s66
    v_perm_b32 v219, v94, v90, s66
    v_perm_b32 v226, v92, v88, s67
    v_perm_b32 v227, v94, v90, s67
    v_perm_b32 v22, v93, v89, s66
    v_accvgpr_write_b32 a178, v22
    v_perm_b32 v23, v95, v91, s66
    v_accvgpr_write_b32 a179, v23
    v_perm_b32 v22, v93, v89, s67
    v_accvgpr_write_b32 a186, v22
    v_perm_b32 v23, v95, v91, s67
    v_accvgpr_write_b32 a187, v23
    s_add_u32 s59, s5, 0x80000
    buffer_load_dword v88, v32, s[40:43], s59 offen
    s_add_u32 s59, s5, 0x82000
    buffer_load_dword v89, v32, s[40:43], s59 offen
    s_add_u32 s59, s5, 0xa0000
    buffer_load_dword v90, v32, s[40:43], s59 offen
    s_add_u32 s59, s5, 0xa2000
    buffer_load_dword v91, v32, s[40:43], s59 offen
    s_add_u32 s59, s5, 0x88000
    buffer_load_dword v92, v32, s[40:43], s59 offen
    s_add_u32 s59, s5, 0x8a000
    buffer_load_dword v93, v32, s[40:43], s59 offen
    s_add_u32 s59, s5, 0xa8000
    buffer_load_dword v94, v32, s[40:43], s59 offen
    s_add_u32 s59, s5, 0xaa000
    buffer_load_dword v95, v32, s[40:43], s59 offen
    s_waitcnt vmcnt(50)
    v_perm_b32 v220, v100, v96, s66
    v_perm_b32 v221, v102, v98, s66
    v_perm_b32 v228, v100, v96, s67
    v_perm_b32 v229, v102, v98, s67
    v_perm_b32 v22, v101, v97, s66
    v_accvgpr_write_b32 a180, v22
    v_perm_b32 v23, v103, v99, s66
    v_accvgpr_write_b32 a181, v23
    v_perm_b32 v22, v101, v97, s67
    v_accvgpr_write_b32 a188, v22
    v_perm_b32 v23, v103, v99, s67
    v_accvgpr_write_b32 a189, v23
    s_add_u32 s59, s5, 0x4000
    buffer_load_dword v96, v32, s[40:43], s59 offen
    s_add_u32 s59, s5, 0x6000
    buffer_load_dword v97, v32, s[40:43], s59 offen
    s_add_u32 s59, s5, 0x24000
    buffer_load_dword v98, v32, s[40:43], s59 offen
    s_add_u32 s59, s5, 0x26000
    buffer_load_dword v99, v32, s[40:43], s59 offen
    s_add_u32 s59, s5, 0xc000
    buffer_load_dword v100, v32, s[40:43], s59 offen
    s_add_u32 s59, s5, 0xe000
    buffer_load_dword v101, v32, s[40:43], s59 offen
    s_add_u32 s59, s5, 0x2c000
    buffer_load_dword v102, v32, s[40:43], s59 offen
    s_add_u32 s59, s5, 0x2e000
    buffer_load_dword v103, v32, s[40:43], s59 offen
    s_waitcnt vmcnt(56)
    v_perm_b32 v222, v108, v104, s66
    v_perm_b32 v223, v110, v106, s66
    v_perm_b32 v230, v108, v104, s67
    v_perm_b32 v231, v110, v106, s67
    v_perm_b32 v22, v109, v105, s66
    v_accvgpr_write_b32 a182, v22
    v_perm_b32 v23, v111, v107, s66
    v_accvgpr_write_b32 a183, v23
    v_perm_b32 v22, v109, v105, s67
    v_accvgpr_write_b32 a190, v22
    v_perm_b32 v23, v111, v107, s67
    v_accvgpr_write_b32 a191, v23
    s_add_u32 s59, s5, 0x84000
    buffer_load_dword v104, v32, s[40:43], s59 offen
    s_add_u32 s59, s5, 0x86000
    buffer_load_dword v105, v32, s[40:43], s59 offen
    s_add_u32 s59, s5, 0xa4000
    buffer_load_dword v106, v32, s[40:43], s59 offen
    s_add_u32 s59, s5, 0xa6000
    buffer_load_dword v107, v32, s[40:43], s59 offen
    s_add_u32 s59, s5, 0x8c000
    buffer_load_dword v108, v32, s[40:43], s59 offen
    s_add_u32 s59, s5, 0x8e000
    buffer_load_dword v109, v32, s[40:43], s59 offen
    s_add_u32 s59, s5, 0xac000
    buffer_load_dword v110, v32, s[40:43], s59 offen
    s_add_u32 s59, s5, 0xae000
    buffer_load_dword v111, v32, s[40:43], s59 offen
    s_waitcnt vmcnt(56)
    v_perm_b32 v22, v49, v48, s66
    v_accvgpr_write_b32 a192, v22
    v_perm_b32 v23, v49, v48, s67
    v_accvgpr_write_b32 a200, v23
    v_perm_b32 v22, v51, v50, s66
    v_accvgpr_write_b32 a193, v22
    v_perm_b32 v23, v51, v50, s67
    v_accvgpr_write_b32 a201, v23
    v_perm_b32 v22, v53, v52, s66
    v_accvgpr_write_b32 a194, v22
    v_perm_b32 v23, v53, v52, s67
    v_accvgpr_write_b32 a202, v23
    v_perm_b32 v22, v55, v54, s66
    v_accvgpr_write_b32 a195, v22
    v_perm_b32 v23, v55, v54, s67
    v_accvgpr_write_b32 a203, v23
    s_add_u32 s59, s6, 0x0
    buffer_load_dword v48, v32, s[40:43], s59 offen
    s_add_u32 s59, s6, 0x2000
    buffer_load_dword v49, v32, s[40:43], s59 offen
    s_add_u32 s59, s6, 0x20000
    buffer_load_dword v50, v32, s[40:43], s59 offen
    s_add_u32 s59, s6, 0x22000
    buffer_load_dword v51, v32, s[40:43], s59 offen
    s_add_u32 s59, s6, 0x8000
    buffer_load_dword v52, v32, s[40:43], s59 offen
    s_add_u32 s59, s6, 0xa000
    buffer_load_dword v53, v32, s[40:43], s59 offen
    s_add_u32 s59, s6, 0x28000
    buffer_load_dword v54, v32, s[40:43], s59 offen
    s_add_u32 s59, s6, 0x2a000
    buffer_load_dword v55, v32, s[40:43], s59 offen
    s_waitcnt vmcnt(56)
    v_perm_b32 v22, v57, v56, s66
    v_accvgpr_write_b32 a196, v22
    v_perm_b32 v23, v57, v56, s67
    v_accvgpr_write_b32 a204, v23
    v_perm_b32 v22, v59, v58, s66
    v_accvgpr_write_b32 a197, v22
    v_perm_b32 v23, v59, v58, s67
    v_accvgpr_write_b32 a205, v23
    v_perm_b32 v22, v61, v60, s66
    v_accvgpr_write_b32 a198, v22
    v_perm_b32 v23, v61, v60, s67
    v_accvgpr_write_b32 a206, v23
    v_perm_b32 v22, v63, v62, s66
    v_accvgpr_write_b32 a199, v22
    v_perm_b32 v23, v63, v62, s67
    v_accvgpr_write_b32 a207, v23
    s_add_u32 s59, s6, 0x80000
    buffer_load_dword v56, v32, s[40:43], s59 offen
    s_add_u32 s59, s6, 0x82000
    buffer_load_dword v57, v32, s[40:43], s59 offen
    s_add_u32 s59, s6, 0xa0000
    buffer_load_dword v58, v32, s[40:43], s59 offen
    s_add_u32 s59, s6, 0xa2000
    buffer_load_dword v59, v32, s[40:43], s59 offen
    s_add_u32 s59, s6, 0x88000
    buffer_load_dword v60, v32, s[40:43], s59 offen
    s_add_u32 s59, s6, 0x8a000
    buffer_load_dword v61, v32, s[40:43], s59 offen
    s_add_u32 s59, s6, 0xa8000
    buffer_load_dword v62, v32, s[40:43], s59 offen
    s_add_u32 s59, s6, 0xaa000
    buffer_load_dword v63, v32, s[40:43], s59 offen
    s_waitcnt vmcnt(56)
    v_perm_b32 v22, v65, v64, s66
    v_accvgpr_write_b32 a208, v22
    v_perm_b32 v23, v65, v64, s67
    v_accvgpr_write_b32 a216, v23
    v_perm_b32 v22, v67, v66, s66
    v_accvgpr_write_b32 a209, v22
    v_perm_b32 v23, v67, v66, s67
    v_accvgpr_write_b32 a217, v23
    v_perm_b32 v22, v69, v68, s66
    v_accvgpr_write_b32 a210, v22
    v_perm_b32 v23, v69, v68, s67
    v_accvgpr_write_b32 a218, v23
    v_perm_b32 v22, v71, v70, s66
    v_accvgpr_write_b32 a211, v22
    v_perm_b32 v23, v71, v70, s67
    v_accvgpr_write_b32 a219, v23
    s_add_u32 s59, s6, 0x4000
    buffer_load_dword v64, v32, s[40:43], s59 offen
    s_add_u32 s59, s6, 0x6000
    buffer_load_dword v65, v32, s[40:43], s59 offen
    s_add_u32 s59, s6, 0x24000
    buffer_load_dword v66, v32, s[40:43], s59 offen
    s_add_u32 s59, s6, 0x26000
    buffer_load_dword v67, v32, s[40:43], s59 offen
    s_add_u32 s59, s6, 0xc000
    buffer_load_dword v68, v32, s[40:43], s59 offen
    s_add_u32 s59, s6, 0xe000
    buffer_load_dword v69, v32, s[40:43], s59 offen
    s_add_u32 s59, s6, 0x2c000
    buffer_load_dword v70, v32, s[40:43], s59 offen
    s_add_u32 s59, s6, 0x2e000
    buffer_load_dword v71, v32, s[40:43], s59 offen
    s_waitcnt vmcnt(56)
    v_perm_b32 v22, v73, v72, s66
    v_accvgpr_write_b32 a212, v22
    v_perm_b32 v23, v73, v72, s67
    v_accvgpr_write_b32 a220, v23
    v_perm_b32 v22, v75, v74, s66
    v_accvgpr_write_b32 a213, v22
    v_perm_b32 v23, v75, v74, s67
    v_accvgpr_write_b32 a221, v23
    v_perm_b32 v22, v77, v76, s66
    v_accvgpr_write_b32 a214, v22
    v_perm_b32 v23, v77, v76, s67
    v_accvgpr_write_b32 a222, v23
    v_perm_b32 v22, v79, v78, s66
    v_accvgpr_write_b32 a215, v22
    v_perm_b32 v23, v79, v78, s67
    v_accvgpr_write_b32 a223, v23
    s_add_u32 s59, s6, 0x84000
    buffer_load_dword v72, v32, s[40:43], s59 offen
    s_add_u32 s59, s6, 0x86000
    buffer_load_dword v73, v32, s[40:43], s59 offen
    s_add_u32 s59, s6, 0xa4000
    buffer_load_dword v74, v32, s[40:43], s59 offen
    s_add_u32 s59, s6, 0xa6000
    buffer_load_dword v75, v32, s[40:43], s59 offen
    s_add_u32 s59, s6, 0x8c000
    buffer_load_dword v76, v32, s[40:43], s59 offen
    s_add_u32 s59, s6, 0x8e000
    buffer_load_dword v77, v32, s[40:43], s59 offen
    s_add_u32 s59, s6, 0xac000
    buffer_load_dword v78, v32, s[40:43], s59 offen
    s_add_u32 s59, s6, 0xae000
    buffer_load_dword v79, v32, s[40:43], s59 offen
    s_waitcnt vmcnt(56)
    v_perm_b32 v22, v81, v80, s66
    v_accvgpr_write_b32 a224, v22
    v_perm_b32 v23, v81, v80, s67
    v_accvgpr_write_b32 a232, v23
    v_perm_b32 v22, v83, v82, s66
    v_accvgpr_write_b32 a225, v22
    v_perm_b32 v23, v83, v82, s67
    v_accvgpr_write_b32 a233, v23
    v_perm_b32 v22, v85, v84, s66
    v_accvgpr_write_b32 a226, v22
    v_perm_b32 v23, v85, v84, s67
    v_accvgpr_write_b32 a234, v23
    v_perm_b32 v22, v87, v86, s66
    v_accvgpr_write_b32 a227, v22
    v_perm_b32 v23, v87, v86, s67
    v_accvgpr_write_b32 a235, v23
    s_add_u32 s59, s7, 0x0
    buffer_load_dword v80, v32, s[40:43], s59 offen
    s_add_u32 s59, s7, 0x2000
    buffer_load_dword v81, v32, s[40:43], s59 offen
    s_add_u32 s59, s7, 0x20000
    buffer_load_dword v82, v32, s[40:43], s59 offen
    s_add_u32 s59, s7, 0x22000
    buffer_load_dword v83, v32, s[40:43], s59 offen
    s_add_u32 s59, s7, 0x8000
    buffer_load_dword v84, v32, s[40:43], s59 offen
    s_add_u32 s59, s7, 0xa000
    buffer_load_dword v85, v32, s[40:43], s59 offen
    s_add_u32 s59, s7, 0x28000
    buffer_load_dword v86, v32, s[40:43], s59 offen
    s_add_u32 s59, s7, 0x2a000
    buffer_load_dword v87, v32, s[40:43], s59 offen
    s_waitcnt vmcnt(56)
    v_perm_b32 v22, v89, v88, s66
    v_accvgpr_write_b32 a228, v22
    v_perm_b32 v23, v89, v88, s67
    v_accvgpr_write_b32 a236, v23
    v_perm_b32 v22, v91, v90, s66
    v_accvgpr_write_b32 a229, v22
    v_perm_b32 v23, v91, v90, s67
    v_accvgpr_write_b32 a237, v23
    v_perm_b32 v22, v93, v92, s66
    v_accvgpr_write_b32 a230, v22
    v_perm_b32 v23, v93, v92, s67
    v_accvgpr_write_b32 a238, v23
    v_perm_b32 v22, v95, v94, s66
    v_accvgpr_write_b32 a231, v22
    v_perm_b32 v23, v95, v94, s67
    v_accvgpr_write_b32 a239, v23
    s_add_u32 s59, s7, 0x80000
    buffer_load_dword v88, v32, s[40:43], s59 offen
    s_add_u32 s59, s7, 0x82000
    buffer_load_dword v89, v32, s[40:43], s59 offen
    s_add_u32 s59, s7, 0xa0000
    buffer_load_dword v90, v32, s[40:43], s59 offen
    s_add_u32 s59, s7, 0xa2000
    buffer_load_dword v91, v32, s[40:43], s59 offen
    s_add_u32 s59, s7, 0x88000
    buffer_load_dword v92, v32, s[40:43], s59 offen
    s_add_u32 s59, s7, 0x8a000
    buffer_load_dword v93, v32, s[40:43], s59 offen
    s_add_u32 s59, s7, 0xa8000
    buffer_load_dword v94, v32, s[40:43], s59 offen
    s_add_u32 s59, s7, 0xaa000
    buffer_load_dword v95, v32, s[40:43], s59 offen
    s_waitcnt vmcnt(56)
    v_perm_b32 v22, v97, v96, s66
    v_accvgpr_write_b32 a240, v22
    v_perm_b32 v23, v97, v96, s67
    v_accvgpr_write_b32 a248, v23
    v_perm_b32 v22, v99, v98, s66
    v_accvgpr_write_b32 a241, v22
    v_perm_b32 v23, v99, v98, s67
    v_accvgpr_write_b32 a249, v23
    v_perm_b32 v22, v101, v100, s66
    v_accvgpr_write_b32 a242, v22
    v_perm_b32 v23, v101, v100, s67
    v_accvgpr_write_b32 a250, v23
    v_perm_b32 v22, v103, v102, s66
    v_accvgpr_write_b32 a243, v22
    v_perm_b32 v23, v103, v102, s67
    v_accvgpr_write_b32 a251, v23
    s_add_u32 s59, s7, 0x4000
    buffer_load_dword v96, v32, s[40:43], s59 offen
    s_add_u32 s59, s7, 0x6000
    buffer_load_dword v97, v32, s[40:43], s59 offen
    s_add_u32 s59, s7, 0x24000
    buffer_load_dword v98, v32, s[40:43], s59 offen
    s_add_u32 s59, s7, 0x26000
    buffer_load_dword v99, v32, s[40:43], s59 offen
    s_add_u32 s59, s7, 0xc000
    buffer_load_dword v100, v32, s[40:43], s59 offen
    s_add_u32 s59, s7, 0xe000
    buffer_load_dword v101, v32, s[40:43], s59 offen
    s_add_u32 s59, s7, 0x2c000
    buffer_load_dword v102, v32, s[40:43], s59 offen
    s_add_u32 s59, s7, 0x2e000
    buffer_load_dword v103, v32, s[40:43], s59 offen
    s_waitcnt vmcnt(56)
    v_perm_b32 v22, v105, v104, s66
    v_accvgpr_write_b32 a244, v22
    v_perm_b32 v23, v105, v104, s67
    v_accvgpr_write_b32 a252, v23
    v_perm_b32 v22, v107, v106, s66
    v_accvgpr_write_b32 a245, v22
    v_perm_b32 v23, v107, v106, s67
    v_accvgpr_write_b32 a253, v23
    v_perm_b32 v22, v109, v108, s66
    v_accvgpr_write_b32 a246, v22
    v_perm_b32 v23, v109, v108, s67
    v_accvgpr_write_b32 a254, v23
    v_perm_b32 v22, v111, v110, s66
    v_accvgpr_write_b32 a247, v22
    v_perm_b32 v23, v111, v110, s67
    v_accvgpr_write_b32 a255, v23
    s_add_u32 s59, s7, 0x84000
    buffer_load_dword v104, v32, s[40:43], s59 offen
    s_add_u32 s59, s7, 0x86000
    buffer_load_dword v105, v32, s[40:43], s59 offen
    s_add_u32 s59, s7, 0xa4000
    buffer_load_dword v106, v32, s[40:43], s59 offen
    s_add_u32 s59, s7, 0xa6000
    buffer_load_dword v107, v32, s[40:43], s59 offen
    s_add_u32 s59, s7, 0x8c000
    buffer_load_dword v108, v32, s[40:43], s59 offen
    s_add_u32 s59, s7, 0x8e000
    buffer_load_dword v109, v32, s[40:43], s59 offen
    s_add_u32 s59, s7, 0xac000
    buffer_load_dword v110, v32, s[40:43], s59 offen
    s_add_u32 s59, s7, 0xae000
    buffer_load_dword v111, v32, s[40:43], s59 offen
    s_waitcnt vmcnt(56)
    v_perm_b32 v128, v49, v48, s66
    v_perm_b32 v136, v49, v48, s67
    v_perm_b32 v129, v51, v50, s66
    v_perm_b32 v137, v51, v50, s67
    v_perm_b32 v130, v53, v52, s66
    v_perm_b32 v138, v53, v52, s67
    v_perm_b32 v131, v55, v54, s66
    v_perm_b32 v139, v55, v54, s67
    s_add_u32 s59, s4, 0x0
    buffer_load_dword v48, v32, s[44:47], s59 offen
    s_add_u32 s59, s4, 0x2000
    buffer_load_dword v49, v32, s[44:47], s59 offen
    s_add_u32 s59, s4, 0x20000
    buffer_load_dword v50, v32, s[44:47], s59 offen
    s_add_u32 s59, s4, 0x22000
    buffer_load_dword v51, v32, s[44:47], s59 offen
    s_add_u32 s59, s4, 0x8000
    buffer_load_dword v52, v32, s[44:47], s59 offen
    s_add_u32 s59, s4, 0xa000
    buffer_load_dword v53, v32, s[44:47], s59 offen
    s_add_u32 s59, s4, 0x28000
    buffer_load_dword v54, v32, s[44:47], s59 offen
    s_add_u32 s59, s4, 0x2a000
    buffer_load_dword v55, v32, s[44:47], s59 offen
    s_waitcnt vmcnt(56)
    v_perm_b32 v132, v57, v56, s66
    v_perm_b32 v140, v57, v56, s67
    v_perm_b32 v133, v59, v58, s66
    v_perm_b32 v141, v59, v58, s67
    v_perm_b32 v134, v61, v60, s66
    v_perm_b32 v142, v61, v60, s67
    v_perm_b32 v135, v63, v62, s66
    v_perm_b32 v143, v63, v62, s67
    s_add_u32 s59, s4, 0x80000
    buffer_load_dword v56, v32, s[44:47], s59 offen
    s_add_u32 s59, s4, 0x82000
    buffer_load_dword v57, v32, s[44:47], s59 offen
    s_add_u32 s59, s4, 0xa0000
    buffer_load_dword v58, v32, s[44:47], s59 offen
    s_add_u32 s59, s4, 0xa2000
    buffer_load_dword v59, v32, s[44:47], s59 offen
    s_add_u32 s59, s4, 0x88000
    buffer_load_dword v60, v32, s[44:47], s59 offen
    s_add_u32 s59, s4, 0x8a000
    buffer_load_dword v61, v32, s[44:47], s59 offen
    s_add_u32 s59, s4, 0xa8000
    buffer_load_dword v62, v32, s[44:47], s59 offen
    s_add_u32 s59, s4, 0xaa000
    buffer_load_dword v63, v32, s[44:47], s59 offen
    s_waitcnt vmcnt(56)
    v_perm_b32 v144, v65, v64, s66
    v_perm_b32 v152, v65, v64, s67
    v_perm_b32 v145, v67, v66, s66
    v_perm_b32 v153, v67, v66, s67
    v_perm_b32 v146, v69, v68, s66
    v_perm_b32 v154, v69, v68, s67
    v_perm_b32 v147, v71, v70, s66
    v_perm_b32 v155, v71, v70, s67
    s_add_u32 s59, s4, 0x4000
    buffer_load_dword v64, v32, s[44:47], s59 offen
    s_add_u32 s59, s4, 0x6000
    buffer_load_dword v65, v32, s[44:47], s59 offen
    s_add_u32 s59, s4, 0x24000
    buffer_load_dword v66, v32, s[44:47], s59 offen
    s_add_u32 s59, s4, 0x26000
    buffer_load_dword v67, v32, s[44:47], s59 offen
    s_add_u32 s59, s4, 0xc000
    buffer_load_dword v68, v32, s[44:47], s59 offen
    s_add_u32 s59, s4, 0xe000
    buffer_load_dword v69, v32, s[44:47], s59 offen
    s_add_u32 s59, s4, 0x2c000
    buffer_load_dword v70, v32, s[44:47], s59 offen
    s_add_u32 s59, s4, 0x2e000
    buffer_load_dword v71, v32, s[44:47], s59 offen
    s_waitcnt vmcnt(56)
    v_perm_b32 v148, v73, v72, s66
    v_perm_b32 v156, v73, v72, s67
    v_perm_b32 v149, v75, v74, s66
    v_perm_b32 v157, v75, v74, s67
    v_perm_b32 v150, v77, v76, s66
    v_perm_b32 v158, v77, v76, s67
    v_perm_b32 v151, v79, v78, s66
    v_perm_b32 v159, v79, v78, s67
    s_add_u32 s59, s4, 0x84000
    buffer_load_dword v72, v32, s[44:47], s59 offen
    s_add_u32 s59, s4, 0x86000
    buffer_load_dword v73, v32, s[44:47], s59 offen
    s_add_u32 s59, s4, 0xa4000
    buffer_load_dword v74, v32, s[44:47], s59 offen
    s_add_u32 s59, s4, 0xa6000
    buffer_load_dword v75, v32, s[44:47], s59 offen
    s_add_u32 s59, s4, 0x8c000
    buffer_load_dword v76, v32, s[44:47], s59 offen
    s_add_u32 s59, s4, 0x8e000
    buffer_load_dword v77, v32, s[44:47], s59 offen
    s_add_u32 s59, s4, 0xac000
    buffer_load_dword v78, v32, s[44:47], s59 offen
    s_add_u32 s59, s4, 0xae000
    buffer_load_dword v79, v32, s[44:47], s59 offen
    s_waitcnt vmcnt(56)
    v_perm_b32 v160, v81, v80, s66
    v_perm_b32 v168, v81, v80, s67
    v_perm_b32 v161, v83, v82, s66
    v_perm_b32 v169, v83, v82, s67
    v_perm_b32 v162, v85, v84, s66
    v_perm_b32 v170, v85, v84, s67
    v_perm_b32 v163, v87, v86, s66
    v_perm_b32 v171, v87, v86, s67
    s_add_u32 s59, s5, 0x0
    buffer_load_dword v80, v32, s[44:47], s59 offen
    s_add_u32 s59, s5, 0x2000
    buffer_load_dword v81, v32, s[44:47], s59 offen
    s_add_u32 s59, s5, 0x20000
    buffer_load_dword v82, v32, s[44:47], s59 offen
    s_add_u32 s59, s5, 0x22000
    buffer_load_dword v83, v32, s[44:47], s59 offen
    s_add_u32 s59, s5, 0x8000
    buffer_load_dword v84, v32, s[44:47], s59 offen
    s_add_u32 s59, s5, 0xa000
    buffer_load_dword v85, v32, s[44:47], s59 offen
    s_add_u32 s59, s5, 0x28000
    buffer_load_dword v86, v32, s[44:47], s59 offen
    s_add_u32 s59, s5, 0x2a000
    buffer_load_dword v87, v32, s[44:47], s59 offen
    s_waitcnt vmcnt(56)
    v_perm_b32 v164, v89, v88, s66
    v_perm_b32 v172, v89, v88, s67
    v_perm_b32 v165, v91, v90, s66
    v_perm_b32 v173, v91, v90, s67
    v_perm_b32 v166, v93, v92, s66
    v_perm_b32 v174, v93, v92, s67
    v_perm_b32 v167, v95, v94, s66
    v_perm_b32 v175, v95, v94, s67
    s_add_u32 s59, s5, 0x80000
    buffer_load_dword v88, v32, s[44:47], s59 offen
    s_add_u32 s59, s5, 0x82000
    buffer_load_dword v89, v32, s[44:47], s59 offen
    s_add_u32 s59, s5, 0xa0000
    buffer_load_dword v90, v32, s[44:47], s59 offen
    s_add_u32 s59, s5, 0xa2000
    buffer_load_dword v91, v32, s[44:47], s59 offen
    s_add_u32 s59, s5, 0x88000
    buffer_load_dword v92, v32, s[44:47], s59 offen
    s_add_u32 s59, s5, 0x8a000
    buffer_load_dword v93, v32, s[44:47], s59 offen
    s_add_u32 s59, s5, 0xa8000
    buffer_load_dword v94, v32, s[44:47], s59 offen
    s_add_u32 s59, s5, 0xaa000
    buffer_load_dword v95, v32, s[44:47], s59 offen
    s_waitcnt vmcnt(56)
    v_perm_b32 v176, v97, v96, s66
    v_perm_b32 v184, v97, v96, s67
    v_perm_b32 v177, v99, v98, s66
    v_perm_b32 v185, v99, v98, s67
    v_perm_b32 v178, v101, v100, s66
    v_perm_b32 v186, v101, v100, s67
    v_perm_b32 v179, v103, v102, s66
    v_perm_b32 v187, v103, v102, s67
    s_add_u32 s59, s5, 0x4000
    buffer_load_dword v96, v32, s[44:47], s59 offen
    s_add_u32 s59, s5, 0x6000
    buffer_load_dword v97, v32, s[44:47], s59 offen
    s_add_u32 s59, s5, 0x24000
    buffer_load_dword v98, v32, s[44:47], s59 offen
    s_add_u32 s59, s5, 0x26000
    buffer_load_dword v99, v32, s[44:47], s59 offen
    s_add_u32 s59, s5, 0xc000
    buffer_load_dword v100, v32, s[44:47], s59 offen
    s_add_u32 s59, s5, 0xe000
    buffer_load_dword v101, v32, s[44:47], s59 offen
    s_add_u32 s59, s5, 0x2c000
    buffer_load_dword v102, v32, s[44:47], s59 offen
    s_add_u32 s59, s5, 0x2e000
    buffer_load_dword v103, v32, s[44:47], s59 offen
    s_waitcnt vmcnt(56)
    v_perm_b32 v180, v105, v104, s66
    v_perm_b32 v188, v105, v104, s67
    v_perm_b32 v181, v107, v106, s66
    v_perm_b32 v189, v107, v106, s67
    v_perm_b32 v182, v109, v108, s66
    v_perm_b32 v190, v109, v108, s67
    v_perm_b32 v183, v111, v110, s66
    v_perm_b32 v191, v111, v110, s67
    s_add_u32 s59, s5, 0x84000
    buffer_load_dword v104, v32, s[44:47], s59 offen
    s_add_u32 s59, s5, 0x86000
    buffer_load_dword v105, v32, s[44:47], s59 offen
    s_add_u32 s59, s5, 0xa4000
    buffer_load_dword v106, v32, s[44:47], s59 offen
    s_add_u32 s59, s5, 0xa6000
    buffer_load_dword v107, v32, s[44:47], s59 offen
    s_add_u32 s59, s5, 0x8c000
    buffer_load_dword v108, v32, s[44:47], s59 offen
    s_add_u32 s59, s5, 0x8e000
    buffer_load_dword v109, v32, s[44:47], s59 offen
    s_add_u32 s59, s5, 0xac000
    buffer_load_dword v110, v32, s[44:47], s59 offen
    s_add_u32 s59, s5, 0xae000
    buffer_load_dword v111, v32, s[44:47], s59 offen
    s_waitcnt vmcnt(56)
    v_perm_b32 v22, v49, v48, s66
    v_accvgpr_write_b32 a0, v22
    v_perm_b32 v23, v49, v48, s67
    v_accvgpr_write_b32 a8, v23
    v_perm_b32 v22, v51, v50, s66
    v_accvgpr_write_b32 a1, v22
    v_perm_b32 v23, v51, v50, s67
    v_accvgpr_write_b32 a9, v23
    v_perm_b32 v22, v53, v52, s66
    v_accvgpr_write_b32 a2, v22
    v_perm_b32 v23, v53, v52, s67
    v_accvgpr_write_b32 a10, v23
    v_perm_b32 v22, v55, v54, s66
    v_accvgpr_write_b32 a3, v22
    v_perm_b32 v23, v55, v54, s67
    v_accvgpr_write_b32 a11, v23
    s_add_u32 s59, s6, 0x0
    buffer_load_dword v48, v32, s[44:47], s59 offen
    s_add_u32 s59, s6, 0x2000
    buffer_load_dword v49, v32, s[44:47], s59 offen
    s_add_u32 s59, s6, 0x20000
    buffer_load_dword v50, v32, s[44:47], s59 offen
    s_add_u32 s59, s6, 0x22000
    buffer_load_dword v51, v32, s[44:47], s59 offen
    s_add_u32 s59, s6, 0x8000
    buffer_load_dword v52, v32, s[44:47], s59 offen
    s_add_u32 s59, s6, 0xa000
    buffer_load_dword v53, v32, s[44:47], s59 offen
    s_add_u32 s59, s6, 0x28000
    buffer_load_dword v54, v32, s[44:47], s59 offen
    s_add_u32 s59, s6, 0x2a000
    buffer_load_dword v55, v32, s[44:47], s59 offen
    s_waitcnt vmcnt(56)
    v_perm_b32 v22, v57, v56, s66
    v_accvgpr_write_b32 a4, v22
    v_perm_b32 v23, v57, v56, s67
    v_accvgpr_write_b32 a12, v23
    v_perm_b32 v22, v59, v58, s66
    v_accvgpr_write_b32 a5, v22
    v_perm_b32 v23, v59, v58, s67
    v_accvgpr_write_b32 a13, v23
    v_perm_b32 v22, v61, v60, s66
    v_accvgpr_write_b32 a6, v22
    v_perm_b32 v23, v61, v60, s67
    v_accvgpr_write_b32 a14, v23
    v_perm_b32 v22, v63, v62, s66
    v_accvgpr_write_b32 a7, v22
    v_perm_b32 v23, v63, v62, s67
    v_accvgpr_write_b32 a15, v23
    s_add_u32 s59, s6, 0x80000
    buffer_load_dword v56, v32, s[44:47], s59 offen
    s_add_u32 s59, s6, 0x82000
    buffer_load_dword v57, v32, s[44:47], s59 offen
    s_add_u32 s59, s6, 0xa0000
    buffer_load_dword v58, v32, s[44:47], s59 offen
    s_add_u32 s59, s6, 0xa2000
    buffer_load_dword v59, v32, s[44:47], s59 offen
    s_add_u32 s59, s6, 0x88000
    buffer_load_dword v60, v32, s[44:47], s59 offen
    s_add_u32 s59, s6, 0x8a000
    buffer_load_dword v61, v32, s[44:47], s59 offen
    s_add_u32 s59, s6, 0xa8000
    buffer_load_dword v62, v32, s[44:47], s59 offen
    s_add_u32 s59, s6, 0xaa000
    buffer_load_dword v63, v32, s[44:47], s59 offen
    s_waitcnt vmcnt(56)
    v_perm_b32 v22, v65, v64, s66
    v_accvgpr_write_b32 a16, v22
    v_perm_b32 v23, v65, v64, s67
    v_accvgpr_write_b32 a24, v23
    v_perm_b32 v22, v67, v66, s66
    v_accvgpr_write_b32 a17, v22
    v_perm_b32 v23, v67, v66, s67
    v_accvgpr_write_b32 a25, v23
    v_perm_b32 v22, v69, v68, s66
    v_accvgpr_write_b32 a18, v22
    v_perm_b32 v23, v69, v68, s67
    v_accvgpr_write_b32 a26, v23
    v_perm_b32 v22, v71, v70, s66
    v_accvgpr_write_b32 a19, v22
    v_perm_b32 v23, v71, v70, s67
    v_accvgpr_write_b32 a27, v23
    s_add_u32 s59, s6, 0x4000
    buffer_load_dword v64, v32, s[44:47], s59 offen
    s_add_u32 s59, s6, 0x6000
    buffer_load_dword v65, v32, s[44:47], s59 offen
    s_add_u32 s59, s6, 0x24000
    buffer_load_dword v66, v32, s[44:47], s59 offen
    s_add_u32 s59, s6, 0x26000
    buffer_load_dword v67, v32, s[44:47], s59 offen
    s_add_u32 s59, s6, 0xc000
    buffer_load_dword v68, v32, s[44:47], s59 offen
    s_add_u32 s59, s6, 0xe000
    buffer_load_dword v69, v32, s[44:47], s59 offen
    s_add_u32 s59, s6, 0x2c000
    buffer_load_dword v70, v32, s[44:47], s59 offen
    s_add_u32 s59, s6, 0x2e000
    buffer_load_dword v71, v32, s[44:47], s59 offen
    s_waitcnt vmcnt(56)
    v_perm_b32 v22, v73, v72, s66
    v_accvgpr_write_b32 a20, v22
    v_perm_b32 v23, v73, v72, s67
    v_accvgpr_write_b32 a28, v23
    v_perm_b32 v22, v75, v74, s66
    v_accvgpr_write_b32 a21, v22
    v_perm_b32 v23, v75, v74, s67
    v_accvgpr_write_b32 a29, v23
    v_perm_b32 v22, v77, v76, s66
    v_accvgpr_write_b32 a22, v22
    v_perm_b32 v23, v77, v76, s67
    v_accvgpr_write_b32 a30, v23
    v_perm_b32 v22, v79, v78, s66
    v_accvgpr_write_b32 a23, v22
    v_perm_b32 v23, v79, v78, s67
    v_accvgpr_write_b32 a31, v23
    s_add_u32 s59, s6, 0x84000
    buffer_load_dword v72, v32, s[44:47], s59 offen
    s_add_u32 s59, s6, 0x86000
    buffer_load_dword v73, v32, s[44:47], s59 offen
    s_add_u32 s59, s6, 0xa4000
    buffer_load_dword v74, v32, s[44:47], s59 offen
    s_add_u32 s59, s6, 0xa6000
    buffer_load_dword v75, v32, s[44:47], s59 offen
    s_add_u32 s59, s6, 0x8c000
    buffer_load_dword v76, v32, s[44:47], s59 offen
    s_add_u32 s59, s6, 0x8e000
    buffer_load_dword v77, v32, s[44:47], s59 offen
    s_add_u32 s59, s6, 0xac000
    buffer_load_dword v78, v32, s[44:47], s59 offen
    s_add_u32 s59, s6, 0xae000
    buffer_load_dword v79, v32, s[44:47], s59 offen
    s_waitcnt vmcnt(56)
    v_perm_b32 v22, v81, v80, s66
    v_accvgpr_write_b32 a32, v22
    v_perm_b32 v23, v81, v80, s67
    v_accvgpr_write_b32 a40, v23
    v_perm_b32 v22, v83, v82, s66
    v_accvgpr_write_b32 a33, v22
    v_perm_b32 v23, v83, v82, s67
    v_accvgpr_write_b32 a41, v23
    v_perm_b32 v22, v85, v84, s66
    v_accvgpr_write_b32 a34, v22
    v_perm_b32 v23, v85, v84, s67
    v_accvgpr_write_b32 a42, v23
    v_perm_b32 v22, v87, v86, s66
    v_accvgpr_write_b32 a35, v22
    v_perm_b32 v23, v87, v86, s67
    v_accvgpr_write_b32 a43, v23
    s_add_u32 s59, s7, 0x0
    buffer_load_dword v80, v32, s[44:47], s59 offen
    s_add_u32 s59, s7, 0x2000
    buffer_load_dword v81, v32, s[44:47], s59 offen
    s_add_u32 s59, s7, 0x20000
    buffer_load_dword v82, v32, s[44:47], s59 offen
    s_add_u32 s59, s7, 0x22000
    buffer_load_dword v83, v32, s[44:47], s59 offen
    s_add_u32 s59, s7, 0x8000
    buffer_load_dword v84, v32, s[44:47], s59 offen
    s_add_u32 s59, s7, 0xa000
    buffer_load_dword v85, v32, s[44:47], s59 offen
    s_add_u32 s59, s7, 0x28000
    buffer_load_dword v86, v32, s[44:47], s59 offen
    s_add_u32 s59, s7, 0x2a000
    buffer_load_dword v87, v32, s[44:47], s59 offen
    s_waitcnt vmcnt(56)
    v_perm_b32 v22, v89, v88, s66
    v_accvgpr_write_b32 a36, v22
    v_perm_b32 v23, v89, v88, s67
    v_accvgpr_write_b32 a44, v23
    v_perm_b32 v22, v91, v90, s66
    v_accvgpr_write_b32 a37, v22
    v_perm_b32 v23, v91, v90, s67
    v_accvgpr_write_b32 a45, v23
    v_perm_b32 v22, v93, v92, s66
    v_accvgpr_write_b32 a38, v22
    v_perm_b32 v23, v93, v92, s67
    v_accvgpr_write_b32 a46, v23
    v_perm_b32 v22, v95, v94, s66
    v_accvgpr_write_b32 a39, v22
    v_perm_b32 v23, v95, v94, s67
    v_accvgpr_write_b32 a47, v23
    s_add_u32 s59, s7, 0x80000
    buffer_load_dword v88, v32, s[44:47], s59 offen
    s_add_u32 s59, s7, 0x82000
    buffer_load_dword v89, v32, s[44:47], s59 offen
    s_add_u32 s59, s7, 0xa0000
    buffer_load_dword v90, v32, s[44:47], s59 offen
    s_add_u32 s59, s7, 0xa2000
    buffer_load_dword v91, v32, s[44:47], s59 offen
    s_add_u32 s59, s7, 0x88000
    buffer_load_dword v92, v32, s[44:47], s59 offen
    s_add_u32 s59, s7, 0x8a000
    buffer_load_dword v93, v32, s[44:47], s59 offen
    s_add_u32 s59, s7, 0xa8000
    buffer_load_dword v94, v32, s[44:47], s59 offen
    s_add_u32 s59, s7, 0xaa000
    buffer_load_dword v95, v32, s[44:47], s59 offen
    s_waitcnt vmcnt(56)
    v_perm_b32 v22, v97, v96, s66
    v_accvgpr_write_b32 a48, v22
    v_perm_b32 v23, v97, v96, s67
    v_accvgpr_write_b32 a56, v23
    v_perm_b32 v22, v99, v98, s66
    v_accvgpr_write_b32 a49, v22
    v_perm_b32 v23, v99, v98, s67
    v_accvgpr_write_b32 a57, v23
    v_perm_b32 v22, v101, v100, s66
    v_accvgpr_write_b32 a50, v22
    v_perm_b32 v23, v101, v100, s67
    v_accvgpr_write_b32 a58, v23
    v_perm_b32 v22, v103, v102, s66
    v_accvgpr_write_b32 a51, v22
    v_perm_b32 v23, v103, v102, s67
    v_accvgpr_write_b32 a59, v23
    s_add_u32 s59, s7, 0x4000
    buffer_load_dword v96, v32, s[44:47], s59 offen
    s_add_u32 s59, s7, 0x6000
    buffer_load_dword v97, v32, s[44:47], s59 offen
    s_add_u32 s59, s7, 0x24000
    buffer_load_dword v98, v32, s[44:47], s59 offen
    s_add_u32 s59, s7, 0x26000
    buffer_load_dword v99, v32, s[44:47], s59 offen
    s_add_u32 s59, s7, 0xc000
    buffer_load_dword v100, v32, s[44:47], s59 offen
    s_add_u32 s59, s7, 0xe000
    buffer_load_dword v101, v32, s[44:47], s59 offen
    s_add_u32 s59, s7, 0x2c000
    buffer_load_dword v102, v32, s[44:47], s59 offen
    s_add_u32 s59, s7, 0x2e000
    buffer_load_dword v103, v32, s[44:47], s59 offen
    s_waitcnt vmcnt(56)
    v_perm_b32 v22, v105, v104, s66
    v_accvgpr_write_b32 a52, v22
    v_perm_b32 v23, v105, v104, s67
    v_accvgpr_write_b32 a60, v23
    v_perm_b32 v22, v107, v106, s66
    v_accvgpr_write_b32 a53, v22
    v_perm_b32 v23, v107, v106, s67
    v_accvgpr_write_b32 a61, v23
    v_perm_b32 v22, v109, v108, s66
    v_accvgpr_write_b32 a54, v22
    v_perm_b32 v23, v109, v108, s67
    v_accvgpr_write_b32 a62, v23
    v_perm_b32 v22, v111, v110, s66
    v_accvgpr_write_b32 a55, v22
    v_perm_b32 v23, v111, v110, s67
    v_accvgpr_write_b32 a63, v23
    s_add_u32 s59, s7, 0x84000
    buffer_load_dword v104, v32, s[44:47], s59 offen
    s_add_u32 s59, s7, 0x86000
    buffer_load_dword v105, v32, s[44:47], s59 offen
    s_add_u32 s59, s7, 0xa4000
    buffer_load_dword v106, v32, s[44:47], s59 offen
    s_add_u32 s59, s7, 0xa6000
    buffer_load_dword v107, v32, s[44:47], s59 offen
    s_add_u32 s59, s7, 0x8c000
    buffer_load_dword v108, v32, s[44:47], s59 offen
    s_add_u32 s59, s7, 0x8e000
    buffer_load_dword v109, v32, s[44:47], s59 offen
    s_add_u32 s59, s7, 0xac000
    buffer_load_dword v110, v32, s[44:47], s59 offen
    s_add_u32 s59, s7, 0xae000
    buffer_load_dword v111, v32, s[44:47], s59 offen
    s_waitcnt vmcnt(56)
    v_perm_b32 v22, v49, v48, s66
    v_accvgpr_write_b32 a64, v22
    v_perm_b32 v23, v49, v48, s67
    v_accvgpr_write_b32 a72, v23
    v_perm_b32 v22, v51, v50, s66
    v_accvgpr_write_b32 a65, v22
    v_perm_b32 v23, v51, v50, s67
    v_accvgpr_write_b32 a73, v23
    v_perm_b32 v22, v53, v52, s66
    v_accvgpr_write_b32 a66, v22
    v_perm_b32 v23, v53, v52, s67
    v_accvgpr_write_b32 a74, v23
    v_perm_b32 v22, v55, v54, s66
    v_accvgpr_write_b32 a67, v22
    v_perm_b32 v23, v55, v54, s67
    v_accvgpr_write_b32 a75, v23
    s_waitcnt vmcnt(48)
    v_perm_b32 v22, v57, v56, s66
    v_accvgpr_write_b32 a68, v22
    v_perm_b32 v23, v57, v56, s67
    v_accvgpr_write_b32 a76, v23
    v_perm_b32 v22, v59, v58, s66
    v_accvgpr_write_b32 a69, v22
    v_perm_b32 v23, v59, v58, s67
    v_accvgpr_write_b32 a77, v23
    v_perm_b32 v22, v61, v60, s66
    v_accvgpr_write_b32 a70, v22
    v_perm_b32 v23, v61, v60, s67
    v_accvgpr_write_b32 a78, v23
    v_perm_b32 v22, v63, v62, s66
    v_accvgpr_write_b32 a71, v22
    v_perm_b32 v23, v63, v62, s67
    v_accvgpr_write_b32 a79, v23
    s_waitcnt vmcnt(40)
    v_perm_b32 v22, v65, v64, s66
    v_accvgpr_write_b32 a80, v22
    v_perm_b32 v23, v65, v64, s67
    v_accvgpr_write_b32 a88, v23
    v_perm_b32 v22, v67, v66, s66
    v_accvgpr_write_b32 a81, v22
    v_perm_b32 v23, v67, v66, s67
    v_accvgpr_write_b32 a89, v23
    v_perm_b32 v22, v69, v68, s66
    v_accvgpr_write_b32 a82, v22
    v_perm_b32 v23, v69, v68, s67
    v_accvgpr_write_b32 a90, v23
    v_perm_b32 v22, v71, v70, s66
    v_accvgpr_write_b32 a83, v22
    v_perm_b32 v23, v71, v70, s67
    v_accvgpr_write_b32 a91, v23
    s_waitcnt vmcnt(32)
    v_perm_b32 v22, v73, v72, s66
    v_accvgpr_write_b32 a84, v22
    v_perm_b32 v23, v73, v72, s67
    v_accvgpr_write_b32 a92, v23
    v_perm_b32 v22, v75, v74, s66
    v_accvgpr_write_b32 a85, v22
    v_perm_b32 v23, v75, v74, s67
    v_accvgpr_write_b32 a93, v23
    v_perm_b32 v22, v77, v76, s66
    v_accvgpr_write_b32 a86, v22
    v_perm_b32 v23, v77, v76, s67
    v_accvgpr_write_b32 a94, v23
    v_perm_b32 v22, v79, v78, s66
    v_accvgpr_write_b32 a87, v22
    v_perm_b32 v23, v79, v78, s67
    v_accvgpr_write_b32 a95, v23
    s_waitcnt vmcnt(24)
    v_perm_b32 v22, v81, v80, s66
    v_accvgpr_write_b32 a96, v22
    v_perm_b32 v23, v81, v80, s67
    v_accvgpr_write_b32 a104, v23
    v_perm_b32 v22, v83, v82, s66
    v_accvgpr_write_b32 a97, v22
    v_perm_b32 v23, v83, v82, s67
    v_accvgpr_write_b32 a105, v23
    v_perm_b32 v22, v85, v84, s66
    v_accvgpr_write_b32 a98, v22
    v_perm_b32 v23, v85, v84, s67
    v_accvgpr_write_b32 a106, v23
    v_perm_b32 v22, v87, v86, s66
    v_accvgpr_write_b32 a99, v22
    v_perm_b32 v23, v87, v86, s67
    v_accvgpr_write_b32 a107, v23
    s_waitcnt vmcnt(16)
    v_perm_b32 v22, v89, v88, s66
    v_accvgpr_write_b32 a100, v22
    v_perm_b32 v23, v89, v88, s67
    v_accvgpr_write_b32 a108, v23
    v_perm_b32 v22, v91, v90, s66
    v_accvgpr_write_b32 a101, v22
    v_perm_b32 v23, v91, v90, s67
    v_accvgpr_write_b32 a109, v23
    v_perm_b32 v22, v93, v92, s66
    v_accvgpr_write_b32 a102, v22
    v_perm_b32 v23, v93, v92, s67
    v_accvgpr_write_b32 a110, v23
    v_perm_b32 v22, v95, v94, s66
    v_accvgpr_write_b32 a103, v22
    v_perm_b32 v23, v95, v94, s67
    v_accvgpr_write_b32 a111, v23
    s_waitcnt vmcnt(8)
    v_perm_b32 v22, v97, v96, s66
    v_accvgpr_write_b32 a112, v22
    v_perm_b32 v23, v97, v96, s67
    v_accvgpr_write_b32 a120, v23
    v_perm_b32 v22, v99, v98, s66
    v_accvgpr_write_b32 a113, v22
    v_perm_b32 v23, v99, v98, s67
    v_accvgpr_write_b32 a121, v23
    v_perm_b32 v22, v101, v100, s66
    v_accvgpr_write_b32 a114, v22
    v_perm_b32 v23, v101, v100, s67
    v_accvgpr_write_b32 a122, v23
    v_perm_b32 v22, v103, v102, s66
    v_accvgpr_write_b32 a115, v22
    v_perm_b32 v23, v103, v102, s67
    v_accvgpr_write_b32 a123, v23
    s_waitcnt vmcnt(0)
    v_perm_b32 v22, v105, v104, s66
    v_accvgpr_write_b32 a116, v22
    v_perm_b32 v23, v105, v104, s67
    v_accvgpr_write_b32 a124, v23
    v_perm_b32 v22, v107, v106, s66
    v_accvgpr_write_b32 a117, v22
    v_perm_b32 v23, v107, v106, s67
    v_accvgpr_write_b32 a125, v23
    v_perm_b32 v22, v109, v108, s66
    v_accvgpr_write_b32 a118, v22
    v_perm_b32 v23, v109, v108, s67
    v_accvgpr_write_b32 a126, v23
    v_perm_b32 v22, v111, v110, s66
    v_accvgpr_write_b32 a119, v22
    v_perm_b32 v23, v111, v110, s67
    v_accvgpr_write_b32 a127, v23
    ds_write_b128 v2, a[128:131] offset:16384
    ds_write_b128 v2, a[132:135] offset:17408
    ds_write_b128 v2, a[192:195] offset:0
    ds_write_b128 v2, a[196:199] offset:1024
    s_waitcnt lgkmcnt(0)
    ds_write_b128 v2, a[136:139] offset:18432
    ds_write_b128 v2, a[140:143] offset:19456
    ds_write_b128 v2, a[200:203] offset:2048
    ds_write_b128 v2, a[204:207] offset:3072
    s_waitcnt lgkmcnt(0)
    ds_write_b128 v2, a[144:147] offset:20480
    ds_write_b128 v2, a[148:151] offset:21504
    ds_write_b128 v2, a[208:211] offset:4096
    ds_write_b128 v2, a[212:215] offset:5120
    s_waitcnt lgkmcnt(0)
    ds_write_b128 v2, a[152:155] offset:22528
    ds_write_b128 v2, a[156:159] offset:23552
    ds_write_b128 v2, a[216:219] offset:6144
    ds_write_b128 v2, a[220:223] offset:7168
    s_waitcnt lgkmcnt(0)
    ds_write_b128 v2, a[160:163] offset:24576
    ds_write_b128 v2, a[164:167] offset:25600
    ds_write_b128 v2, a[224:227] offset:8192
    ds_write_b128 v2, a[228:231] offset:9216
    s_waitcnt lgkmcnt(0)
    ds_write_b128 v2, a[168:171] offset:26624
    ds_write_b128 v2, a[172:175] offset:27648
    ds_write_b128 v2, a[232:235] offset:10240
    ds_write_b128 v2, a[236:239] offset:11264
    s_waitcnt lgkmcnt(0)
    ds_write_b128 v2, a[176:179] offset:28672
    ds_write_b128 v2, a[180:183] offset:29696
    ds_write_b128 v2, a[240:243] offset:12288
    ds_write_b128 v2, a[244:247] offset:13312
    s_waitcnt lgkmcnt(0)
    ds_write_b128 v2, a[184:187] offset:30720
    ds_write_b128 v2, a[188:191] offset:31744
    ds_write_b128 v2, a[248:251] offset:14336
    ds_write_b128 v2, a[252:255] offset:15360
    s_waitcnt lgkmcnt(0)
    v_mov_b32 v24, 0
    s_nop 1
Lrdy_11:
    global_load_dword v25, v24, s[32:33] offset:4 sc1
    s_waitcnt vmcnt(0)
    v_cmp_ne_u32 vcc, 0, v25
    s_nop 0
    s_cmp_eq_u64 vcc, exec
    s_nop 1
    s_cbranch_scc0 Lrdy_11
    s_barrier
    s_lshl_b32 s59, s56, 7
    s_add_u32 s59, s59, 0x626000
    v_mov_b32 v24, 1
    s_mov_b64 exec, s[88:89]
    buffer_store_dword v24, off, s[36:39], s59 sc1
    s_mov_b64 exec, -1
    s_add_u32 s59, s4, 0x0
    buffer_load_dword v48, v32, s[48:51], s59 offen
    s_add_u32 s59, s4, 0x2000
    buffer_load_dword v49, v32, s[48:51], s59 offen
    s_add_u32 s59, s4, 0x20000
    buffer_load_dword v50, v32, s[48:51], s59 offen
    s_add_u32 s59, s4, 0x22000
    buffer_load_dword v51, v32, s[48:51], s59 offen
    s_add_u32 s59, s4, 0x8000
    buffer_load_dword v52, v32, s[48:51], s59 offen
    s_add_u32 s59, s4, 0xa000
    buffer_load_dword v53, v32, s[48:51], s59 offen
    s_add_u32 s59, s4, 0x28000
    buffer_load_dword v54, v32, s[48:51], s59 offen
    s_add_u32 s59, s4, 0x2a000
    buffer_load_dword v55, v32, s[48:51], s59 offen
    s_add_u32 s59, s4, 0x80000
    buffer_load_dword v56, v32, s[48:51], s59 offen
    s_add_u32 s59, s4, 0x82000
    buffer_load_dword v57, v32, s[48:51], s59 offen
    s_add_u32 s59, s4, 0xa0000
    buffer_load_dword v58, v32, s[48:51], s59 offen
    s_add_u32 s59, s4, 0xa2000
    buffer_load_dword v59, v32, s[48:51], s59 offen
    s_add_u32 s59, s4, 0x88000
    buffer_load_dword v60, v32, s[48:51], s59 offen
    s_add_u32 s59, s4, 0x8a000
    buffer_load_dword v61, v32, s[48:51], s59 offen
    s_add_u32 s59, s4, 0xa8000
    buffer_load_dword v62, v32, s[48:51], s59 offen
    s_add_u32 s59, s4, 0xaa000
    buffer_load_dword v63, v32, s[48:51], s59 offen
    s_add_u32 s59, s4, 0x4000
    buffer_load_dword v64, v32, s[48:51], s59 offen
    s_add_u32 s59, s4, 0x6000
    buffer_load_dword v65, v32, s[48:51], s59 offen
    s_add_u32 s59, s4, 0x24000
    buffer_load_dword v66, v32, s[48:51], s59 offen
    s_add_u32 s59, s4, 0x26000
    buffer_load_dword v67, v32, s[48:51], s59 offen
    s_add_u32 s59, s4, 0xc000
    buffer_load_dword v68, v32, s[48:51], s59 offen
    s_add_u32 s59, s4, 0xe000
    buffer_load_dword v69, v32, s[48:51], s59 offen
    s_add_u32 s59, s4, 0x2c000
    buffer_load_dword v70, v32, s[48:51], s59 offen
    s_add_u32 s59, s4, 0x2e000
    buffer_load_dword v71, v32, s[48:51], s59 offen
    s_add_u32 s59, s4, 0x84000
    buffer_load_dword v72, v32, s[48:51], s59 offen
    s_add_u32 s59, s4, 0x86000
    buffer_load_dword v73, v32, s[48:51], s59 offen
    s_add_u32 s59, s4, 0xa4000
    buffer_load_dword v74, v32, s[48:51], s59 offen
    s_add_u32 s59, s4, 0xa6000
    buffer_load_dword v75, v32, s[48:51], s59 offen
    s_add_u32 s59, s4, 0x8c000
    buffer_load_dword v76, v32, s[48:51], s59 offen
    s_add_u32 s59, s4, 0x8e000
    buffer_load_dword v77, v32, s[48:51], s59 offen
    s_add_u32 s59, s4, 0xac000
    buffer_load_dword v78, v32, s[48:51], s59 offen
    s_add_u32 s59, s4, 0xae000
    buffer_load_dword v79, v32, s[48:51], s59 offen
    s_add_u32 s59, s5, 0x0
    buffer_load_dword v80, v32, s[48:51], s59 offen
    s_add_u32 s59, s5, 0x2000
    buffer_load_dword v81, v32, s[48:51], s59 offen
    s_add_u32 s59, s5, 0x20000
    buffer_load_dword v82, v32, s[48:51], s59 offen
    s_add_u32 s59, s5, 0x22000
    buffer_load_dword v83, v32, s[48:51], s59 offen
    s_add_u32 s59, s5, 0x8000
    buffer_load_dword v84, v32, s[48:51], s59 offen
    s_add_u32 s59, s5, 0xa000
    buffer_load_dword v85, v32, s[48:51], s59 offen
    s_add_u32 s59, s5, 0x28000
    buffer_load_dword v86, v32, s[48:51], s59 offen
    s_add_u32 s59, s5, 0x2a000
    buffer_load_dword v87, v32, s[48:51], s59 offen
    s_add_u32 s59, s5, 0x80000
    buffer_load_dword v88, v32, s[48:51], s59 offen
    s_add_u32 s59, s5, 0x82000
    buffer_load_dword v89, v32, s[48:51], s59 offen
    s_add_u32 s59, s5, 0xa0000
    buffer_load_dword v90, v32, s[48:51], s59 offen
    s_add_u32 s59, s5, 0xa2000
    buffer_load_dword v91, v32, s[48:51], s59 offen
    s_add_u32 s59, s5, 0x88000
    buffer_load_dword v92, v32, s[48:51], s59 offen
    s_add_u32 s59, s5, 0x8a000
    buffer_load_dword v93, v32, s[48:51], s59 offen
    s_add_u32 s59, s5, 0xa8000
    buffer_load_dword v94, v32, s[48:51], s59 offen
    s_add_u32 s59, s5, 0xaa000
    buffer_load_dword v95, v32, s[48:51], s59 offen
    s_add_u32 s59, s5, 0x4000
    buffer_load_dword v96, v32, s[48:51], s59 offen
    s_add_u32 s59, s5, 0x6000
    buffer_load_dword v97, v32, s[48:51], s59 offen
    s_add_u32 s59, s5, 0x24000
    buffer_load_dword v98, v32, s[48:51], s59 offen
    s_add_u32 s59, s5, 0x26000
    buffer_load_dword v99, v32, s[48:51], s59 offen
    s_add_u32 s59, s5, 0xc000
    buffer_load_dword v100, v32, s[48:51], s59 offen
    s_add_u32 s59, s5, 0xe000
    buffer_load_dword v101, v32, s[48:51], s59 offen
    s_add_u32 s59, s5, 0x2c000
    buffer_load_dword v102, v32, s[48:51], s59 offen
    s_add_u32 s59, s5, 0x2e000
    buffer_load_dword v103, v32, s[48:51], s59 offen
    s_add_u32 s59, s5, 0x84000
    buffer_load_dword v104, v32, s[48:51], s59 offen
    s_add_u32 s59, s5, 0x86000
    buffer_load_dword v105, v32, s[48:51], s59 offen
    s_add_u32 s59, s5, 0xa4000
    buffer_load_dword v106, v32, s[48:51], s59 offen
    s_add_u32 s59, s5, 0xa6000
    buffer_load_dword v107, v32, s[48:51], s59 offen
    s_add_u32 s59, s5, 0x8c000
    buffer_load_dword v108, v32, s[48:51], s59 offen
    s_add_u32 s59, s5, 0x8e000
    buffer_load_dword v109, v32, s[48:51], s59 offen
    s_add_u32 s59, s5, 0xac000
    buffer_load_dword v110, v32, s[48:51], s59 offen
    s_add_u32 s59, s5, 0xae000
    buffer_load_dword v111, v32, s[48:51], s59 offen
    s_waitcnt vmcnt(56)
    v_perm_b32 v22, v49, v48, s66
    v_accvgpr_write_b32 a128, v22
    v_perm_b32 v23, v49, v48, s67
    v_accvgpr_write_b32 a136, v23
    v_perm_b32 v22, v51, v50, s66
    v_accvgpr_write_b32 a129, v22
    v_perm_b32 v23, v51, v50, s67
    v_accvgpr_write_b32 a137, v23
    v_perm_b32 v22, v53, v52, s66
    v_accvgpr_write_b32 a130, v22
    v_perm_b32 v23, v53, v52, s67
    v_accvgpr_write_b32 a138, v23
    v_perm_b32 v22, v55, v54, s66
    v_accvgpr_write_b32 a131, v22
    v_perm_b32 v23, v55, v54, s67
    v_accvgpr_write_b32 a139, v23
    s_add_u32 s59, s6, 0x0
    buffer_load_dword v48, v32, s[48:51], s59 offen
    s_add_u32 s59, s6, 0x2000
    buffer_load_dword v49, v32, s[48:51], s59 offen
    s_add_u32 s59, s6, 0x20000
    buffer_load_dword v50, v32, s[48:51], s59 offen
    s_add_u32 s59, s6, 0x22000
    buffer_load_dword v51, v32, s[48:51], s59 offen
    s_add_u32 s59, s6, 0x8000
    buffer_load_dword v52, v32, s[48:51], s59 offen
    s_add_u32 s59, s6, 0xa000
    buffer_load_dword v53, v32, s[48:51], s59 offen
    s_add_u32 s59, s6, 0x28000
    buffer_load_dword v54, v32, s[48:51], s59 offen
    s_add_u32 s59, s6, 0x2a000
    buffer_load_dword v55, v32, s[48:51], s59 offen
    s_waitcnt vmcnt(56)
    v_perm_b32 v22, v57, v56, s66
    v_accvgpr_write_b32 a132, v22
    v_perm_b32 v23, v57, v56, s67
    v_accvgpr_write_b32 a140, v23
    v_perm_b32 v22, v59, v58, s66
    v_accvgpr_write_b32 a133, v22
    v_perm_b32 v23, v59, v58, s67
    v_accvgpr_write_b32 a141, v23
    v_perm_b32 v22, v61, v60, s66
    v_accvgpr_write_b32 a134, v22
    v_perm_b32 v23, v61, v60, s67
    v_accvgpr_write_b32 a142, v23
    v_perm_b32 v22, v63, v62, s66
    v_accvgpr_write_b32 a135, v22
    v_perm_b32 v23, v63, v62, s67
    v_accvgpr_write_b32 a143, v23
    s_add_u32 s59, s6, 0x80000
    buffer_load_dword v56, v32, s[48:51], s59 offen
    s_add_u32 s59, s6, 0x82000
    buffer_load_dword v57, v32, s[48:51], s59 offen
    s_add_u32 s59, s6, 0xa0000
    buffer_load_dword v58, v32, s[48:51], s59 offen
    s_add_u32 s59, s6, 0xa2000
    buffer_load_dword v59, v32, s[48:51], s59 offen
    s_add_u32 s59, s6, 0x88000
    buffer_load_dword v60, v32, s[48:51], s59 offen
    s_add_u32 s59, s6, 0x8a000
    buffer_load_dword v61, v32, s[48:51], s59 offen
    s_add_u32 s59, s6, 0xa8000
    buffer_load_dword v62, v32, s[48:51], s59 offen
    s_add_u32 s59, s6, 0xaa000
    buffer_load_dword v63, v32, s[48:51], s59 offen
    s_waitcnt vmcnt(56)
    v_perm_b32 v22, v65, v64, s66
    v_accvgpr_write_b32 a144, v22
    v_perm_b32 v23, v65, v64, s67
    v_accvgpr_write_b32 a152, v23
    v_perm_b32 v22, v67, v66, s66
    v_accvgpr_write_b32 a145, v22
    v_perm_b32 v23, v67, v66, s67
    v_accvgpr_write_b32 a153, v23
    v_perm_b32 v22, v69, v68, s66
    v_accvgpr_write_b32 a146, v22
    v_perm_b32 v23, v69, v68, s67
    v_accvgpr_write_b32 a154, v23
    v_perm_b32 v22, v71, v70, s66
    v_accvgpr_write_b32 a147, v22
    v_perm_b32 v23, v71, v70, s67
    v_accvgpr_write_b32 a155, v23
    s_add_u32 s59, s6, 0x4000
    buffer_load_dword v64, v32, s[48:51], s59 offen
    s_add_u32 s59, s6, 0x6000
    buffer_load_dword v65, v32, s[48:51], s59 offen
    s_add_u32 s59, s6, 0x24000
    buffer_load_dword v66, v32, s[48:51], s59 offen
    s_add_u32 s59, s6, 0x26000
    buffer_load_dword v67, v32, s[48:51], s59 offen
    s_add_u32 s59, s6, 0xc000
    buffer_load_dword v68, v32, s[48:51], s59 offen
    s_add_u32 s59, s6, 0xe000
    buffer_load_dword v69, v32, s[48:51], s59 offen
    s_add_u32 s59, s6, 0x2c000
    buffer_load_dword v70, v32, s[48:51], s59 offen
    s_add_u32 s59, s6, 0x2e000
    buffer_load_dword v71, v32, s[48:51], s59 offen
    s_waitcnt vmcnt(56)
    v_perm_b32 v22, v73, v72, s66
    v_accvgpr_write_b32 a148, v22
    v_perm_b32 v23, v73, v72, s67
    v_accvgpr_write_b32 a156, v23
    v_perm_b32 v22, v75, v74, s66
    v_accvgpr_write_b32 a149, v22
    v_perm_b32 v23, v75, v74, s67
    v_accvgpr_write_b32 a157, v23
    v_perm_b32 v22, v77, v76, s66
    v_accvgpr_write_b32 a150, v22
    v_perm_b32 v23, v77, v76, s67
    v_accvgpr_write_b32 a158, v23
    v_perm_b32 v22, v79, v78, s66
    v_accvgpr_write_b32 a151, v22
    v_perm_b32 v23, v79, v78, s67
    v_accvgpr_write_b32 a159, v23
    s_add_u32 s59, s6, 0x84000
    buffer_load_dword v72, v32, s[48:51], s59 offen
    s_add_u32 s59, s6, 0x86000
    buffer_load_dword v73, v32, s[48:51], s59 offen
    s_add_u32 s59, s6, 0xa4000
    buffer_load_dword v74, v32, s[48:51], s59 offen
    s_add_u32 s59, s6, 0xa6000
    buffer_load_dword v75, v32, s[48:51], s59 offen
    s_add_u32 s59, s6, 0x8c000
    buffer_load_dword v76, v32, s[48:51], s59 offen
    s_add_u32 s59, s6, 0x8e000
    buffer_load_dword v77, v32, s[48:51], s59 offen
    s_add_u32 s59, s6, 0xac000
    buffer_load_dword v78, v32, s[48:51], s59 offen
    s_add_u32 s59, s6, 0xae000
    buffer_load_dword v79, v32, s[48:51], s59 offen
    s_waitcnt vmcnt(56)
    v_perm_b32 v22, v81, v80, s66
    v_accvgpr_write_b32 a160, v22
    v_perm_b32 v23, v81, v80, s67
    v_accvgpr_write_b32 a168, v23
    v_perm_b32 v22, v83, v82, s66
    v_accvgpr_write_b32 a161, v22
    v_perm_b32 v23, v83, v82, s67
    v_accvgpr_write_b32 a169, v23
    v_perm_b32 v22, v85, v84, s66
    v_accvgpr_write_b32 a162, v22
    v_perm_b32 v23, v85, v84, s67
    v_accvgpr_write_b32 a170, v23
    v_perm_b32 v22, v87, v86, s66
    v_accvgpr_write_b32 a163, v22
    v_perm_b32 v23, v87, v86, s67
    v_accvgpr_write_b32 a171, v23
    s_add_u32 s59, s7, 0x0
    buffer_load_dword v80, v32, s[48:51], s59 offen
    s_add_u32 s59, s7, 0x2000
    buffer_load_dword v81, v32, s[48:51], s59 offen
    s_add_u32 s59, s7, 0x20000
    buffer_load_dword v82, v32, s[48:51], s59 offen
    s_add_u32 s59, s7, 0x22000
    buffer_load_dword v83, v32, s[48:51], s59 offen
    s_add_u32 s59, s7, 0x8000
    buffer_load_dword v84, v32, s[48:51], s59 offen
    s_add_u32 s59, s7, 0xa000
    buffer_load_dword v85, v32, s[48:51], s59 offen
    s_add_u32 s59, s7, 0x28000
    buffer_load_dword v86, v32, s[48:51], s59 offen
    s_add_u32 s59, s7, 0x2a000
    buffer_load_dword v87, v32, s[48:51], s59 offen
    s_waitcnt vmcnt(56)
    v_perm_b32 v22, v89, v88, s66
    v_accvgpr_write_b32 a164, v22
    v_perm_b32 v23, v89, v88, s67
    v_accvgpr_write_b32 a172, v23
    v_perm_b32 v22, v91, v90, s66
    v_accvgpr_write_b32 a165, v22
    v_perm_b32 v23, v91, v90, s67
    v_accvgpr_write_b32 a173, v23
    v_perm_b32 v22, v93, v92, s66
    v_accvgpr_write_b32 a166, v22
    v_perm_b32 v23, v93, v92, s67
    v_accvgpr_write_b32 a174, v23
    v_perm_b32 v22, v95, v94, s66
    v_accvgpr_write_b32 a167, v22
    v_perm_b32 v23, v95, v94, s67
    v_accvgpr_write_b32 a175, v23
    s_add_u32 s59, s7, 0x80000
    buffer_load_dword v88, v32, s[48:51], s59 offen
    s_add_u32 s59, s7, 0x82000
    buffer_load_dword v89, v32, s[48:51], s59 offen
    s_add_u32 s59, s7, 0xa0000
    buffer_load_dword v90, v32, s[48:51], s59 offen
    s_add_u32 s59, s7, 0xa2000
    buffer_load_dword v91, v32, s[48:51], s59 offen
    s_add_u32 s59, s7, 0x88000
    buffer_load_dword v92, v32, s[48:51], s59 offen
    s_add_u32 s59, s7, 0x8a000
    buffer_load_dword v93, v32, s[48:51], s59 offen
    s_add_u32 s59, s7, 0xa8000
    buffer_load_dword v94, v32, s[48:51], s59 offen
    s_add_u32 s59, s7, 0xaa000
    buffer_load_dword v95, v32, s[48:51], s59 offen
    s_waitcnt vmcnt(56)
    v_perm_b32 v22, v97, v96, s66
    v_accvgpr_write_b32 a176, v22
    v_perm_b32 v23, v97, v96, s67
    v_accvgpr_write_b32 a184, v23
    v_perm_b32 v22, v99, v98, s66
    v_accvgpr_write_b32 a177, v22
    v_perm_b32 v23, v99, v98, s67
    v_accvgpr_write_b32 a185, v23
    v_perm_b32 v22, v101, v100, s66
    v_accvgpr_write_b32 a178, v22
    v_perm_b32 v23, v101, v100, s67
    v_accvgpr_write_b32 a186, v23
    v_perm_b32 v22, v103, v102, s66
    v_accvgpr_write_b32 a179, v22
    v_perm_b32 v23, v103, v102, s67
    v_accvgpr_write_b32 a187, v23
    s_add_u32 s59, s7, 0x4000
    buffer_load_dword v96, v32, s[48:51], s59 offen
    s_add_u32 s59, s7, 0x6000
    buffer_load_dword v97, v32, s[48:51], s59 offen
    s_add_u32 s59, s7, 0x24000
    buffer_load_dword v98, v32, s[48:51], s59 offen
    s_add_u32 s59, s7, 0x26000
    buffer_load_dword v99, v32, s[48:51], s59 offen
    s_add_u32 s59, s7, 0xc000
    buffer_load_dword v100, v32, s[48:51], s59 offen
    s_add_u32 s59, s7, 0xe000
    buffer_load_dword v101, v32, s[48:51], s59 offen
    s_add_u32 s59, s7, 0x2c000
    buffer_load_dword v102, v32, s[48:51], s59 offen
    s_add_u32 s59, s7, 0x2e000
    buffer_load_dword v103, v32, s[48:51], s59 offen
    s_waitcnt vmcnt(56)
    v_perm_b32 v22, v105, v104, s66
    v_accvgpr_write_b32 a180, v22
    v_perm_b32 v23, v105, v104, s67
    v_accvgpr_write_b32 a188, v23
    v_perm_b32 v22, v107, v106, s66
    v_accvgpr_write_b32 a181, v22
    v_perm_b32 v23, v107, v106, s67
    v_accvgpr_write_b32 a189, v23
    v_perm_b32 v22, v109, v108, s66
    v_accvgpr_write_b32 a182, v22
    v_perm_b32 v23, v109, v108, s67
    v_accvgpr_write_b32 a190, v23
    v_perm_b32 v22, v111, v110, s66
    v_accvgpr_write_b32 a183, v22
    v_perm_b32 v23, v111, v110, s67
    v_accvgpr_write_b32 a191, v23
    s_add_u32 s59, s7, 0x84000
    buffer_load_dword v104, v32, s[48:51], s59 offen
    s_add_u32 s59, s7, 0x86000
    buffer_load_dword v105, v32, s[48:51], s59 offen
    s_add_u32 s59, s7, 0xa4000
    buffer_load_dword v106, v32, s[48:51], s59 offen
    s_add_u32 s59, s7, 0xa6000
    buffer_load_dword v107, v32, s[48:51], s59 offen
    s_add_u32 s59, s7, 0x8c000
    buffer_load_dword v108, v32, s[48:51], s59 offen
    s_add_u32 s59, s7, 0x8e000
    buffer_load_dword v109, v32, s[48:51], s59 offen
    s_add_u32 s59, s7, 0xac000
    buffer_load_dword v110, v32, s[48:51], s59 offen
    s_add_u32 s59, s7, 0xae000
    buffer_load_dword v111, v32, s[48:51], s59 offen
    s_waitcnt vmcnt(56)
    v_perm_b32 v22, v49, v48, s66
    v_accvgpr_write_b32 a192, v22
    v_perm_b32 v23, v49, v48, s67
    v_accvgpr_write_b32 a200, v23
    v_perm_b32 v22, v51, v50, s66
    v_accvgpr_write_b32 a193, v22
    v_perm_b32 v23, v51, v50, s67
    v_accvgpr_write_b32 a201, v23
    v_perm_b32 v22, v53, v52, s66
    v_accvgpr_write_b32 a194, v22
    v_perm_b32 v23, v53, v52, s67
    v_accvgpr_write_b32 a202, v23
    v_perm_b32 v22, v55, v54, s66
    v_accvgpr_write_b32 a195, v22
    v_perm_b32 v23, v55, v54, s67
    v_accvgpr_write_b32 a203, v23
    s_waitcnt vmcnt(48)
    v_perm_b32 v22, v57, v56, s66
    v_accvgpr_write_b32 a196, v22
    v_perm_b32 v23, v57, v56, s67
    v_accvgpr_write_b32 a204, v23
    v_perm_b32 v22, v59, v58, s66
    v_accvgpr_write_b32 a197, v22
    v_perm_b32 v23, v59, v58, s67
    v_accvgpr_write_b32 a205, v23
    v_perm_b32 v22, v61, v60, s66
    v_accvgpr_write_b32 a198, v22
    v_perm_b32 v23, v61, v60, s67
    v_accvgpr_write_b32 a206, v23
    v_perm_b32 v22, v63, v62, s66
    v_accvgpr_write_b32 a199, v22
    v_perm_b32 v23, v63, v62, s67
    v_accvgpr_write_b32 a207, v23
    s_waitcnt vmcnt(40)
    v_perm_b32 v22, v65, v64, s66
    v_accvgpr_write_b32 a208, v22
    v_perm_b32 v23, v65, v64, s67
    v_accvgpr_write_b32 a216, v23
    v_perm_b32 v22, v67, v66, s66
    v_accvgpr_write_b32 a209, v22
    v_perm_b32 v23, v67, v66, s67
    v_accvgpr_write_b32 a217, v23
    v_perm_b32 v22, v69, v68, s66
    v_accvgpr_write_b32 a210, v22
    v_perm_b32 v23, v69, v68, s67
    v_accvgpr_write_b32 a218, v23
    v_perm_b32 v22, v71, v70, s66
    v_accvgpr_write_b32 a211, v22
    v_perm_b32 v23, v71, v70, s67
    v_accvgpr_write_b32 a219, v23
    s_waitcnt vmcnt(32)
    v_perm_b32 v22, v73, v72, s66
    v_accvgpr_write_b32 a212, v22
    v_perm_b32 v23, v73, v72, s67
    v_accvgpr_write_b32 a220, v23
    v_perm_b32 v22, v75, v74, s66
    v_accvgpr_write_b32 a213, v22
    v_perm_b32 v23, v75, v74, s67
    v_accvgpr_write_b32 a221, v23
    v_perm_b32 v22, v77, v76, s66
    v_accvgpr_write_b32 a214, v22
    v_perm_b32 v23, v77, v76, s67
    v_accvgpr_write_b32 a222, v23
    v_perm_b32 v22, v79, v78, s66
    v_accvgpr_write_b32 a215, v22
    v_perm_b32 v23, v79, v78, s67
    v_accvgpr_write_b32 a223, v23
    s_waitcnt vmcnt(24)
    v_perm_b32 v22, v81, v80, s66
    v_accvgpr_write_b32 a224, v22
    v_perm_b32 v23, v81, v80, s67
    v_accvgpr_write_b32 a232, v23
    v_perm_b32 v22, v83, v82, s66
    v_accvgpr_write_b32 a225, v22
    v_perm_b32 v23, v83, v82, s67
    v_accvgpr_write_b32 a233, v23
    v_perm_b32 v22, v85, v84, s66
    v_accvgpr_write_b32 a226, v22
    v_perm_b32 v23, v85, v84, s67
    v_accvgpr_write_b32 a234, v23
    v_perm_b32 v22, v87, v86, s66
    v_accvgpr_write_b32 a227, v22
    v_perm_b32 v23, v87, v86, s67
    v_accvgpr_write_b32 a235, v23
    s_waitcnt vmcnt(16)
    v_perm_b32 v22, v89, v88, s66
    v_accvgpr_write_b32 a228, v22
    v_perm_b32 v23, v89, v88, s67
    v_accvgpr_write_b32 a236, v23
    v_perm_b32 v22, v91, v90, s66
    v_accvgpr_write_b32 a229, v22
    v_perm_b32 v23, v91, v90, s67
    v_accvgpr_write_b32 a237, v23
    v_perm_b32 v22, v93, v92, s66
    v_accvgpr_write_b32 a230, v22
    v_perm_b32 v23, v93, v92, s67
    v_accvgpr_write_b32 a238, v23
    v_perm_b32 v22, v95, v94, s66
    v_accvgpr_write_b32 a231, v22
    v_perm_b32 v23, v95, v94, s67
    v_accvgpr_write_b32 a239, v23
    s_waitcnt vmcnt(8)
    v_perm_b32 v22, v97, v96, s66
    v_accvgpr_write_b32 a240, v22
    v_perm_b32 v23, v97, v96, s67
    v_accvgpr_write_b32 a248, v23
    v_perm_b32 v22, v99, v98, s66
    v_accvgpr_write_b32 a241, v22
    v_perm_b32 v23, v99, v98, s67
    v_accvgpr_write_b32 a249, v23
    v_perm_b32 v22, v101, v100, s66
    v_accvgpr_write_b32 a242, v22
    v_perm_b32 v23, v101, v100, s67
    v_accvgpr_write_b32 a250, v23
    v_perm_b32 v22, v103, v102, s66
    v_accvgpr_write_b32 a243, v22
    v_perm_b32 v23, v103, v102, s67
    v_accvgpr_write_b32 a251, v23
    s_waitcnt vmcnt(0)
    v_perm_b32 v22, v105, v104, s66
    v_accvgpr_write_b32 a244, v22
    v_perm_b32 v23, v105, v104, s67
    v_accvgpr_write_b32 a252, v23
    v_perm_b32 v22, v107, v106, s66
    v_accvgpr_write_b32 a245, v22
    v_perm_b32 v23, v107, v106, s67
    v_accvgpr_write_b32 a253, v23
    v_perm_b32 v22, v109, v108, s66
    v_accvgpr_write_b32 a246, v22
    v_perm_b32 v23, v109, v108, s67
    v_accvgpr_write_b32 a254, v23
    v_perm_b32 v22, v111, v110, s66
    v_accvgpr_write_b32 a247, v22
    v_perm_b32 v23, v111, v110, s67
    v_accvgpr_write_b32 a255, v23
    v_and_b32 v24, 31, v34
    v_lshlrev_b32 v24, 7, v24
    v_add_u32 v24, 0x626000, v24
    s_mov_b32 s61, 1
    s_nop 0
Lw_12:
    buffer_load_dword v25, v24, s[36:39], 0 offen sc1
    s_waitcnt vmcnt(0)
    v_cmp_le_u32 vcc, s61, v25
    s_nop 0
    s_cmp_eq_u64 vcc, exec
    s_nop 1
    s_cbranch_scc1 Lwd_13
    s_sleep 1
    s_branch Lw_12
Lwd_13:
    s_mov_b32 s40, s12
    s_and_b32 s41, s13, 0xffff
    s_mov_b32 s42, 0x2000
    s_mov_b32 s43, 0x20000
    s_mov_b32 s58, 0
    v_and_b32 v15, 7, v34
    v_lshlrev_b32 v15, 10, v15
    v_lshrrev_b32 v20, 3, v34
    v_lshl_add_u32 v15, v20, 5, v15
    s_lshl_b32 s59, s57, 8
    buffer_load_dword v16, v15, s[40:43], s59 offen offset:0
    buffer_load_dword v17, v15, s[40:43], s59 offen offset:8
    buffer_load_dword v18, v15, s[40:43], s59 offen offset:16
    buffer_load_dword v19, v15, s[40:43], s59 offen offset:24
    buffer_load_dword v20, v15, s[40:43], s59 offen offset:4
    buffer_load_dword v21, v15, s[40:43], s59 offen offset:12
    buffer_load_dword v22, v15, s[40:43], s59 offen offset:20
    buffer_load_dword v23, v15, s[40:43], s59 offen offset:28
    s_waitcnt vmcnt(0)
    v_min_u32 v16, -2, v16
    v_min_u32 v17, -2, v17
    v_min_u32 v18, -2, v18
    v_min_u32 v19, -2, v19
    v_min_u32 v20, -2, v20
    v_min_u32 v21, -2, v21
    v_min_u32 v22, -2, v22
    v_min_u32 v23, -2, v23
    ds_write_b128 v14, v[16:19] offset:0
    ds_write_b128 v14, v[20:23] offset:1024
    s_waitcnt lgkmcnt(0)
    s_add_u32 s65, s80, 8192
    s_add_u32 s71, s79, 0x1000000
    s_cmp_gt_u32 s77, s58
    s_cbranch_scc0 CHkvp_15
CHkvok_14:
    s_mov_b32 m0, s80
    s_nop 0
    buffer_load_dwordx4 v1, s[36:39], s79 offen offset:0 sc1 lds
    buffer_load_dwordx4 v1, s[36:39], s79 offen offset:1024 sc1 lds
    s_mov_b32 m0, s65
    s_nop 0
    buffer_load_dwordx4 v1, s[36:39], s71 offen offset:0 sc1 lds
    buffer_load_dwordx4 v1, s[36:39], s71 offen offset:1024 sc1 lds
    s_mov_b32 s72, 0x700000
    s_mov_b32 s73, 0x701000
    ds_read_b128 v[48:51], v2 offset:0
    ds_read_b128 v[52:55], v2 offset:1024
    v_mov_b64 v[112:113], 0
    ds_read_b128 v[56:59], v2 offset:2048
    ds_read_b128 v[60:63], v2 offset:3072
    v_mov_b64 v[114:115], 0
    ds_read_b128 v[64:67], v2 offset:4096
    ds_read_b128 v[68:71], v2 offset:5120
    v_mov_b64 v[116:117], 0
    ds_read_b128 v[72:75], v2 offset:6144
    ds_read_b128 v[76:79], v2 offset:7168
    v_mov_b64 v[118:119], 0
    ds_read_b128 v[80:83], v2 offset:8192
    ds_read_b128 v[84:87], v2 offset:9216
    v_mov_b64 v[120:121], 0
    ds_read_b128 v[88:91], v2 offset:10240
    ds_read_b128 v[92:95], v2 offset:11264
    v_mov_b64 v[122:123], 0
    ds_read_b128 v[96:99], v2 offset:12288
    ds_read_b128 v[100:103], v2 offset:13312
    v_mov_b64 v[124:125], 0
    ds_read_b128 v[104:107], v2 offset:14336
    ds_read_b128 v[108:111], v2 offset:15360
    v_mov_b64 v[126:127], 0
    s_and_b32 s59, s58, 3
    s_lshl_b32 s74, s59, 13
    s_add_u32 s74, s74, 0x6f8000
    s_and_b32 s16, s58, 1
    s_min_u32 s76, s77, 63
    s_and_b32 s76, s76, 48
    s_lshl_b32 s76, s76, 8
    s_add_u32 s76, s76, s20
    s_add_u32 s61, s58, 8
    s_cmp_gt_u32 s77, s61
    s_cselect_b32 s83, 0x610400, s76
    v_xor_b32 v24, 0x800, v14
    v_xor_b32 v32, 0x1000, v14
    v_xor_b32 v40, 0x1800, v14
    s_add_u32 s78, s78, 0x10000
    s_add_u32 s3, s58, 1
    s_min_u32 s3, s3, 63
    s_add_u32 s60, s79, s97
    s_add_u32 s79, s79, 0x40000
    s_add_u32 s71, s71, 0x40000
    s_add_u32 s96, s60, 0x80000
    s_add_u32 s61, s58, 2
    s_cmp_gt_u32 s77, s61
    s_cselect_b32 s96, s96, s60
    s_cmp_lt_u32 s57, 2
    s_cselect_b32 s96, s96, s83
    s_xor_b32 s93, s74, 0x4000
    s_lshl_b32 s60, s56, 7
    s_add_u32 s93, s93, s60
    s_cmp_eq_u32 s57, 2
    s_cselect_b32 s18, s93, 0x80000000
    s_cmp_gt_u32 s77, s3
    s_cbranch_scc0 CHkvp_19
CHkvok_18:
    s_waitcnt vmcnt(0)
    s_waitcnt lgkmcnt(0)
CHtop_20:
    v_smfmac_f32_16x16x64_bf16 v[112:115], v[16:19], v[48:55], v5
    v_smfmac_f32_16x16x64_bf16 v[116:119], v[16:19], v[56:63], v5
    v_smfmac_f32_16x16x64_bf16 v[112:115], v[20:23], v[64:71], v5
    v_smfmac_f32_16x16x64_bf16 v[116:119], v[20:23], v[72:79], v5
    s_waitcnt lgkmcnt(0)
    s_barrier
    ds_read_b128 v[28:31], v24 offset:1024
    ds_read_b128 v[24:27], v24
    ds_read_b128 v[36:39], v32 offset:1024
    ds_read_b128 v[32:35], v32
    ds_read_b128 v[44:47], v40 offset:1024
    ds_read_b128 v[40:43], v40
    v_smfmac_f32_16x16x64_bf16 v[120:123], v[16:19], a[0:7], v5
    v_smfmac_f32_16x16x64_bf16 v[124:127], v[16:19], a[8:15], v5
    buffer_load_dword v15, v0, s[36:39], s96 offen sc1
    v_smfmac_f32_16x16x64_bf16 v[120:123], v[20:23], a[16:23], v5
    v_smfmac_f32_16x16x64_bf16 v[124:127], v[20:23], a[24:31], v5
    s_waitcnt lgkmcnt(4)
    v_smfmac_f32_16x16x64_bf16 v[112:115], v[24:27], v[80:87], v5
    v_smfmac_f32_16x16x64_bf16 v[116:119], v[24:27], v[88:95], v5
    v_smfmac_f32_16x16x64_bf16 v[112:115], v[28:31], v[96:103], v5
    v_smfmac_f32_16x16x64_bf16 v[116:119], v[28:31], v[104:111], v5
    s_waitcnt lgkmcnt(2)
    v_smfmac_f32_16x16x64_bf16 v[112:115], v[32:35], v[128:135], v5
    ds_read_b128 v[48:51], v2 offset:16384
    v_smfmac_f32_16x16x64_bf16 v[116:119], v[32:35], v[136:143], v5
    ds_read_b128 v[52:55], v2 offset:17408
    v_smfmac_f32_16x16x64_bf16 v[112:115], v[36:39], v[144:151], v5
    ds_read_b128 v[56:59], v2 offset:18432
    v_smfmac_f32_16x16x64_bf16 v[116:119], v[36:39], v[152:159], v5
    ds_read_b128 v[60:63], v2 offset:19456
    s_waitcnt lgkmcnt(4)
    v_smfmac_f32_16x16x64_bf16 v[112:115], v[40:43], v[160:167], v5
    ds_read_b128 v[64:67], v2 offset:20480
    v_smfmac_f32_16x16x64_bf16 v[116:119], v[40:43], v[168:175], v5
    ds_read_b128 v[68:71], v2 offset:21504
    v_smfmac_f32_16x16x64_bf16 v[112:115], v[44:47], v[176:183], v5
    ds_read_b128 v[96:99], v4 offset:0
    v_smfmac_f32_16x16x64_bf16 v[116:119], v[44:47], v[184:191], v5
    ds_read_b128 v[100:103], v4 offset:256
    v_smfmac_f32_16x16x64_bf16 v[120:123], v[24:27], a[32:39], v5
    ds_read_b128 v[104:107], v4 offset:2048
    v_smfmac_f32_16x16x64_bf16 v[124:127], v[24:27], a[40:47], v5
    ds_read_b128 v[108:111], v4 offset:2304
    v_smfmac_f32_16x16x64_bf16 v[120:123], v[28:31], a[48:55], v5
    v_smfmac_f32_16x16x64_bf16 v[124:127], v[28:31], a[56:63], v5
    v_permlane32_swap_b32 v112, v114
    v_permlane32_swap_b32 v113, v115
    v_smfmac_f32_16x16x64_bf16 v[120:123], v[32:35], a[64:71], v5
    v_permlane32_swap_b32 v116, v118
    v_permlane32_swap_b32 v117, v119
    v_smfmac_f32_16x16x64_bf16 v[124:127], v[32:35], a[72:79], v5
    v_add_f32 v112, v112, v114
    v_add_f32 v113, v113, v115
    v_add_f32 v116, v116, v118
    v_add_f32 v117, v117, v119
    v_smfmac_f32_16x16x64_bf16 v[120:123], v[36:39], a[80:87], v5
    v_cvt_pk_bf16_f32 v114, v112, v116
    v_cvt_pk_bf16_f32 v115, v113, v117
    v_smfmac_f32_16x16x64_bf16 v[124:127], v[36:39], a[88:95], v5
    ds_write2_b32 v6, v114, v115 offset0:0 offset1:72
    v_smfmac_f32_16x16x64_bf16 v[120:123], v[40:43], a[96:103], v5
    v_mov_b64 v[112:113], 0
    v_smfmac_f32_16x16x64_bf16 v[124:127], v[40:43], a[104:111], v5
    v_mov_b64 v[116:117], 0
    v_smfmac_f32_16x16x64_bf16 v[120:123], v[44:47], a[112:119], v5
    v_mov_b64 v[118:119], 0
    s_waitcnt lgkmcnt(0)
    s_barrier
    v_smfmac_f32_16x16x64_bf16 v[124:127], v[44:47], a[120:127], v5
    ds_read_b128 v[80:83], v7 offset:0
    ds_read_b128 v[84:87], v7 offset:64
    ds_read_b128 v[88:91], v7 offset:128
    ds_read_b128 v[92:95], v7 offset:192
    v_mov_b64 v[114:115], 0
    v_mov_b32 v76, s58
    buffer_store_dword v76, v12, s[36:39], s17 offen sc1
    v_permlane32_swap_b32 v120, v122
    v_permlane32_swap_b32 v121, v123
    v_permlane32_swap_b32 v124, v126
    v_permlane32_swap_b32 v125, v127
    v_add_f32 v120, v120, v122
    v_add_f32 v121, v121, v123
    v_add_f32 v124, v124, v126
    v_add_f32 v125, v125, v127
    v_cvt_pk_bf16_f32 v122, v120, v124
    v_cvt_pk_bf16_f32 v123, v121, v125
    ds_write_b32 v6, v122 offset:2304
    ds_write_b32 v6, v123 offset:2592
    s_waitcnt lgkmcnt(2)
    v_mfma_f32_16x16x32_bf16 v[72:75], v[96:99], v[80:83], 0
    ds_read_b128 v[96:99], v4 offset:4096
    v_mfma_f32_16x16x32_bf16 v[76:79], v[100:103], v[80:83], 0
    ds_read_b128 v[100:103], v4 offset:4352
    v_mfma_f32_16x16x32_bf16 v[72:75], v[104:107], v[84:87], v[72:75]
    ds_read_b128 v[104:107], v4 offset:6144
    v_mfma_f32_16x16x32_bf16 v[76:79], v[108:111], v[84:87], v[76:79]
    ds_read_b128 v[108:111], v4 offset:6400
    s_waitcnt lgkmcnt(4)
    s_barrier
    v_smfmac_f32_16x16x64_bf16 v[116:119], v[44:47], a[248:255], v5
    buffer_store_dwordx2 v[122:123], v10, s[36:39], s78 offen sc1
    s_waitcnt lgkmcnt(0)
    v_mfma_f32_16x16x32_bf16 v[72:75], v[96:99], v[88:91], v[72:75]
    ds_read_b128 v[96:99], v7 offset:2304
    v_mfma_f32_16x16x32_bf16 v[76:79], v[100:103], v[88:91], v[76:79]
    ds_read_b128 v[100:103], v7 offset:2368
    v_mfma_f32_16x16x32_bf16 v[72:75], v[104:107], v[92:95], v[72:75]
    ds_read_b128 v[104:107], v7 offset:2432
    v_mfma_f32_16x16x32_bf16 v[76:79], v[108:111], v[92:95], v[76:79]
    ds_read_b128 v[108:111], v7 offset:2496
    v_smfmac_f32_16x16x64_bf16 v[112:115], v[44:47], a[240:247], v5
    v_mov_b64 v[124:125], 0
    v_smfmac_f32_16x16x64_bf16 v[116:119], v[40:43], a[232:239], v5
    v_mov_b64 v[126:127], 0
    s_waitcnt lgkmcnt(3)
    v_mfma_f32_16x16x32_bf16 v[120:123], v[96:99], v[80:83], 0
    s_nop 0
    v_cndmask_b32 v72, v72, v76, s[84:85]
    v_cndmask_b32 v73, v73, v77, s[84:85]
    s_waitcnt lgkmcnt(0)
    v_mfma_f32_16x16x32_bf16 v[120:123], v[100:103], v[84:87], v[120:123]
    v_cndmask_b32 v74, v74, v78, s[84:85]
    v_cndmask_b32 v75, v75, v79, s[84:85]
    v_mfma_f32_16x16x32_bf16 v[120:123], v[104:107], v[88:91], v[120:123]
    v_cvt_pk_bf16_f32 v72, 0, v72
    v_cvt_pk_bf16_f32 v73, 0, v73
    v_mfma_f32_16x16x32_bf16 v[120:123], v[108:111], v[92:95], v[120:123]
    v_cvt_pk_bf16_f32 v74, 0, v74
    v_cvt_pk_bf16_f32 v75, 0, v75
    ds_read_b128 v[84:87], v14 offset:16384
    ds_read_b128 v[88:91], v14 offset:17408
    v_mov_b64 v[92:93], -1
    v_mov_b64 v[94:95], -1
    buffer_store_dwordx4 v[92:95], v12, s[36:39], s18 offen
    v_mul_f32 v72, s70, v72
    v_mul_f32 v73, s70, v73
    v_mul_f32 v74, s70, v74
    v_mul_f32 v75, s70, v75
    v_cvt_pk_bf16_f32 v72, 0, v72
    v_cvt_pk_bf16_f32 v73, 0, v73
    v_cvt_pk_bf16_f32 v74, 0, v74
    v_cvt_pk_bf16_f32 v75, 0, v75
    v_max3_f32 v76, v72, v73, v74
    v_cndmask_b32 v120, v120, v122, s[84:85]
    v_cndmask_b32 v121, v121, v123, s[84:85]
    v_cvt_pk_bf16_f32 v120, 0, v120
    v_cvt_pk_bf16_f32 v121, 0, v121
    v_mul_f32 v120, s70, v120
    v_mul_f32 v121, s70, v121
    v_cvt_pk_bf16_f32 v120, 0, v120
    v_cvt_pk_bf16_f32 v121, 0, v121
    v_max3_f32 v77, v75, v120, v121
    v_max_f32 v76, v76, v77
    v_smfmac_f32_16x16x64_bf16 v[112:115], v[40:43], a[224:231], v5
    v_mov_b64 v[96:97], 0
    v_max_f32_dpp v76, v76, v76 row_ror:8 row_mask:0xf bank_mask:0xf
    v_mov_b32 v77, v76
    v_smfmac_f32_16x16x64_bf16 v[116:119], v[36:39], a[216:223], v5
    v_mov_b64 v[98:99], 0
    v_permlane32_swap_b32 v76, v77
    v_max_f32 v76, v76, v77
    v_mov_b32 v77, v76
    v_smfmac_f32_16x16x64_bf16 v[112:115], v[36:39], a[208:215], v5
    v_mov_b64 v[100:101], 0
    v_permlane16_swap_b32 v76, v77
    v_max_f32 v76, v76, v77
    v_mul_f32 v76, s69, v76
    v_fma_f32 v72, v72, s69, -v76
    v_smfmac_f32_16x16x64_bf16 v[116:119], v[32:35], a[200:207], v5
    v_fma_f32 v73, v73, s69, -v76
    v_smfmac_f32_16x16x64_bf16 v[112:115], v[32:35], a[192:199], v5
    v_fma_f32 v74, v74, s69, -v76
    v_smfmac_f32_16x16x64_bf16 v[116:119], v[28:31], a[184:191], v5
    v_fma_f32 v75, v75, s69, -v76
    v_smfmac_f32_16x16x64_bf16 v[112:115], v[28:31], a[176:183], v5
    v_fma_f32 v120, v120, s69, -v76
    v_smfmac_f32_16x16x64_bf16 v[116:119], v[24:27], a[168:175], v5
    v_fma_f32 v121, v121, s69, -v76
    v_smfmac_f32_16x16x64_bf16 v[112:115], v[24:27], a[160:167], v5
    ds_read_b128 v[32:35], v2 offset:22528
    v_smfmac_f32_16x16x64_bf16 v[116:119], v[20:23], a[152:159], v5
    v_exp_f32 v72, v72
    v_exp_f32 v73, v73
    v_exp_f32 v74, v74
    v_exp_f32 v75, v75
    v_exp_f32 v120, v120
    v_exp_f32 v121, v121
    s_waitcnt lgkmcnt(1)
    s_mov_b32 m0, s65
    s_nop 0
    buffer_load_dwordx4 v1, s[36:39], s71 offen offset:0 sc1 lds
    buffer_load_dwordx4 v1, s[36:39], s71 offen offset:1024 sc1 lds
    s_mov_b32 m0, s80
    v_add_f32 v76, v72, v74
    v_add_f32 v77, v73, v75
    v_add_f32 v122, v120, v121
    v_add_f32 v76, v76, v77
    v_fma_f32 v76, v122, 0.5, v76
    v_smfmac_f32_16x16x64_bf16 v[112:115], v[20:23], a[144:151], v5
    v_mov_b64 v[102:103], 0
    v_add_f32_dpp v76, v76, v76 row_ror:8 row_mask:0xf bank_mask:0xf
    v_mov_b32 v77, v76
    v_smfmac_f32_16x16x64_bf16 v[116:119], v[16:19], a[136:143], v5
    v_mov_b64 v[104:105], 0
    v_permlane32_swap_b32 v76, v77
    v_add_f32 v76, v76, v77
    v_mov_b32 v77, v76
    v_smfmac_f32_16x16x64_bf16 v[112:115], v[16:19], a[128:135], v5
    v_mov_b64 v[106:107], 0
    v_permlane16_swap_b32 v76, v77
    v_add_f32 v76, v76, v77
    v_rcp_f32 v76, v76
    ds_read_b128 v[36:39], v2 offset:23552
    v_mul_f32 v72, v72, v76
    v_mul_f32 v73, v73, v76
    v_mul_f32 v74, v74, v76
    v_mul_f32 v75, v75, v76
    v_mul_f32 v120, v120, v76
    v_mul_f32 v121, v121, v76
    v_cvt_pk_bf16_f32 v80, v72, v73
    v_cvt_pk_bf16_f32 v81, v74, v75
    v_cvt_pk_bf16_f32 v122, v120, v121
    v_mov_b32_dpp v82, v80 row_ror:8 row_mask:0xf bank_mask:0xf
    v_mov_b32_dpp v83, v81 row_ror:8 row_mask:0xf bank_mask:0xf
    v_permlane32_swap_b32 v112, v116
    v_permlane32_swap_b32 v113, v117
    v_mfma_f32_16x16x32_bf16 v[72:75], v[84:87], v[80:83], 0
    v_permlane32_swap_b32 v114, v118
    v_permlane32_swap_b32 v115, v119
    v_mfma_f32_16x16x32_bf16 v[76:79], v[88:91], v[80:83], 0
    v_add_f32 v112, v112, v116
    v_add_f32 v113, v113, v117
    v_add_f32 v114, v114, v118
    v_add_f32 v115, v115, v119
    v_cvt_pk_bf16_f32 v116, v112, v113
    v_cvt_pk_bf16_f32 v117, v114, v115
    v_mov_b32_dpp v124, v122 quad_perm:[0,1,2,3] row_mask:0x3 bank_mask:0xf
    v_mov_b32_dpp v125, v122 row_ror:8 row_mask:0x3 bank_mask:0xf
    v_mov_b32_dpp v126, v122 quad_perm:[0,1,2,3] row_mask:0xc bank_mask:0xf
    v_mov_b32_dpp v127, v122 row_ror:8 row_mask:0xc bank_mask:0xf
    v_mfma_f32_16x16x16_bf16 v[72:75], v[116:117], v[124:125], v[72:75]
    s_nop 0
    v_mfma_f32_16x16x16_bf16 v[76:79], v[116:117], v[126:127], v[76:79]
    buffer_store_dwordx2 v[116:117], v11, s[36:39], s78 offen sc1
    ds_read_b128 v[40:43], v2 offset:24576
    ds_read_b128 v[44:47], v2 offset:25600
    v_mov_b64 v[108:109], 0
    v_mov_b64 v[110:111], 0
    s_nop 2
    v_cvt_pk_bf16_f32 v92, v72, v76
    v_cvt_pk_bf16_f32 v93, v73, v77
    v_cvt_pk_bf16_f32 v94, v74, v78
    v_cvt_pk_bf16_f32 v95, v75, v79
    s_mov_b64 exec, s[86:87]
    ds_write_b128 v13, v[92:95]
    s_mov_b64 exec, -1
    v_mov_b32_dpp v92, v92 row_ror:8 row_mask:0xf bank_mask:0xc
    v_mov_b32_dpp v93, v93 row_ror:8 row_mask:0xf bank_mask:0xc
    v_mov_b32_dpp v94, v94 row_ror:8 row_mask:0xf bank_mask:0xc
    v_mov_b32_dpp v95, v95 row_ror:8 row_mask:0xf bank_mask:0xc
    v_xor_b32 v20, 0x200, v13
    v_xor_b32 v24, 0x400, v13
    v_xor_b32 v28, 0x600, v13
    v_smfmac_f32_16x16x64_bf16 v[96:99], v[92:95], v[48:55], v5
    v_smfmac_f32_16x16x64_bf16 v[100:103], v[92:95], v[56:63], v5
    s_waitcnt lgkmcnt(0)
    s_barrier
    ds_read_b128 v[20:23], v20
    ds_read_b128 v[24:27], v24
    ds_read_b128 v[28:31], v28
    v_smfmac_f32_16x16x64_bf16 v[104:107], v[92:95], v[64:71], v5
    v_smfmac_f32_16x16x64_bf16 v[108:111], v[92:95], v[32:39], v5
    buffer_load_dwordx4 v1, s[36:39], s79 offen offset:0 sc1 lds
    buffer_load_dwordx4 v1, s[36:39], s79 offen offset:1024 sc1 lds
    s_waitcnt lgkmcnt(2)
    v_smfmac_f32_16x16x64_bf16 v[96:99], v[20:23], v[40:47], v5
    ds_read_b128 v[48:51], v2 offset:26624
    v_smfmac_f32_16x16x64_bf16 v[100:103], v[20:23], v[192:199], v5
    ds_read_b128 v[52:55], v2 offset:27648
    s_waitcnt lgkmcnt(2)
    v_smfmac_f32_16x16x64_bf16 v[96:99], v[24:27], v[200:207], v5
    ds_read_b128 v[56:59], v2 offset:28672
    v_smfmac_f32_16x16x64_bf16 v[100:103], v[24:27], v[208:215], v5
    ds_read_b128 v[60:63], v2 offset:29696
    v_smfmac_f32_16x16x64_bf16 v[96:99], v[28:31], v[216:223], v5
    ds_read_b128 v[64:67], v2 offset:30720
    v_smfmac_f32_16x16x64_bf16 v[100:103], v[28:31], v[224:231], v5
    ds_read_b128 v[68:71], v2 offset:31744
    v_smfmac_f32_16x16x64_bf16 v[104:107], v[20:23], v[232:239], v5
    v_smfmac_f32_16x16x64_bf16 v[108:111], v[20:23], v[240:247], v5
    v_smfmac_f32_16x16x64_bf16 v[104:107], v[24:27], v[248:255], v5
    s_nop 3
    v_cvt_pk_bf16_f32 v80, v96, v100
    v_and_or_b32 v80, v80, -2, s16
    v_cvt_pk_bf16_f32 v81, v97, v101
    s_waitcnt lgkmcnt(0)
    v_smfmac_f32_16x16x64_bf16 v[108:111], v[24:27], v[48:55], v5
    v_and_or_b32 v81, v81, -2, s16
    v_cvt_pk_bf16_f32 v82, v98, v102
    v_and_or_b32 v82, v82, -2, s16
    v_smfmac_f32_16x16x64_bf16 v[104:107], v[28:31], v[56:63], v5
    v_cvt_pk_bf16_f32 v83, v99, v103
    v_and_or_b32 v83, v83, -2, s16
    buffer_store_dwordx4 v[80:83], v8, s[36:39], s72 offen
    v_smfmac_f32_16x16x64_bf16 v[108:111], v[28:31], v[64:71], v5
    s_nop 7
    v_cvt_pk_bf16_f32 v84, v104, v108
    v_and_or_b32 v84, v84, -2, s16
    v_cvt_pk_bf16_f32 v85, v105, v109
    v_and_or_b32 v85, v85, -2, s16
    v_cvt_pk_bf16_f32 v86, v106, v110
    v_and_or_b32 v86, v86, -2, s16
    v_cvt_pk_bf16_f32 v87, v107, v111
    v_and_or_b32 v87, v87, -2, s16
    buffer_store_dwordx4 v[84:87], v8, s[36:39], s73 offen
    ds_read_b128 v[32:35], v3 offset:31296
    s_waitcnt vmcnt(8)
    s_mov_b64 exec, s[88:89]
    ds_write_b32 v3, v15 offset:32320
    s_mov_b64 exec, -1
    ds_read_b128 v[48:51], v2 offset:0
    ds_read_b128 v[52:55], v2 offset:1024
    v_mov_b64 v[112:113], 0
    ds_read_b128 v[56:59], v2 offset:2048
    ds_read_b128 v[60:63], v2 offset:3072
    v_mov_b64 v[114:115], 0
    ds_read_b128 v[64:67], v2 offset:4096
    ds_read_b128 v[68:71], v2 offset:5120
    v_mov_b64 v[116:117], 0
    ds_read_b128 v[72:75], v2 offset:6144
    ds_read_b128 v[76:79], v2 offset:7168
    v_mov_b64 v[118:119], 0
    ds_read_b128 v[80:83], v2 offset:8192
    ds_read_b128 v[84:87], v2 offset:9216
    v_mov_b64 v[120:121], 0
    ds_read_b128 v[88:91], v2 offset:10240
    ds_read_b128 v[92:95], v2 offset:11264
    v_mov_b64 v[122:123], 0
    ds_read_b128 v[96:99], v2 offset:12288
    ds_read_b128 v[100:103], v2 offset:13312
    v_mov_b64 v[124:125], 0
    ds_read_b128 v[104:107], v2 offset:14336
    ds_read_b128 v[108:111], v2 offset:15360
    v_mov_b64 v[126:127], 0
    s_add_u32 s64, s72, s82
    s_lshl_b32 s62, s57, 10
    s_add_u32 s62, s62, s74
    s_add_u32 s21, s62, 4096
    s_mov_b32 s63, s74
    s_waitcnt lgkmcnt(0)
    s_cmp_ge_u32 s57, 2
    s_cbranch_scc1 CHbe_22
    s_sleep 3
    buffer_load_dwordx4 v[16:19], v1, s[36:39], s64 offen offset:0 sc1
    buffer_load_dwordx4 v[20:23], v1, s[36:39], s64 offen offset:1024 sc1
    buffer_load_dwordx4 v[24:27], v1, s[36:39], s64 offen offset:2048 sc1
    buffer_load_dwordx4 v[28:31], v1, s[36:39], s64 offen offset:3072 sc1
    s_waitcnt vmcnt(3)
    v_mfma_f32_16x16x32_bf16 v[36:39], v[32:35], v[16:19], 0
    v_bitop3_b32 v40, v16, v17, s16 bitop3:0x7e
    v_bitop3_b32 v41, v18, v19, s16 bitop3:0x7e
    s_waitcnt vmcnt(2)
    v_mfma_f32_16x16x32_bf16 v[36:39], v[32:35], v[20:23], v[36:39]
    v_bitop3_b32 v42, v20, v21, s16 bitop3:0x7e
    v_bitop3_b32 v43, v22, v23, s16 bitop3:0x7e
    s_waitcnt vmcnt(1)
    v_mfma_f32_16x16x32_bf16 v[36:39], v[32:35], v[24:27], v[36:39]
    v_bitop3_b32 v44, v24, v25, s16 bitop3:0x7e
    v_bitop3_b32 v45, v26, v27, s16 bitop3:0x7e
    s_waitcnt vmcnt(0)
    v_mfma_f32_16x16x32_bf16 v[36:39], v[32:35], v[28:31], v[36:39]
    v_bitop3_b32 v46, v28, v29, s16 bitop3:0x7e
    v_bitop3_b32 v47, v30, v31, s16 bitop3:0x7e
    v_or3_b32 v40, v40, v41, v42
    v_or3_b32 v43, v43, v44, v45
    v_or3_b32 v40, v40, v46, v47
    v_or_b32 v41, v40, v43
    v_and_b32 v41, 1, v41
    v_cmpx_ne_u32 vcc, 0, v41
    s_nop 3
    s_cbranch_execz CHok1_25
CHp1_24:
    buffer_load_dwordx4 v[16:19], v1, s[36:39], s64 offen offset:0 sc1
    buffer_load_dwordx4 v[20:23], v1, s[36:39], s64 offen offset:1024 sc1
    buffer_load_dwordx4 v[24:27], v1, s[36:39], s64 offen offset:2048 sc1
    buffer_load_dwordx4 v[28:31], v1, s[36:39], s64 offen offset:3072 sc1
    s_waitcnt vmcnt(8)
    v_bitop3_b32 v40, v16, v17, s16 bitop3:0x7e
    v_bitop3_b32 v41, v18, v19, s16 bitop3:0x7e
    v_bitop3_b32 v42, v20, v21, s16 bitop3:0x7e
    v_bitop3_b32 v43, v22, v23, s16 bitop3:0x7e
    v_bitop3_b32 v44, v24, v25, s16 bitop3:0x7e
    v_bitop3_b32 v45, v26, v27, s16 bitop3:0x7e
    v_bitop3_b32 v46, v28, v29, s16 bitop3:0x7e
    v_bitop3_b32 v47, v30, v31, s16 bitop3:0x7e
    v_or3_b32 v40, v40, v41, v42
    v_or3_b32 v43, v43, v44, v45
    v_or3_b32 v40, v40, v46, v47
    v_or_b32 v41, v40, v43
    v_and_b32 v41, 1, v41
    v_cmpx_ne_u32 vcc, 0, v41
    s_nop 3
    s_cbranch_execnz CHp1_24
    s_mov_b64 exec, -1
    v_mfma_f32_16x16x32_bf16 v[36:39], v[32:35], v[16:19], 0
    v_mfma_f32_16x16x32_bf16 v[36:39], v[32:35], v[20:23], v[36:39]
    v_mfma_f32_16x16x32_bf16 v[36:39], v[32:35], v[24:27], v[36:39]
    v_mfma_f32_16x16x32_bf16 v[36:39], v[32:35], v[28:31], v[36:39]
    s_nop 7
CHok1_25:
    s_mov_b64 exec, -1
    v_add_f32_dpp v36, v36, v36 row_ror:8 row_mask:0xf bank_mask:0xf
    v_add_f32_dpp v37, v37, v37 row_ror:8 row_mask:0xf bank_mask:0xf
    s_mov_b64 exec, s[86:87]
    v_cvt_pk_bf16_f32 v36, v36, v37
    buffer_store_dword v36, v9, s[36:39], s63 offen
    s_mov_b64 exec, -1
CHbe_22:
    s_barrier
    v_mov_b32 v15, 163392
    ds_read_b32 v15, v15
    s_waitcnt lgkmcnt(0)
    v_readfirstlane_b32 s59, v15
    s_nop 0
    s_max_u32 s77, s77, s59
    s_add_u32 s58, s58, 1
    s_and_b32 s59, s58, 3
    s_lshl_b32 s74, s59, 13
    s_add_u32 s74, s74, 0x6f8000
    s_and_b32 s16, s58, 1
    s_min_u32 s76, s77, 63
    s_and_b32 s76, s76, 48
    s_lshl_b32 s76, s76, 8
    s_add_u32 s76, s76, s20
    s_add_u32 s61, s58, 8
    s_cmp_gt_u32 s77, s61
    s_cselect_b32 s83, 0x610400, s76
    s_add_u32 s78, s78, 0x10000
    s_add_u32 s3, s58, 1
    s_min_u32 s3, s3, 63
    s_add_u32 s60, s79, s97
    s_add_u32 s79, s79, 0x40000
    s_add_u32 s71, s71, 0x40000
    s_add_u32 s96, s60, 0x80000
    s_add_u32 s61, s58, 2
    s_cmp_gt_u32 s77, s61
    s_cselect_b32 s96, s96, s60
    s_cmp_lt_u32 s57, 2
    s_cselect_b32 s96, s96, s83
    s_xor_b32 s93, s74, 0x4000
    s_lshl_b32 s60, s56, 7
    s_add_u32 s93, s93, s60
    s_cmp_eq_u32 s57, 2
    s_cselect_b32 s18, s93, 0x80000000
    s_cmp_gt_u32 s77, s3
    s_cbranch_scc0 CHkvp_27
CHkvok_26:
    s_sleep 1
    buffer_load_dwordx4 v[16:19], v1, s[36:39], s62 offen sc1
    buffer_load_dwordx4 v[20:23], v1, s[36:39], s21 offen sc1
    s_waitcnt vmcnt(1)
    ds_write_b128 v14, v[16:19] offset:0
    s_waitcnt vmcnt(0)
    ds_write_b128 v14, v[20:23] offset:1024
    v_max3_u32 v41, v16, v17, v18
    v_max3_u32 v41, v41, v19, v20
    v_max3_u32 v41, v41, v21, v22
    v_max_u32 v41, v41, v23
    v_xor_b32 v24, 0x800, v14
    v_xor_b32 v32, 0x1000, v14
    v_xor_b32 v40, 0x1800, v14
    v_cmpx_eq_u32 vcc, -1, v41
    s_nop 3
    s_cbranch_execz CHok2_29
    s_mov_b64 s[40:41], exec
CHp2_28:
    buffer_load_dwordx4 v[16:19], v1, s[36:39], s62 offen sc1
    buffer_load_dwordx4 v[20:23], v1, s[36:39], s21 offen sc1
    s_waitcnt vmcnt(4)
    v_max3_u32 v41, v16, v17, v18
    v_max3_u32 v41, v41, v19, v20
    v_max3_u32 v41, v41, v21, v22
    v_max_u32 v41, v41, v23
    v_cmpx_eq_u32 vcc, -1, v41
    s_nop 3
    s_cbranch_execnz CHp2_28
    s_mov_b64 exec, s[40:41]
    ds_write_b128 v14, v[16:19] offset:0
    ds_write_b128 v14, v[20:23] offset:1024
CHok2_29:
    s_mov_b64 exec, -1
    s_cmp_lg_u32 s58, 63
    s_cbranch_scc1 CHtop_20
    v_smfmac_f32_16x16x64_bf16 v[120:123], v[16:19], a[0:7], v5
    v_smfmac_f32_16x16x64_bf16 v[124:127], v[16:19], a[8:15], v5
    v_smfmac_f32_16x16x64_bf16 v[120:123], v[20:23], a[16:23], v5
    v_smfmac_f32_16x16x64_bf16 v[124:127], v[20:23], a[24:31], v5
    s_waitcnt lgkmcnt(0)
    s_barrier
    ds_read_b128 v[28:31], v24 offset:1024
    ds_read_b128 v[24:27], v24
    ds_read_b128 v[36:39], v32 offset:1024
    ds_read_b128 v[32:35], v32
    ds_read_b128 v[44:47], v40 offset:1024
    ds_read_b128 v[40:43], v40
    v_mov_b32 v76, s58
    s_mov_b64 exec, s[88:89]
    buffer_store_dword v76, off, s[36:39], s75 sc1
    s_mov_b64 exec, -1
    v_smfmac_f32_16x16x64_bf16 v[112:115], v[16:19], a[128:135], v5
    v_smfmac_f32_16x16x64_bf16 v[116:119], v[16:19], a[136:143], v5
    v_smfmac_f32_16x16x64_bf16 v[112:115], v[20:23], a[144:151], v5
    v_smfmac_f32_16x16x64_bf16 v[116:119], v[20:23], a[152:159], v5
    s_waitcnt lgkmcnt(0)
    v_smfmac_f32_16x16x64_bf16 v[120:123], v[24:27], a[32:39], v5
    v_smfmac_f32_16x16x64_bf16 v[124:127], v[24:27], a[40:47], v5
    v_smfmac_f32_16x16x64_bf16 v[120:123], v[28:31], a[48:55], v5
    v_smfmac_f32_16x16x64_bf16 v[124:127], v[28:31], a[56:63], v5
    v_smfmac_f32_16x16x64_bf16 v[120:123], v[32:35], a[64:71], v5
    v_smfmac_f32_16x16x64_bf16 v[124:127], v[32:35], a[72:79], v5
    v_smfmac_f32_16x16x64_bf16 v[120:123], v[36:39], a[80:87], v5
    v_smfmac_f32_16x16x64_bf16 v[124:127], v[36:39], a[88:95], v5
    v_smfmac_f32_16x16x64_bf16 v[120:123], v[40:43], a[96:103], v5
    v_smfmac_f32_16x16x64_bf16 v[124:127], v[40:43], a[104:111], v5
    v_smfmac_f32_16x16x64_bf16 v[120:123], v[44:47], a[112:119], v5
    v_smfmac_f32_16x16x64_bf16 v[124:127], v[44:47], a[120:127], v5
    v_smfmac_f32_16x16x64_bf16 v[112:115], v[24:27], a[160:167], v5
    v_smfmac_f32_16x16x64_bf16 v[116:119], v[24:27], a[168:175], v5
    v_smfmac_f32_16x16x64_bf16 v[112:115], v[28:31], a[176:183], v5
    s_nop 3
    v_permlane32_swap_b32 v120, v122
    v_smfmac_f32_16x16x64_bf16 v[116:119], v[28:31], a[184:191], v5
    v_permlane32_swap_b32 v121, v123
    v_smfmac_f32_16x16x64_bf16 v[112:115], v[32:35], a[192:199], v5
    v_permlane32_swap_b32 v124, v126
    v_smfmac_f32_16x16x64_bf16 v[116:119], v[32:35], a[200:207], v5
    v_permlane32_swap_b32 v125, v127
    v_smfmac_f32_16x16x64_bf16 v[112:115], v[36:39], a[208:215], v5
    v_add_f32 v120, v120, v122
    v_add_f32 v121, v121, v123
    v_smfmac_f32_16x16x64_bf16 v[116:119], v[36:39], a[216:223], v5
    v_add_f32 v124, v124, v126
    v_add_f32 v125, v125, v127
    v_smfmac_f32_16x16x64_bf16 v[112:115], v[40:43], a[224:231], v5
    v_cvt_pk_bf16_f32 v122, v120, v124
    v_smfmac_f32_16x16x64_bf16 v[116:119], v[40:43], a[232:239], v5
    v_cvt_pk_bf16_f32 v123, v121, v125
    v_smfmac_f32_16x16x64_bf16 v[112:115], v[44:47], a[240:247], v5
    buffer_store_dwordx2 v[122:123], v10, s[36:39], s78 offen sc1
    v_smfmac_f32_16x16x64_bf16 v[116:119], v[44:47], a[248:255], v5
    s_nop 7
    v_permlane32_swap_b32 v112, v116
    v_permlane32_swap_b32 v113, v117
    v_permlane32_swap_b32 v114, v118
    v_permlane32_swap_b32 v115, v119
    v_add_f32 v112, v112, v116
    v_add_f32 v113, v113, v117
    v_add_f32 v114, v114, v118
    v_add_f32 v115, v115, v119
    v_cvt_pk_bf16_f32 v116, v112, v113
    v_cvt_pk_bf16_f32 v117, v114, v115
    buffer_store_dwordx2 v[116:117], v11, s[36:39], s78 offen sc1
    s_branch CHfin_16
CHcut_17:
    s_add_u32 s58, s58, 1
    s_waitcnt lgkmcnt(0)
    s_branch CHtop_20
CHfin_16:
    s_waitcnt vmcnt(0)
    s_barrier
    s_add_u32 s59, s58, 1
    v_mov_b32 v15, s59
    s_mov_b64 exec, s[88:89]
    buffer_store_dword v15, off, s[36:39], s75 sc1
    s_mov_b64 exec, -1
    s_branch Lend_1
CHkvp_15:
    buffer_load_dword v34, off, s[36:39], s76 sc1
    s_waitcnt vmcnt(0)
    v_readfirstlane_b32 s64, v34
    s_nop 0
    s_max_u32 s77, s77, s64
    s_min_u32 s76, s77, 63
    s_and_b32 s76, s76, 48
    s_lshl_b32 s76, s76, 8
    s_add_u32 s76, s76, s20
    s_cmp_gt_u32 s77, s58
    s_cbranch_scc1 CHkvok_14
    s_branch CHkvp_15
CHkvp_19:
    buffer_load_dword v43, off, s[36:39], s76 sc1
    s_waitcnt vmcnt(0)
    v_readfirstlane_b32 s64, v43
    s_nop 0
    s_max_u32 s77, s77, s64
    s_min_u32 s76, s77, 63
    s_and_b32 s76, s76, 48
    s_lshl_b32 s76, s76, 8
    s_add_u32 s76, s76, s20
    s_cmp_gt_u32 s77, s3
    s_cbranch_scc1 CHkvok_18
    s_branch CHkvp_19
CHkvp_27:
    buffer_load_dword v43, off, s[36:39], s76 sc1
    s_waitcnt vmcnt(0)
    v_readfirstlane_b32 s64, v43
    s_nop 0
    s_max_u32 s77, s77, s64
    s_min_u32 s76, s77, 63
    s_and_b32 s76, s76, 48
    s_lshl_b32 s76, s76, 8
    s_add_u32 s76, s76, s20
    s_cmp_gt_u32 s77, s3
    s_cbranch_scc1 CHkvok_26
    s_branch CHkvp_27
Lx1_4:
    s_mov_b32 s91, 0
Lkv_30:
    s_mov_b32 s40, s10
    s_and_b32 s41, s11, 0xffff
    s_mov_b32 s42, 0x400000
    s_mov_b32 s43, 0x20000
    s_mov_b32 s44, s12
    s_and_b32 s45, s13, 0xffff
    s_mov_b32 s46, 0x400000
    s_mov_b32 s47, 0x20000
    v_bfe_u32 v5, v0, 2, 2
    v_lshlrev_b32 v5, 3, v5
    v_lshrrev_b32 v3, 4, v0
    v_add_u32 v5, v5, v3
    s_mov_b32 s59, 8192
    v_mul_lo_u32 v3, v5, s59
    v_and_b32 v5, 3, v0
    v_lshl_add_u32 v3, v5, 4, v3
    s_lshl_b32 s78, s57, 15
    v_lshlrev_b32 v4, 2, v0
    v_add_u32 v4, s78, v4
    s_lshl_b32 s77, s56, 8
    s_lshl_b32 s59, s57, 6
    s_add_u32 s77, s77, s59
    v_lshrrev_b32 v4, 4, v0
    s_mov_b32 s59, 65536
    v_mul_lo_u32 v3, v4, s59
    v_and_b32 v4, 15, v0
    v_mul_u32_u24 v4, 4, v4
    v_add_u32 v3, v3, v4
    s_add_u32 s59, s77, 0x0
    buffer_load_dword v128, v3, s[40:43], s59 offen
    s_add_u32 s59, s77, 0x2000
    buffer_load_dword v129, v3, s[40:43], s59 offen
    s_add_u32 s59, s77, 0x4000
    buffer_load_dword v130, v3, s[40:43], s59 offen
    s_add_u32 s59, s77, 0x6000
    buffer_load_dword v131, v3, s[40:43], s59 offen
    s_add_u32 s59, s77, 0x8000
    buffer_load_dword v132, v3, s[40:43], s59 offen
    s_add_u32 s59, s77, 0xa000
    buffer_load_dword v133, v3, s[40:43], s59 offen
    s_add_u32 s59, s77, 0xc000
    buffer_load_dword v134, v3, s[40:43], s59 offen
    s_add_u32 s59, s77, 0xe000
    buffer_load_dword v135, v3, s[40:43], s59 offen
    s_add_u32 s59, s77, 0x40000
    buffer_load_dword v136, v3, s[40:43], s59 offen
    s_add_u32 s59, s77, 0x42000
    buffer_load_dword v137, v3, s[40:43], s59 offen
    s_add_u32 s59, s77, 0x44000
    buffer_load_dword v138, v3, s[40:43], s59 offen
    s_add_u32 s59, s77, 0x46000
    buffer_load_dword v139, v3, s[40:43], s59 offen
    s_add_u32 s59, s77, 0x48000
    buffer_load_dword v140, v3, s[40:43], s59 offen
    s_add_u32 s59, s77, 0x4a000
    buffer_load_dword v141, v3, s[40:43], s59 offen
    s_add_u32 s59, s77, 0x4c000
    buffer_load_dword v142, v3, s[40:43], s59 offen
    s_add_u32 s59, s77, 0x4e000
    buffer_load_dword v143, v3, s[40:43], s59 offen
    s_add_u32 s59, s77, 0x80000
    buffer_load_dword v144, v3, s[40:43], s59 offen
    s_add_u32 s59, s77, 0x82000
    buffer_load_dword v145, v3, s[40:43], s59 offen
    s_add_u32 s59, s77, 0x84000
    buffer_load_dword v146, v3, s[40:43], s59 offen
    s_add_u32 s59, s77, 0x86000
    buffer_load_dword v147, v3, s[40:43], s59 offen
    s_add_u32 s59, s77, 0x88000
    buffer_load_dword v148, v3, s[40:43], s59 offen
    s_add_u32 s59, s77, 0x8a000
    buffer_load_dword v149, v3, s[40:43], s59 offen
    s_add_u32 s59, s77, 0x8c000
    buffer_load_dword v150, v3, s[40:43], s59 offen
    s_add_u32 s59, s77, 0x8e000
    buffer_load_dword v151, v3, s[40:43], s59 offen
    s_add_u32 s59, s77, 0xc0000
    buffer_load_dword v152, v3, s[40:43], s59 offen
    s_add_u32 s59, s77, 0xc2000
    buffer_load_dword v153, v3, s[40:43], s59 offen
    s_add_u32 s59, s77, 0xc4000
    buffer_load_dword v154, v3, s[40:43], s59 offen
    s_add_u32 s59, s77, 0xc6000
    buffer_load_dword v155, v3, s[40:43], s59 offen
    s_add_u32 s59, s77, 0xc8000
    buffer_load_dword v156, v3, s[40:43], s59 offen
    s_add_u32 s59, s77, 0xca000
    buffer_load_dword v157, v3, s[40:43], s59 offen
    s_add_u32 s59, s77, 0xcc000
    buffer_load_dword v158, v3, s[40:43], s59 offen
    s_add_u32 s59, s77, 0xce000
    buffer_load_dword v159, v3, s[40:43], s59 offen
    s_add_u32 s59, s77, 0x100000
    buffer_load_dword v160, v3, s[40:43], s59 offen
    s_add_u32 s59, s77, 0x102000
    buffer_load_dword v161, v3, s[40:43], s59 offen
    s_add_u32 s59, s77, 0x104000
    buffer_load_dword v162, v3, s[40:43], s59 offen
    s_add_u32 s59, s77, 0x106000
    buffer_load_dword v163, v3, s[40:43], s59 offen
    s_add_u32 s59, s77, 0x108000
    buffer_load_dword v164, v3, s[40:43], s59 offen
    s_add_u32 s59, s77, 0x10a000
    buffer_load_dword v165, v3, s[40:43], s59 offen
    s_add_u32 s59, s77, 0x10c000
    buffer_load_dword v166, v3, s[40:43], s59 offen
    s_add_u32 s59, s77, 0x10e000
    buffer_load_dword v167, v3, s[40:43], s59 offen
    s_add_u32 s59, s77, 0x140000
    buffer_load_dword v168, v3, s[40:43], s59 offen
    s_add_u32 s59, s77, 0x142000
    buffer_load_dword v169, v3, s[40:43], s59 offen
    s_add_u32 s59, s77, 0x144000
    buffer_load_dword v170, v3, s[40:43], s59 offen
    s_add_u32 s59, s77, 0x146000
    buffer_load_dword v171, v3, s[40:43], s59 offen
    s_add_u32 s59, s77, 0x148000
    buffer_load_dword v172, v3, s[40:43], s59 offen
    s_add_u32 s59, s77, 0x14a000
    buffer_load_dword v173, v3, s[40:43], s59 offen
    s_add_u32 s59, s77, 0x14c000
    buffer_load_dword v174, v3, s[40:43], s59 offen
    s_add_u32 s59, s77, 0x14e000
    buffer_load_dword v175, v3, s[40:43], s59 offen
    s_add_u32 s59, s77, 0x180000
    buffer_load_dword v176, v3, s[40:43], s59 offen
    s_add_u32 s59, s77, 0x182000
    buffer_load_dword v177, v3, s[40:43], s59 offen
    s_add_u32 s59, s77, 0x184000
    buffer_load_dword v178, v3, s[40:43], s59 offen
    s_add_u32 s59, s77, 0x186000
    buffer_load_dword v179, v3, s[40:43], s59 offen
    s_add_u32 s59, s77, 0x188000
    buffer_load_dword v180, v3, s[40:43], s59 offen
    s_add_u32 s59, s77, 0x18a000
    buffer_load_dword v181, v3, s[40:43], s59 offen
    s_add_u32 s59, s77, 0x18c000
    buffer_load_dword v182, v3, s[40:43], s59 offen
    s_add_u32 s59, s77, 0x18e000
    buffer_load_dword v183, v3, s[40:43], s59 offen
    s_add_u32 s59, s77, 0x1c0000
    buffer_load_dword v184, v3, s[40:43], s59 offen
    s_add_u32 s59, s77, 0x1c2000
    buffer_load_dword v185, v3, s[40:43], s59 offen
    s_add_u32 s59, s77, 0x1c4000
    buffer_load_dword v186, v3, s[40:43], s59 offen
    s_add_u32 s59, s77, 0x1c6000
    buffer_load_dword v187, v3, s[40:43], s59 offen
    s_add_u32 s59, s77, 0x1c8000
    buffer_load_dword v188, v3, s[40:43], s59 offen
    s_add_u32 s59, s77, 0x1ca000
    buffer_load_dword v189, v3, s[40:43], s59 offen
    s_add_u32 s59, s77, 0x1cc000
    buffer_load_dword v190, v3, s[40:43], s59 offen
    s_add_u32 s59, s77, 0x1ce000
    buffer_load_dword v191, v3, s[40:43], s59 offen
    s_waitcnt vmcnt(56)
    v_perm_b32 v4, v129, v128, s66
    v_accvgpr_write_b32 a0, v4
    v_perm_b32 v5, v129, v128, s67
    v_accvgpr_write_b32 a4, v5
    v_perm_b32 v4, v131, v130, s66
    v_accvgpr_write_b32 a1, v4
    v_perm_b32 v5, v131, v130, s67
    v_accvgpr_write_b32 a5, v5
    v_perm_b32 v4, v133, v132, s66
    v_accvgpr_write_b32 a2, v4
    v_perm_b32 v5, v133, v132, s67
    v_accvgpr_write_b32 a6, v5
    v_perm_b32 v4, v135, v134, s66
    v_accvgpr_write_b32 a3, v4
    v_perm_b32 v5, v135, v134, s67
    v_accvgpr_write_b32 a7, v5
    s_add_u32 s59, s77, 0x200000
    buffer_load_dword v128, v3, s[40:43], s59 offen
    s_add_u32 s59, s77, 0x202000
    buffer_load_dword v129, v3, s[40:43], s59 offen
    s_add_u32 s59, s77, 0x204000
    buffer_load_dword v130, v3, s[40:43], s59 offen
    s_add_u32 s59, s77, 0x206000
    buffer_load_dword v131, v3, s[40:43], s59 offen
    s_add_u32 s59, s77, 0x208000
    buffer_load_dword v132, v3, s[40:43], s59 offen
    s_add_u32 s59, s77, 0x20a000
    buffer_load_dword v133, v3, s[40:43], s59 offen
    s_add_u32 s59, s77, 0x20c000
    buffer_load_dword v134, v3, s[40:43], s59 offen
    s_add_u32 s59, s77, 0x20e000
    buffer_load_dword v135, v3, s[40:43], s59 offen
    s_waitcnt vmcnt(56)
    v_perm_b32 v4, v137, v136, s66
    v_accvgpr_write_b32 a8, v4
    v_perm_b32 v5, v137, v136, s67
    v_accvgpr_write_b32 a12, v5
    v_perm_b32 v4, v139, v138, s66
    v_accvgpr_write_b32 a9, v4
    v_perm_b32 v5, v139, v138, s67
    v_accvgpr_write_b32 a13, v5
    v_perm_b32 v4, v141, v140, s66
    v_accvgpr_write_b32 a10, v4
    v_perm_b32 v5, v141, v140, s67
    v_accvgpr_write_b32 a14, v5
    v_perm_b32 v4, v143, v142, s66
    v_accvgpr_write_b32 a11, v4
    v_perm_b32 v5, v143, v142, s67
    v_accvgpr_write_b32 a15, v5
    s_add_u32 s59, s77, 0x240000
    buffer_load_dword v136, v3, s[40:43], s59 offen
    s_add_u32 s59, s77, 0x242000
    buffer_load_dword v137, v3, s[40:43], s59 offen
    s_add_u32 s59, s77, 0x244000
    buffer_load_dword v138, v3, s[40:43], s59 offen
    s_add_u32 s59, s77, 0x246000
    buffer_load_dword v139, v3, s[40:43], s59 offen
    s_add_u32 s59, s77, 0x248000
    buffer_load_dword v140, v3, s[40:43], s59 offen
    s_add_u32 s59, s77, 0x24a000
    buffer_load_dword v141, v3, s[40:43], s59 offen
    s_add_u32 s59, s77, 0x24c000
    buffer_load_dword v142, v3, s[40:43], s59 offen
    s_add_u32 s59, s77, 0x24e000
    buffer_load_dword v143, v3, s[40:43], s59 offen
    s_waitcnt vmcnt(56)
    v_perm_b32 v4, v145, v144, s66
    v_accvgpr_write_b32 a16, v4
    v_perm_b32 v5, v145, v144, s67
    v_accvgpr_write_b32 a20, v5
    v_perm_b32 v4, v147, v146, s66
    v_accvgpr_write_b32 a17, v4
    v_perm_b32 v5, v147, v146, s67
    v_accvgpr_write_b32 a21, v5
    v_perm_b32 v4, v149, v148, s66
    v_accvgpr_write_b32 a18, v4
    v_perm_b32 v5, v149, v148, s67
    v_accvgpr_write_b32 a22, v5
    v_perm_b32 v4, v151, v150, s66
    v_accvgpr_write_b32 a19, v4
    v_perm_b32 v5, v151, v150, s67
    v_accvgpr_write_b32 a23, v5
    s_add_u32 s59, s77, 0x280000
    buffer_load_dword v144, v3, s[40:43], s59 offen
    s_add_u32 s59, s77, 0x282000
    buffer_load_dword v145, v3, s[40:43], s59 offen
    s_add_u32 s59, s77, 0x284000
    buffer_load_dword v146, v3, s[40:43], s59 offen
    s_add_u32 s59, s77, 0x286000
    buffer_load_dword v147, v3, s[40:43], s59 offen
    s_add_u32 s59, s77, 0x288000
    buffer_load_dword v148, v3, s[40:43], s59 offen
    s_add_u32 s59, s77, 0x28a000
    buffer_load_dword v149, v3, s[40:43], s59 offen
    s_add_u32 s59, s77, 0x28c000
    buffer_load_dword v150, v3, s[40:43], s59 offen
    s_add_u32 s59, s77, 0x28e000
    buffer_load_dword v151, v3, s[40:43], s59 offen
    s_waitcnt vmcnt(56)
    v_perm_b32 v4, v153, v152, s66
    v_accvgpr_write_b32 a24, v4
    v_perm_b32 v5, v153, v152, s67
    v_accvgpr_write_b32 a28, v5
    v_perm_b32 v4, v155, v154, s66
    v_accvgpr_write_b32 a25, v4
    v_perm_b32 v5, v155, v154, s67
    v_accvgpr_write_b32 a29, v5
    v_perm_b32 v4, v157, v156, s66
    v_accvgpr_write_b32 a26, v4
    v_perm_b32 v5, v157, v156, s67
    v_accvgpr_write_b32 a30, v5
    v_perm_b32 v4, v159, v158, s66
    v_accvgpr_write_b32 a27, v4
    v_perm_b32 v5, v159, v158, s67
    v_accvgpr_write_b32 a31, v5
    s_add_u32 s59, s77, 0x2c0000
    buffer_load_dword v152, v3, s[40:43], s59 offen
    s_add_u32 s59, s77, 0x2c2000
    buffer_load_dword v153, v3, s[40:43], s59 offen
    s_add_u32 s59, s77, 0x2c4000
    buffer_load_dword v154, v3, s[40:43], s59 offen
    s_add_u32 s59, s77, 0x2c6000
    buffer_load_dword v155, v3, s[40:43], s59 offen
    s_add_u32 s59, s77, 0x2c8000
    buffer_load_dword v156, v3, s[40:43], s59 offen
    s_add_u32 s59, s77, 0x2ca000
    buffer_load_dword v157, v3, s[40:43], s59 offen
    s_add_u32 s59, s77, 0x2cc000
    buffer_load_dword v158, v3, s[40:43], s59 offen
    s_add_u32 s59, s77, 0x2ce000
    buffer_load_dword v159, v3, s[40:43], s59 offen
    s_waitcnt vmcnt(56)
    v_perm_b32 v4, v161, v160, s66
    v_accvgpr_write_b32 a32, v4
    v_perm_b32 v5, v161, v160, s67
    v_accvgpr_write_b32 a36, v5
    v_perm_b32 v4, v163, v162, s66
    v_accvgpr_write_b32 a33, v4
    v_perm_b32 v5, v163, v162, s67
    v_accvgpr_write_b32 a37, v5
    v_perm_b32 v4, v165, v164, s66
    v_accvgpr_write_b32 a34, v4
    v_perm_b32 v5, v165, v164, s67
    v_accvgpr_write_b32 a38, v5
    v_perm_b32 v4, v167, v166, s66
    v_accvgpr_write_b32 a35, v4
    v_perm_b32 v5, v167, v166, s67
    v_accvgpr_write_b32 a39, v5
    s_add_u32 s59, s77, 0x300000
    buffer_load_dword v160, v3, s[40:43], s59 offen
    s_add_u32 s59, s77, 0x302000
    buffer_load_dword v161, v3, s[40:43], s59 offen
    s_add_u32 s59, s77, 0x304000
    buffer_load_dword v162, v3, s[40:43], s59 offen
    s_add_u32 s59, s77, 0x306000
    buffer_load_dword v163, v3, s[40:43], s59 offen
    s_add_u32 s59, s77, 0x308000
    buffer_load_dword v164, v3, s[40:43], s59 offen
    s_add_u32 s59, s77, 0x30a000
    buffer_load_dword v165, v3, s[40:43], s59 offen
    s_add_u32 s59, s77, 0x30c000
    buffer_load_dword v166, v3, s[40:43], s59 offen
    s_add_u32 s59, s77, 0x30e000
    buffer_load_dword v167, v3, s[40:43], s59 offen
    s_waitcnt vmcnt(56)
    v_perm_b32 v4, v169, v168, s66
    v_accvgpr_write_b32 a40, v4
    v_perm_b32 v5, v169, v168, s67
    v_accvgpr_write_b32 a44, v5
    v_perm_b32 v4, v171, v170, s66
    v_accvgpr_write_b32 a41, v4
    v_perm_b32 v5, v171, v170, s67
    v_accvgpr_write_b32 a45, v5
    v_perm_b32 v4, v173, v172, s66
    v_accvgpr_write_b32 a42, v4
    v_perm_b32 v5, v173, v172, s67
    v_accvgpr_write_b32 a46, v5
    v_perm_b32 v4, v175, v174, s66
    v_accvgpr_write_b32 a43, v4
    v_perm_b32 v5, v175, v174, s67
    v_accvgpr_write_b32 a47, v5
    s_add_u32 s59, s77, 0x340000
    buffer_load_dword v168, v3, s[40:43], s59 offen
    s_add_u32 s59, s77, 0x342000
    buffer_load_dword v169, v3, s[40:43], s59 offen
    s_add_u32 s59, s77, 0x344000
    buffer_load_dword v170, v3, s[40:43], s59 offen
    s_add_u32 s59, s77, 0x346000
    buffer_load_dword v171, v3, s[40:43], s59 offen
    s_add_u32 s59, s77, 0x348000
    buffer_load_dword v172, v3, s[40:43], s59 offen
    s_add_u32 s59, s77, 0x34a000
    buffer_load_dword v173, v3, s[40:43], s59 offen
    s_add_u32 s59, s77, 0x34c000
    buffer_load_dword v174, v3, s[40:43], s59 offen
    s_add_u32 s59, s77, 0x34e000
    buffer_load_dword v175, v3, s[40:43], s59 offen
    s_waitcnt vmcnt(56)
    v_perm_b32 v4, v177, v176, s66
    v_accvgpr_write_b32 a48, v4
    v_perm_b32 v5, v177, v176, s67
    v_accvgpr_write_b32 a52, v5
    v_perm_b32 v4, v179, v178, s66
    v_accvgpr_write_b32 a49, v4
    v_perm_b32 v5, v179, v178, s67
    v_accvgpr_write_b32 a53, v5
    v_perm_b32 v4, v181, v180, s66
    v_accvgpr_write_b32 a50, v4
    v_perm_b32 v5, v181, v180, s67
    v_accvgpr_write_b32 a54, v5
    v_perm_b32 v4, v183, v182, s66
    v_accvgpr_write_b32 a51, v4
    v_perm_b32 v5, v183, v182, s67
    v_accvgpr_write_b32 a55, v5
    s_add_u32 s59, s77, 0x380000
    buffer_load_dword v176, v3, s[40:43], s59 offen
    s_add_u32 s59, s77, 0x382000
    buffer_load_dword v177, v3, s[40:43], s59 offen
    s_add_u32 s59, s77, 0x384000
    buffer_load_dword v178, v3, s[40:43], s59 offen
    s_add_u32 s59, s77, 0x386000
    buffer_load_dword v179, v3, s[40:43], s59 offen
    s_add_u32 s59, s77, 0x388000
    buffer_load_dword v180, v3, s[40:43], s59 offen
    s_add_u32 s59, s77, 0x38a000
    buffer_load_dword v181, v3, s[40:43], s59 offen
    s_add_u32 s59, s77, 0x38c000
    buffer_load_dword v182, v3, s[40:43], s59 offen
    s_add_u32 s59, s77, 0x38e000
    buffer_load_dword v183, v3, s[40:43], s59 offen
    s_waitcnt vmcnt(56)
    v_perm_b32 v4, v185, v184, s66
    v_accvgpr_write_b32 a56, v4
    v_perm_b32 v5, v185, v184, s67
    v_accvgpr_write_b32 a60, v5
    v_perm_b32 v4, v187, v186, s66
    v_accvgpr_write_b32 a57, v4
    v_perm_b32 v5, v187, v186, s67
    v_accvgpr_write_b32 a61, v5
    v_perm_b32 v4, v189, v188, s66
    v_accvgpr_write_b32 a58, v4
    v_perm_b32 v5, v189, v188, s67
    v_accvgpr_write_b32 a62, v5
    v_perm_b32 v4, v191, v190, s66
    v_accvgpr_write_b32 a59, v4
    v_perm_b32 v5, v191, v190, s67
    v_accvgpr_write_b32 a63, v5
    s_add_u32 s59, s77, 0x3c0000
    buffer_load_dword v184, v3, s[40:43], s59 offen
    s_add_u32 s59, s77, 0x3c2000
    buffer_load_dword v185, v3, s[40:43], s59 offen
    s_add_u32 s59, s77, 0x3c4000
    buffer_load_dword v186, v3, s[40:43], s59 offen
    s_add_u32 s59, s77, 0x3c6000
    buffer_load_dword v187, v3, s[40:43], s59 offen
    s_add_u32 s59, s77, 0x3c8000
    buffer_load_dword v188, v3, s[40:43], s59 offen
    s_add_u32 s59, s77, 0x3ca000
    buffer_load_dword v189, v3, s[40:43], s59 offen
    s_add_u32 s59, s77, 0x3cc000
    buffer_load_dword v190, v3, s[40:43], s59 offen
    s_add_u32 s59, s77, 0x3ce000
    buffer_load_dword v191, v3, s[40:43], s59 offen
    s_waitcnt vmcnt(56)
    v_perm_b32 v4, v129, v128, s66
    v_accvgpr_write_b32 a64, v4
    v_perm_b32 v5, v129, v128, s67
    v_accvgpr_write_b32 a68, v5
    v_perm_b32 v4, v131, v130, s66
    v_accvgpr_write_b32 a65, v4
    v_perm_b32 v5, v131, v130, s67
    v_accvgpr_write_b32 a69, v5
    v_perm_b32 v4, v133, v132, s66
    v_accvgpr_write_b32 a66, v4
    v_perm_b32 v5, v133, v132, s67
    v_accvgpr_write_b32 a70, v5
    v_perm_b32 v4, v135, v134, s66
    v_accvgpr_write_b32 a67, v4
    v_perm_b32 v5, v135, v134, s67
    v_accvgpr_write_b32 a71, v5
    s_add_u32 s59, s77, 0x0
    buffer_load_dword v128, v3, s[44:47], s59 offen
    s_add_u32 s59, s77, 0x2000
    buffer_load_dword v129, v3, s[44:47], s59 offen
    s_add_u32 s59, s77, 0x4000
    buffer_load_dword v130, v3, s[44:47], s59 offen
    s_add_u32 s59, s77, 0x6000
    buffer_load_dword v131, v3, s[44:47], s59 offen
    s_add_u32 s59, s77, 0x8000
    buffer_load_dword v132, v3, s[44:47], s59 offen
    s_add_u32 s59, s77, 0xa000
    buffer_load_dword v133, v3, s[44:47], s59 offen
    s_add_u32 s59, s77, 0xc000
    buffer_load_dword v134, v3, s[44:47], s59 offen
    s_add_u32 s59, s77, 0xe000
    buffer_load_dword v135, v3, s[44:47], s59 offen
    s_waitcnt vmcnt(56)
    v_perm_b32 v4, v137, v136, s66
    v_accvgpr_write_b32 a72, v4
    v_perm_b32 v5, v137, v136, s67
    v_accvgpr_write_b32 a76, v5
    v_perm_b32 v4, v139, v138, s66
    v_accvgpr_write_b32 a73, v4
    v_perm_b32 v5, v139, v138, s67
    v_accvgpr_write_b32 a77, v5
    v_perm_b32 v4, v141, v140, s66
    v_accvgpr_write_b32 a74, v4
    v_perm_b32 v5, v141, v140, s67
    v_accvgpr_write_b32 a78, v5
    v_perm_b32 v4, v143, v142, s66
    v_accvgpr_write_b32 a75, v4
    v_perm_b32 v5, v143, v142, s67
    v_accvgpr_write_b32 a79, v5
    s_add_u32 s59, s77, 0x40000
    buffer_load_dword v136, v3, s[44:47], s59 offen
    s_add_u32 s59, s77, 0x42000
    buffer_load_dword v137, v3, s[44:47], s59 offen
    s_add_u32 s59, s77, 0x44000
    buffer_load_dword v138, v3, s[44:47], s59 offen
    s_add_u32 s59, s77, 0x46000
    buffer_load_dword v139, v3, s[44:47], s59 offen
    s_add_u32 s59, s77, 0x48000
    buffer_load_dword v140, v3, s[44:47], s59 offen
    s_add_u32 s59, s77, 0x4a000
    buffer_load_dword v141, v3, s[44:47], s59 offen
    s_add_u32 s59, s77, 0x4c000
    buffer_load_dword v142, v3, s[44:47], s59 offen
    s_add_u32 s59, s77, 0x4e000
    buffer_load_dword v143, v3, s[44:47], s59 offen
    s_waitcnt vmcnt(56)
    v_perm_b32 v4, v145, v144, s66
    v_accvgpr_write_b32 a80, v4
    v_perm_b32 v5, v145, v144, s67
    v_accvgpr_write_b32 a84, v5
    v_perm_b32 v4, v147, v146, s66
    v_accvgpr_write_b32 a81, v4
    v_perm_b32 v5, v147, v146, s67
    v_accvgpr_write_b32 a85, v5
    v_perm_b32 v4, v149, v148, s66
    v_accvgpr_write_b32 a82, v4
    v_perm_b32 v5, v149, v148, s67
    v_accvgpr_write_b32 a86, v5
    v_perm_b32 v4, v151, v150, s66
    v_accvgpr_write_b32 a83, v4
    v_perm_b32 v5, v151, v150, s67
    v_accvgpr_write_b32 a87, v5
    s_add_u32 s59, s77, 0x80000
    buffer_load_dword v144, v3, s[44:47], s59 offen
    s_add_u32 s59, s77, 0x82000
    buffer_load_dword v145, v3, s[44:47], s59 offen
    s_add_u32 s59, s77, 0x84000
    buffer_load_dword v146, v3, s[44:47], s59 offen
    s_add_u32 s59, s77, 0x86000
    buffer_load_dword v147, v3, s[44:47], s59 offen
    s_add_u32 s59, s77, 0x88000
    buffer_load_dword v148, v3, s[44:47], s59 offen
    s_add_u32 s59, s77, 0x8a000
    buffer_load_dword v149, v3, s[44:47], s59 offen
    s_add_u32 s59, s77, 0x8c000
    buffer_load_dword v150, v3, s[44:47], s59 offen
    s_add_u32 s59, s77, 0x8e000
    buffer_load_dword v151, v3, s[44:47], s59 offen
    s_waitcnt vmcnt(56)
    v_perm_b32 v4, v153, v152, s66
    v_accvgpr_write_b32 a88, v4
    v_perm_b32 v5, v153, v152, s67
    v_accvgpr_write_b32 a92, v5
    v_perm_b32 v4, v155, v154, s66
    v_accvgpr_write_b32 a89, v4
    v_perm_b32 v5, v155, v154, s67
    v_accvgpr_write_b32 a93, v5
    v_perm_b32 v4, v157, v156, s66
    v_accvgpr_write_b32 a90, v4
    v_perm_b32 v5, v157, v156, s67
    v_accvgpr_write_b32 a94, v5
    v_perm_b32 v4, v159, v158, s66
    v_accvgpr_write_b32 a91, v4
    v_perm_b32 v5, v159, v158, s67
    v_accvgpr_write_b32 a95, v5
    s_add_u32 s59, s77, 0xc0000
    buffer_load_dword v152, v3, s[44:47], s59 offen
    s_add_u32 s59, s77, 0xc2000
    buffer_load_dword v153, v3, s[44:47], s59 offen
    s_add_u32 s59, s77, 0xc4000
    buffer_load_dword v154, v3, s[44:47], s59 offen
    s_add_u32 s59, s77, 0xc6000
    buffer_load_dword v155, v3, s[44:47], s59 offen
    s_add_u32 s59, s77, 0xc8000
    buffer_load_dword v156, v3, s[44:47], s59 offen
    s_add_u32 s59, s77, 0xca000
    buffer_load_dword v157, v3, s[44:47], s59 offen
    s_add_u32 s59, s77, 0xcc000
    buffer_load_dword v158, v3, s[44:47], s59 offen
    s_add_u32 s59, s77, 0xce000
    buffer_load_dword v159, v3, s[44:47], s59 offen
    s_waitcnt vmcnt(56)
    v_perm_b32 v4, v161, v160, s66
    v_accvgpr_write_b32 a96, v4
    v_perm_b32 v5, v161, v160, s67
    v_accvgpr_write_b32 a100, v5
    v_perm_b32 v4, v163, v162, s66
    v_accvgpr_write_b32 a97, v4
    v_perm_b32 v5, v163, v162, s67
    v_accvgpr_write_b32 a101, v5
    v_perm_b32 v4, v165, v164, s66
    v_accvgpr_write_b32 a98, v4
    v_perm_b32 v5, v165, v164, s67
    v_accvgpr_write_b32 a102, v5
    v_perm_b32 v4, v167, v166, s66
    v_accvgpr_write_b32 a99, v4
    v_perm_b32 v5, v167, v166, s67
    v_accvgpr_write_b32 a103, v5
    s_add_u32 s59, s77, 0x100000
    buffer_load_dword v160, v3, s[44:47], s59 offen
    s_add_u32 s59, s77, 0x102000
    buffer_load_dword v161, v3, s[44:47], s59 offen
    s_add_u32 s59, s77, 0x104000
    buffer_load_dword v162, v3, s[44:47], s59 offen
    s_add_u32 s59, s77, 0x106000
    buffer_load_dword v163, v3, s[44:47], s59 offen
    s_add_u32 s59, s77, 0x108000
    buffer_load_dword v164, v3, s[44:47], s59 offen
    s_add_u32 s59, s77, 0x10a000
    buffer_load_dword v165, v3, s[44:47], s59 offen
    s_add_u32 s59, s77, 0x10c000
    buffer_load_dword v166, v3, s[44:47], s59 offen
    s_add_u32 s59, s77, 0x10e000
    buffer_load_dword v167, v3, s[44:47], s59 offen
    s_waitcnt vmcnt(56)
    v_perm_b32 v4, v169, v168, s66
    v_accvgpr_write_b32 a104, v4
    v_perm_b32 v5, v169, v168, s67
    v_accvgpr_write_b32 a108, v5
    v_perm_b32 v4, v171, v170, s66
    v_accvgpr_write_b32 a105, v4
    v_perm_b32 v5, v171, v170, s67
    v_accvgpr_write_b32 a109, v5
    v_perm_b32 v4, v173, v172, s66
    v_accvgpr_write_b32 a106, v4
    v_perm_b32 v5, v173, v172, s67
    v_accvgpr_write_b32 a110, v5
    v_perm_b32 v4, v175, v174, s66
    v_accvgpr_write_b32 a107, v4
    v_perm_b32 v5, v175, v174, s67
    v_accvgpr_write_b32 a111, v5
    s_add_u32 s59, s77, 0x140000
    buffer_load_dword v168, v3, s[44:47], s59 offen
    s_add_u32 s59, s77, 0x142000
    buffer_load_dword v169, v3, s[44:47], s59 offen
    s_add_u32 s59, s77, 0x144000
    buffer_load_dword v170, v3, s[44:47], s59 offen
    s_add_u32 s59, s77, 0x146000
    buffer_load_dword v171, v3, s[44:47], s59 offen
    s_add_u32 s59, s77, 0x148000
    buffer_load_dword v172, v3, s[44:47], s59 offen
    s_add_u32 s59, s77, 0x14a000
    buffer_load_dword v173, v3, s[44:47], s59 offen
    s_add_u32 s59, s77, 0x14c000
    buffer_load_dword v174, v3, s[44:47], s59 offen
    s_add_u32 s59, s77, 0x14e000
    buffer_load_dword v175, v3, s[44:47], s59 offen
    s_waitcnt vmcnt(56)
    v_perm_b32 v4, v177, v176, s66
    v_accvgpr_write_b32 a112, v4
    v_perm_b32 v5, v177, v176, s67
    v_accvgpr_write_b32 a116, v5
    v_perm_b32 v4, v179, v178, s66
    v_accvgpr_write_b32 a113, v4
    v_perm_b32 v5, v179, v178, s67
    v_accvgpr_write_b32 a117, v5
    v_perm_b32 v4, v181, v180, s66
    v_accvgpr_write_b32 a114, v4
    v_perm_b32 v5, v181, v180, s67
    v_accvgpr_write_b32 a118, v5
    v_perm_b32 v4, v183, v182, s66
    v_accvgpr_write_b32 a115, v4
    v_perm_b32 v5, v183, v182, s67
    v_accvgpr_write_b32 a119, v5
    s_add_u32 s59, s77, 0x180000
    buffer_load_dword v176, v3, s[44:47], s59 offen
    s_add_u32 s59, s77, 0x182000
    buffer_load_dword v177, v3, s[44:47], s59 offen
    s_add_u32 s59, s77, 0x184000
    buffer_load_dword v178, v3, s[44:47], s59 offen
    s_add_u32 s59, s77, 0x186000
    buffer_load_dword v179, v3, s[44:47], s59 offen
    s_add_u32 s59, s77, 0x188000
    buffer_load_dword v180, v3, s[44:47], s59 offen
    s_add_u32 s59, s77, 0x18a000
    buffer_load_dword v181, v3, s[44:47], s59 offen
    s_add_u32 s59, s77, 0x18c000
    buffer_load_dword v182, v3, s[44:47], s59 offen
    s_add_u32 s59, s77, 0x18e000
    buffer_load_dword v183, v3, s[44:47], s59 offen
    s_waitcnt vmcnt(56)
    v_perm_b32 v4, v185, v184, s66
    v_accvgpr_write_b32 a120, v4
    v_perm_b32 v5, v185, v184, s67
    v_accvgpr_write_b32 a124, v5
    v_perm_b32 v4, v187, v186, s66
    v_accvgpr_write_b32 a121, v4
    v_perm_b32 v5, v187, v186, s67
    v_accvgpr_write_b32 a125, v5
    v_perm_b32 v4, v189, v188, s66
    v_accvgpr_write_b32 a122, v4
    v_perm_b32 v5, v189, v188, s67
    v_accvgpr_write_b32 a126, v5
    v_perm_b32 v4, v191, v190, s66
    v_accvgpr_write_b32 a123, v4
    v_perm_b32 v5, v191, v190, s67
    v_accvgpr_write_b32 a127, v5
    s_add_u32 s59, s77, 0x1c0000
    buffer_load_dword v184, v3, s[44:47], s59 offen
    s_add_u32 s59, s77, 0x1c2000
    buffer_load_dword v185, v3, s[44:47], s59 offen
    s_add_u32 s59, s77, 0x1c4000
    buffer_load_dword v186, v3, s[44:47], s59 offen
    s_add_u32 s59, s77, 0x1c6000
    buffer_load_dword v187, v3, s[44:47], s59 offen
    s_add_u32 s59, s77, 0x1c8000
    buffer_load_dword v188, v3, s[44:47], s59 offen
    s_add_u32 s59, s77, 0x1ca000
    buffer_load_dword v189, v3, s[44:47], s59 offen
    s_add_u32 s59, s77, 0x1cc000
    buffer_load_dword v190, v3, s[44:47], s59 offen
    s_add_u32 s59, s77, 0x1ce000
    buffer_load_dword v191, v3, s[44:47], s59 offen
    s_waitcnt vmcnt(56)
    v_perm_b32 v4, v129, v128, s66
    v_accvgpr_write_b32 a128, v4
    v_perm_b32 v5, v129, v128, s67
    v_accvgpr_write_b32 a132, v5
    v_perm_b32 v4, v131, v130, s66
    v_accvgpr_write_b32 a129, v4
    v_perm_b32 v5, v131, v130, s67
    v_accvgpr_write_b32 a133, v5
    v_perm_b32 v4, v133, v132, s66
    v_accvgpr_write_b32 a130, v4
    v_perm_b32 v5, v133, v132, s67
    v_accvgpr_write_b32 a134, v5
    v_perm_b32 v4, v135, v134, s66
    v_accvgpr_write_b32 a131, v4
    v_perm_b32 v5, v135, v134, s67
    v_accvgpr_write_b32 a135, v5
    s_add_u32 s59, s77, 0x200000
    buffer_load_dword v128, v3, s[44:47], s59 offen
    s_add_u32 s59, s77, 0x202000
    buffer_load_dword v129, v3, s[44:47], s59 offen
    s_add_u32 s59, s77, 0x204000
    buffer_load_dword v130, v3, s[44:47], s59 offen
    s_add_u32 s59, s77, 0x206000
    buffer_load_dword v131, v3, s[44:47], s59 offen
    s_add_u32 s59, s77, 0x208000
    buffer_load_dword v132, v3, s[44:47], s59 offen
    s_add_u32 s59, s77, 0x20a000
    buffer_load_dword v133, v3, s[44:47], s59 offen
    s_add_u32 s59, s77, 0x20c000
    buffer_load_dword v134, v3, s[44:47], s59 offen
    s_add_u32 s59, s77, 0x20e000
    buffer_load_dword v135, v3, s[44:47], s59 offen
    s_waitcnt vmcnt(56)
    v_perm_b32 v4, v137, v136, s66
    v_accvgpr_write_b32 a136, v4
    v_perm_b32 v5, v137, v136, s67
    v_accvgpr_write_b32 a140, v5
    v_perm_b32 v4, v139, v138, s66
    v_accvgpr_write_b32 a137, v4
    v_perm_b32 v5, v139, v138, s67
    v_accvgpr_write_b32 a141, v5
    v_perm_b32 v4, v141, v140, s66
    v_accvgpr_write_b32 a138, v4
    v_perm_b32 v5, v141, v140, s67
    v_accvgpr_write_b32 a142, v5
    v_perm_b32 v4, v143, v142, s66
    v_accvgpr_write_b32 a139, v4
    v_perm_b32 v5, v143, v142, s67
    v_accvgpr_write_b32 a143, v5
    s_add_u32 s59, s77, 0x240000
    buffer_load_dword v136, v3, s[44:47], s59 offen
    s_add_u32 s59, s77, 0x242000
    buffer_load_dword v137, v3, s[44:47], s59 offen
    s_add_u32 s59, s77, 0x244000
    buffer_load_dword v138, v3, s[44:47], s59 offen
    s_add_u32 s59, s77, 0x246000
    buffer_load_dword v139, v3, s[44:47], s59 offen
    s_add_u32 s59, s77, 0x248000
    buffer_load_dword v140, v3, s[44:47], s59 offen
    s_add_u32 s59, s77, 0x24a000
    buffer_load_dword v141, v3, s[44:47], s59 offen
    s_add_u32 s59, s77, 0x24c000
    buffer_load_dword v142, v3, s[44:47], s59 offen
    s_add_u32 s59, s77, 0x24e000
    buffer_load_dword v143, v3, s[44:47], s59 offen
    s_waitcnt vmcnt(56)
    v_perm_b32 v4, v145, v144, s66
    v_accvgpr_write_b32 a144, v4
    v_perm_b32 v5, v145, v144, s67
    v_accvgpr_write_b32 a148, v5
    v_perm_b32 v4, v147, v146, s66
    v_accvgpr_write_b32 a145, v4
    v_perm_b32 v5, v147, v146, s67
    v_accvgpr_write_b32 a149, v5
    v_perm_b32 v4, v149, v148, s66
    v_accvgpr_write_b32 a146, v4
    v_perm_b32 v5, v149, v148, s67
    v_accvgpr_write_b32 a150, v5
    v_perm_b32 v4, v151, v150, s66
    v_accvgpr_write_b32 a147, v4
    v_perm_b32 v5, v151, v150, s67
    v_accvgpr_write_b32 a151, v5
    s_add_u32 s59, s77, 0x280000
    buffer_load_dword v144, v3, s[44:47], s59 offen
    s_add_u32 s59, s77, 0x282000
    buffer_load_dword v145, v3, s[44:47], s59 offen
    s_add_u32 s59, s77, 0x284000
    buffer_load_dword v146, v3, s[44:47], s59 offen
    s_add_u32 s59, s77, 0x286000
    buffer_load_dword v147, v3, s[44:47], s59 offen
    s_add_u32 s59, s77, 0x288000
    buffer_load_dword v148, v3, s[44:47], s59 offen
    s_add_u32 s59, s77, 0x28a000
    buffer_load_dword v149, v3, s[44:47], s59 offen
    s_add_u32 s59, s77, 0x28c000
    buffer_load_dword v150, v3, s[44:47], s59 offen
    s_add_u32 s59, s77, 0x28e000
    buffer_load_dword v151, v3, s[44:47], s59 offen
    s_waitcnt vmcnt(56)
    v_perm_b32 v4, v153, v152, s66
    v_accvgpr_write_b32 a152, v4
    v_perm_b32 v5, v153, v152, s67
    v_accvgpr_write_b32 a156, v5
    v_perm_b32 v4, v155, v154, s66
    v_accvgpr_write_b32 a153, v4
    v_perm_b32 v5, v155, v154, s67
    v_accvgpr_write_b32 a157, v5
    v_perm_b32 v4, v157, v156, s66
    v_accvgpr_write_b32 a154, v4
    v_perm_b32 v5, v157, v156, s67
    v_accvgpr_write_b32 a158, v5
    v_perm_b32 v4, v159, v158, s66
    v_accvgpr_write_b32 a155, v4
    v_perm_b32 v5, v159, v158, s67
    v_accvgpr_write_b32 a159, v5
    s_add_u32 s59, s77, 0x2c0000
    buffer_load_dword v152, v3, s[44:47], s59 offen
    s_add_u32 s59, s77, 0x2c2000
    buffer_load_dword v153, v3, s[44:47], s59 offen
    s_add_u32 s59, s77, 0x2c4000
    buffer_load_dword v154, v3, s[44:47], s59 offen
    s_add_u32 s59, s77, 0x2c6000
    buffer_load_dword v155, v3, s[44:47], s59 offen
    s_add_u32 s59, s77, 0x2c8000
    buffer_load_dword v156, v3, s[44:47], s59 offen
    s_add_u32 s59, s77, 0x2ca000
    buffer_load_dword v157, v3, s[44:47], s59 offen
    s_add_u32 s59, s77, 0x2cc000
    buffer_load_dword v158, v3, s[44:47], s59 offen
    s_add_u32 s59, s77, 0x2ce000
    buffer_load_dword v159, v3, s[44:47], s59 offen
    s_waitcnt vmcnt(56)
    v_perm_b32 v4, v161, v160, s66
    v_accvgpr_write_b32 a160, v4
    v_perm_b32 v5, v161, v160, s67
    v_accvgpr_write_b32 a164, v5
    v_perm_b32 v4, v163, v162, s66
    v_accvgpr_write_b32 a161, v4
    v_perm_b32 v5, v163, v162, s67
    v_accvgpr_write_b32 a165, v5
    v_perm_b32 v4, v165, v164, s66
    v_accvgpr_write_b32 a162, v4
    v_perm_b32 v5, v165, v164, s67
    v_accvgpr_write_b32 a166, v5
    v_perm_b32 v4, v167, v166, s66
    v_accvgpr_write_b32 a163, v4
    v_perm_b32 v5, v167, v166, s67
    v_accvgpr_write_b32 a167, v5
    s_add_u32 s59, s77, 0x300000
    buffer_load_dword v160, v3, s[44:47], s59 offen
    s_add_u32 s59, s77, 0x302000
    buffer_load_dword v161, v3, s[44:47], s59 offen
    s_add_u32 s59, s77, 0x304000
    buffer_load_dword v162, v3, s[44:47], s59 offen
    s_add_u32 s59, s77, 0x306000
    buffer_load_dword v163, v3, s[44:47], s59 offen
    s_add_u32 s59, s77, 0x308000
    buffer_load_dword v164, v3, s[44:47], s59 offen
    s_add_u32 s59, s77, 0x30a000
    buffer_load_dword v165, v3, s[44:47], s59 offen
    s_add_u32 s59, s77, 0x30c000
    buffer_load_dword v166, v3, s[44:47], s59 offen
    s_add_u32 s59, s77, 0x30e000
    buffer_load_dword v167, v3, s[44:47], s59 offen
    s_waitcnt vmcnt(56)
    v_perm_b32 v4, v169, v168, s66
    v_accvgpr_write_b32 a168, v4
    v_perm_b32 v5, v169, v168, s67
    v_accvgpr_write_b32 a172, v5
    v_perm_b32 v4, v171, v170, s66
    v_accvgpr_write_b32 a169, v4
    v_perm_b32 v5, v171, v170, s67
    v_accvgpr_write_b32 a173, v5
    v_perm_b32 v4, v173, v172, s66
    v_accvgpr_write_b32 a170, v4
    v_perm_b32 v5, v173, v172, s67
    v_accvgpr_write_b32 a174, v5
    v_perm_b32 v4, v175, v174, s66
    v_accvgpr_write_b32 a171, v4
    v_perm_b32 v5, v175, v174, s67
    v_accvgpr_write_b32 a175, v5
    s_add_u32 s59, s77, 0x340000
    buffer_load_dword v168, v3, s[44:47], s59 offen
    s_add_u32 s59, s77, 0x342000
    buffer_load_dword v169, v3, s[44:47], s59 offen
    s_add_u32 s59, s77, 0x344000
    buffer_load_dword v170, v3, s[44:47], s59 offen
    s_add_u32 s59, s77, 0x346000
    buffer_load_dword v171, v3, s[44:47], s59 offen
    s_add_u32 s59, s77, 0x348000
    buffer_load_dword v172, v3, s[44:47], s59 offen
    s_add_u32 s59, s77, 0x34a000
    buffer_load_dword v173, v3, s[44:47], s59 offen
    s_add_u32 s59, s77, 0x34c000
    buffer_load_dword v174, v3, s[44:47], s59 offen
    s_add_u32 s59, s77, 0x34e000
    buffer_load_dword v175, v3, s[44:47], s59 offen
    s_waitcnt vmcnt(56)
    v_perm_b32 v4, v177, v176, s66
    v_accvgpr_write_b32 a176, v4
    v_perm_b32 v5, v177, v176, s67
    v_accvgpr_write_b32 a180, v5
    v_perm_b32 v4, v179, v178, s66
    v_accvgpr_write_b32 a177, v4
    v_perm_b32 v5, v179, v178, s67
    v_accvgpr_write_b32 a181, v5
    v_perm_b32 v4, v181, v180, s66
    v_accvgpr_write_b32 a178, v4
    v_perm_b32 v5, v181, v180, s67
    v_accvgpr_write_b32 a182, v5
    v_perm_b32 v4, v183, v182, s66
    v_accvgpr_write_b32 a179, v4
    v_perm_b32 v5, v183, v182, s67
    v_accvgpr_write_b32 a183, v5
    s_add_u32 s59, s77, 0x380000
    buffer_load_dword v176, v3, s[44:47], s59 offen
    s_add_u32 s59, s77, 0x382000
    buffer_load_dword v177, v3, s[44:47], s59 offen
    s_add_u32 s59, s77, 0x384000
    buffer_load_dword v178, v3, s[44:47], s59 offen
    s_add_u32 s59, s77, 0x386000
    buffer_load_dword v179, v3, s[44:47], s59 offen
    s_add_u32 s59, s77, 0x388000
    buffer_load_dword v180, v3, s[44:47], s59 offen
    s_add_u32 s59, s77, 0x38a000
    buffer_load_dword v181, v3, s[44:47], s59 offen
    s_add_u32 s59, s77, 0x38c000
    buffer_load_dword v182, v3, s[44:47], s59 offen
    s_add_u32 s59, s77, 0x38e000
    buffer_load_dword v183, v3, s[44:47], s59 offen
    s_waitcnt vmcnt(56)
    v_perm_b32 v4, v185, v184, s66
    v_accvgpr_write_b32 a184, v4
    v_perm_b32 v5, v185, v184, s67
    v_accvgpr_write_b32 a188, v5
    v_perm_b32 v4, v187, v186, s66
    v_accvgpr_write_b32 a185, v4
    v_perm_b32 v5, v187, v186, s67
    v_accvgpr_write_b32 a189, v5
    v_perm_b32 v4, v189, v188, s66
    v_accvgpr_write_b32 a186, v4
    v_perm_b32 v5, v189, v188, s67
    v_accvgpr_write_b32 a190, v5
    v_perm_b32 v4, v191, v190, s66
    v_accvgpr_write_b32 a187, v4
    v_perm_b32 v5, v191, v190, s67
    v_accvgpr_write_b32 a191, v5
    s_add_u32 s59, s77, 0x3c0000
    buffer_load_dword v184, v3, s[44:47], s59 offen
    s_add_u32 s59, s77, 0x3c2000
    buffer_load_dword v185, v3, s[44:47], s59 offen
    s_add_u32 s59, s77, 0x3c4000
    buffer_load_dword v186, v3, s[44:47], s59 offen
    s_add_u32 s59, s77, 0x3c6000
    buffer_load_dword v187, v3, s[44:47], s59 offen
    s_add_u32 s59, s77, 0x3c8000
    buffer_load_dword v188, v3, s[44:47], s59 offen
    s_add_u32 s59, s77, 0x3ca000
    buffer_load_dword v189, v3, s[44:47], s59 offen
    s_add_u32 s59, s77, 0x3cc000
    buffer_load_dword v190, v3, s[44:47], s59 offen
    s_add_u32 s59, s77, 0x3ce000
    buffer_load_dword v191, v3, s[44:47], s59 offen
    s_waitcnt vmcnt(56)
    v_perm_b32 v4, v129, v128, s66
    v_accvgpr_write_b32 a192, v4
    v_perm_b32 v5, v129, v128, s67
    v_accvgpr_write_b32 a196, v5
    v_perm_b32 v4, v131, v130, s66
    v_accvgpr_write_b32 a193, v4
    v_perm_b32 v5, v131, v130, s67
    v_accvgpr_write_b32 a197, v5
    v_perm_b32 v4, v133, v132, s66
    v_accvgpr_write_b32 a194, v4
    v_perm_b32 v5, v133, v132, s67
    v_accvgpr_write_b32 a198, v5
    v_perm_b32 v4, v135, v134, s66
    v_accvgpr_write_b32 a195, v4
    v_perm_b32 v5, v135, v134, s67
    v_accvgpr_write_b32 a199, v5
    s_waitcnt vmcnt(48)
    v_perm_b32 v4, v137, v136, s66
    v_accvgpr_write_b32 a200, v4
    v_perm_b32 v5, v137, v136, s67
    v_accvgpr_write_b32 a204, v5
    v_perm_b32 v4, v139, v138, s66
    v_accvgpr_write_b32 a201, v4
    v_perm_b32 v5, v139, v138, s67
    v_accvgpr_write_b32 a205, v5
    v_perm_b32 v4, v141, v140, s66
    v_accvgpr_write_b32 a202, v4
    v_perm_b32 v5, v141, v140, s67
    v_accvgpr_write_b32 a206, v5
    v_perm_b32 v4, v143, v142, s66
    v_accvgpr_write_b32 a203, v4
    v_perm_b32 v5, v143, v142, s67
    v_accvgpr_write_b32 a207, v5
    s_waitcnt vmcnt(40)
    v_perm_b32 v4, v145, v144, s66
    v_accvgpr_write_b32 a208, v4
    v_perm_b32 v5, v145, v144, s67
    v_accvgpr_write_b32 a212, v5
    v_perm_b32 v4, v147, v146, s66
    v_accvgpr_write_b32 a209, v4
    v_perm_b32 v5, v147, v146, s67
    v_accvgpr_write_b32 a213, v5
    v_perm_b32 v4, v149, v148, s66
    v_accvgpr_write_b32 a210, v4
    v_perm_b32 v5, v149, v148, s67
    v_accvgpr_write_b32 a214, v5
    v_perm_b32 v4, v151, v150, s66
    v_accvgpr_write_b32 a211, v4
    v_perm_b32 v5, v151, v150, s67
    v_accvgpr_write_b32 a215, v5
    s_waitcnt vmcnt(32)
    v_perm_b32 v4, v153, v152, s66
    v_accvgpr_write_b32 a216, v4
    v_perm_b32 v5, v153, v152, s67
    v_accvgpr_write_b32 a220, v5
    v_perm_b32 v4, v155, v154, s66
    v_accvgpr_write_b32 a217, v4
    v_perm_b32 v5, v155, v154, s67
    v_accvgpr_write_b32 a221, v5
    v_perm_b32 v4, v157, v156, s66
    v_accvgpr_write_b32 a218, v4
    v_perm_b32 v5, v157, v156, s67
    v_accvgpr_write_b32 a222, v5
    v_perm_b32 v4, v159, v158, s66
    v_accvgpr_write_b32 a219, v4
    v_perm_b32 v5, v159, v158, s67
    v_accvgpr_write_b32 a223, v5
    s_waitcnt vmcnt(24)
    v_perm_b32 v4, v161, v160, s66
    v_accvgpr_write_b32 a224, v4
    v_perm_b32 v5, v161, v160, s67
    v_accvgpr_write_b32 a228, v5
    v_perm_b32 v4, v163, v162, s66
    v_accvgpr_write_b32 a225, v4
    v_perm_b32 v5, v163, v162, s67
    v_accvgpr_write_b32 a229, v5
    v_perm_b32 v4, v165, v164, s66
    v_accvgpr_write_b32 a226, v4
    v_perm_b32 v5, v165, v164, s67
    v_accvgpr_write_b32 a230, v5
    v_perm_b32 v4, v167, v166, s66
    v_accvgpr_write_b32 a227, v4
    v_perm_b32 v5, v167, v166, s67
    v_accvgpr_write_b32 a231, v5
    s_waitcnt vmcnt(16)
    v_perm_b32 v4, v169, v168, s66
    v_accvgpr_write_b32 a232, v4
    v_perm_b32 v5, v169, v168, s67
    v_accvgpr_write_b32 a236, v5
    v_perm_b32 v4, v171, v170, s66
    v_accvgpr_write_b32 a233, v4
    v_perm_b32 v5, v171, v170, s67
    v_accvgpr_write_b32 a237, v5
    v_perm_b32 v4, v173, v172, s66
    v_accvgpr_write_b32 a234, v4
    v_perm_b32 v5, v173, v172, s67
    v_accvgpr_write_b32 a238, v5
    v_perm_b32 v4, v175, v174, s66
    v_accvgpr_write_b32 a235, v4
    v_perm_b32 v5, v175, v174, s67
    v_accvgpr_write_b32 a239, v5
    s_waitcnt vmcnt(8)
    v_perm_b32 v4, v177, v176, s66
    v_accvgpr_write_b32 a240, v4
    v_perm_b32 v5, v177, v176, s67
    v_accvgpr_write_b32 a244, v5
    v_perm_b32 v4, v179, v178, s66
    v_accvgpr_write_b32 a241, v4
    v_perm_b32 v5, v179, v178, s67
    v_accvgpr_write_b32 a245, v5
    v_perm_b32 v4, v181, v180, s66
    v_accvgpr_write_b32 a242, v4
    v_perm_b32 v5, v181, v180, s67
    v_accvgpr_write_b32 a246, v5
    v_perm_b32 v4, v183, v182, s66
    v_accvgpr_write_b32 a243, v4
    v_perm_b32 v5, v183, v182, s67
    v_accvgpr_write_b32 a247, v5
    s_waitcnt vmcnt(0)
    v_perm_b32 v4, v185, v184, s66
    v_accvgpr_write_b32 a248, v4
    v_perm_b32 v5, v185, v184, s67
    v_accvgpr_write_b32 a252, v5
    v_perm_b32 v4, v187, v186, s66
    v_accvgpr_write_b32 a249, v4
    v_perm_b32 v5, v187, v186, s67
    v_accvgpr_write_b32 a253, v5
    v_perm_b32 v4, v189, v188, s66
    v_accvgpr_write_b32 a250, v4
    v_perm_b32 v5, v189, v188, s67
    v_accvgpr_write_b32 a254, v5
    v_perm_b32 v4, v191, v190, s66
    v_accvgpr_write_b32 a251, v4
    v_perm_b32 v5, v191, v190, s67
    v_accvgpr_write_b32 a255, v5
    s_barrier
    s_and_b32 s59, s57, 1
    s_lshl_b32 s60, s59, 7
    v_xor_b32 v2, s60, v1
    v_and_b32 v11, 15, v0
    v_lshrrev_b32 v10, 4, v0
    v_xor_b32 v10, v10, v11
    v_lshlrev_b32 v10, 4, v10
    v_lshl_or_b32 v11, v11, 10, v10
    v_xor_b32 v4, 0, v11
    v_xor_b32 v5, 64, v11
    v_xor_b32 v6, 128, v11
    v_xor_b32 v7, 192, v11
    v_xor_b32 v11, 0x4000, v7
    v_xor_b32 v10, 0x4000, v6
    v_xor_b32 v9, 0x4000, v5
    v_xor_b32 v8, 0x4000, v4
    s_lshl_b32 s59, s56, 7
    s_add_u32 s59, s59, 0x628000
    s_lshl_b32 s60, s91, 12
    s_add_u32 s59, s59, s60
    v_mov_b32 v22, s59
    s_lshl_b32 s77, s56, 13
    s_lshl_b32 s59, s57, 11
    s_add_u32 s77, s77, s59
    s_add_u32 s77, s77, 0x1000000
    v_lshrrev_b32 v23, 4, v0
    v_lshlrev_b32 v23, 9, v23
    v_and_b32 v20, 15, v0
    v_lshl_add_u32 v23, v20, 4, v23
    s_lshl_b32 s58, s91, 4
    s_add_u32 s92, s58, 16
    s_mov_b32 s87, 0
    s_mov_b32 s72, 0
    v_mov_b32 v24, 0
    s_nop 1
Lrdy_32:
    global_load_dword v20, v24, s[32:33] offset:4 sc1
    s_waitcnt vmcnt(0)
    v_cmp_ne_u32 vcc, 0, v20
    s_nop 0
    s_cmp_eq_u64 vcc, exec
    s_nop 1
    s_cbranch_scc0 Lrdy_32
    s_mov_b32 s74, 8
    s_cmp_lg_u32 s87, 0
    s_cbranch_scc1 Hok_33
    s_cmp_ge_u32 s74, 8
    s_cbranch_scc1 Hall_34
    s_and_b32 s59, s74, 7
    s_lshl_b32 s59, s59, 10
    s_add_u32 s59, s59, 0x610800
    v_and_b32 v24, 7, v0
    v_lshlrev_b32 v24, 7, v24
    v_add_u32 v24, s59, v24
    s_mov_b32 s61, 1
    s_nop 0
Lw_35:
    buffer_load_dword v20, v24, s[36:39], 0 offen sc1
    s_waitcnt vmcnt(0)
    v_cmp_le_u32 vcc, s61, v20
    s_nop 0
    s_cmp_eq_u64 vcc, exec
    s_nop 1
    s_cbranch_scc1 Lwd_36
    s_sleep 1
    s_branch Lw_35
Lwd_36:
    s_branch Hok_33
Hall_34:
    v_lshlrev_b32 v24, 7, v0
    v_add_u32 v24, 0x610800, v24
    s_mov_b32 s61, 8
    s_nop 0
Lw_37:
    buffer_load_dword v20, v24, s[36:39], 0 offen sc1
    s_waitcnt vmcnt(0)
    v_cmp_le_u32 vcc, s61, v20
    s_nop 0
    s_cmp_eq_u64 vcc, exec
    s_nop 1
    s_cbranch_scc1 Lwd_38
    s_sleep 1
    s_branch Lw_37
Lwd_38:
    s_mov_b32 s87, 1
Hok_33:
    s_lshl_b32 s75, s58, 15
    s_add_u32 s75, s75, 0x0
    s_lshl_b32 s59, s57, 13
    s_add_u32 s60, s59, s75
    s_add_u32 s59, s59, s72
    s_mov_b32 m0, s59
    v_xor_b32 v20, 0, v2
    buffer_load_dwordx4 v20, s[36:39], s60 offen offset:0 sc1 lds
    v_xor_b32 v21, 16, v2
    buffer_load_dwordx4 v21, s[36:39], s60 offen offset:1024 sc1 lds
    v_xor_b32 v20, 32, v2
    buffer_load_dwordx4 v20, s[36:39], s60 offen offset:2048 sc1 lds
    v_xor_b32 v21, 48, v2
    buffer_load_dwordx4 v21, s[36:39], s60 offen offset:3072 sc1 lds
    s_add_u32 s59, s59, 4096
    s_add_u32 s60, s60, 4096
    s_mov_b32 m0, s59
    v_xor_b32 v20, 64, v2
    buffer_load_dwordx4 v20, s[36:39], s60 offen offset:0 sc1 lds
    v_xor_b32 v21, 80, v2
    buffer_load_dwordx4 v21, s[36:39], s60 offen offset:1024 sc1 lds
    v_xor_b32 v20, 96, v2
    buffer_load_dwordx4 v20, s[36:39], s60 offen offset:2048 sc1 lds
    v_xor_b32 v21, 112, v2
    buffer_load_dwordx4 v21, s[36:39], s60 offen offset:3072 sc1 lds
    s_waitcnt vmcnt(0)
KVtop_39:
    s_barrier
    v_add_u32 v12, s72, v4
    v_add_u32 v13, s72, v5
    v_add_u32 v14, s72, v6
    v_add_u32 v15, s72, v7
    v_add_u32 v16, s72, v8
    v_add_u32 v17, s72, v9
    v_add_u32 v18, s72, v10
    v_add_u32 v19, s72, v11
    ds_read_b128 v[32:35], v12 offset:0
    ds_read_b128 v[36:39], v16 offset:0
    ds_read_b128 v[40:43], v13 offset:0
    ds_read_b128 v[44:47], v17 offset:0
    ds_read_b128 v[48:51], v14 offset:0
    ds_read_b128 v[52:55], v18 offset:0
    ds_read_b128 v[56:59], v15 offset:0
    ds_read_b128 v[60:63], v19 offset:0
    s_waitcnt lgkmcnt(6)
    v_mfma_f32_16x16x32_bf16 v[64:67], a[0:3], v[32:35], 0
    v_mfma_f32_16x16x32_bf16 v[80:83], v[32:35], a[128:131], 0
    v_mfma_f32_16x16x32_bf16 v[68:71], a[0:3], v[36:39], 0
    v_mfma_f32_16x16x32_bf16 v[84:87], v[36:39], a[128:131], 0
    v_mfma_f32_16x16x32_bf16 v[72:75], a[4:7], v[32:35], 0
    v_mfma_f32_16x16x32_bf16 v[88:91], v[32:35], a[132:135], 0
    v_mfma_f32_16x16x32_bf16 v[76:79], a[4:7], v[36:39], 0
    v_mfma_f32_16x16x32_bf16 v[92:95], v[36:39], a[132:135], 0
    ds_read_b128 v[32:35], v12 offset:256
    ds_read_b128 v[36:39], v16 offset:256
    s_waitcnt lgkmcnt(6)
    v_mfma_f32_16x16x32_bf16 v[64:67], a[8:11], v[40:43], v[64:67]
    v_mfma_f32_16x16x32_bf16 v[80:83], v[40:43], a[136:139], v[80:83]
    v_mfma_f32_16x16x32_bf16 v[68:71], a[8:11], v[44:47], v[68:71]
    v_mfma_f32_16x16x32_bf16 v[84:87], v[44:47], a[136:139], v[84:87]
    v_mfma_f32_16x16x32_bf16 v[72:75], a[12:15], v[40:43], v[72:75]
    v_mfma_f32_16x16x32_bf16 v[88:91], v[40:43], a[140:143], v[88:91]
    v_mfma_f32_16x16x32_bf16 v[76:79], a[12:15], v[44:47], v[76:79]
    v_mfma_f32_16x16x32_bf16 v[92:95], v[44:47], a[140:143], v[92:95]
    ds_read_b128 v[40:43], v13 offset:256
    ds_read_b128 v[44:47], v17 offset:256
    s_waitcnt lgkmcnt(6)
    v_mfma_f32_16x16x32_bf16 v[64:67], a[16:19], v[48:51], v[64:67]
    v_mfma_f32_16x16x32_bf16 v[80:83], v[48:51], a[144:147], v[80:83]
    v_mfma_f32_16x16x32_bf16 v[68:71], a[16:19], v[52:55], v[68:71]
    v_mfma_f32_16x16x32_bf16 v[84:87], v[52:55], a[144:147], v[84:87]
    v_mfma_f32_16x16x32_bf16 v[72:75], a[20:23], v[48:51], v[72:75]
    v_mfma_f32_16x16x32_bf16 v[88:91], v[48:51], a[148:151], v[88:91]
    v_mfma_f32_16x16x32_bf16 v[76:79], a[20:23], v[52:55], v[76:79]
    v_mfma_f32_16x16x32_bf16 v[92:95], v[52:55], a[148:151], v[92:95]
    ds_read_b128 v[48:51], v14 offset:256
    ds_read_b128 v[52:55], v18 offset:256
    s_waitcnt lgkmcnt(6)
    v_mfma_f32_16x16x32_bf16 v[64:67], a[24:27], v[56:59], v[64:67]
    v_mfma_f32_16x16x32_bf16 v[80:83], v[56:59], a[152:155], v[80:83]
    v_mfma_f32_16x16x32_bf16 v[68:71], a[24:27], v[60:63], v[68:71]
    v_mfma_f32_16x16x32_bf16 v[84:87], v[60:63], a[152:155], v[84:87]
    v_mfma_f32_16x16x32_bf16 v[72:75], a[28:31], v[56:59], v[72:75]
    v_mfma_f32_16x16x32_bf16 v[88:91], v[56:59], a[156:159], v[88:91]
    v_mfma_f32_16x16x32_bf16 v[76:79], a[28:31], v[60:63], v[76:79]
    v_mfma_f32_16x16x32_bf16 v[92:95], v[60:63], a[156:159], v[92:95]
    ds_read_b128 v[56:59], v15 offset:256
    ds_read_b128 v[60:63], v19 offset:256
    s_waitcnt lgkmcnt(6)
    v_mfma_f32_16x16x32_bf16 v[64:67], a[32:35], v[32:35], v[64:67]
    v_mfma_f32_16x16x32_bf16 v[80:83], v[32:35], a[160:163], v[80:83]
    v_mfma_f32_16x16x32_bf16 v[68:71], a[32:35], v[36:39], v[68:71]
    v_mfma_f32_16x16x32_bf16 v[84:87], v[36:39], a[160:163], v[84:87]
    v_mfma_f32_16x16x32_bf16 v[72:75], a[36:39], v[32:35], v[72:75]
    v_mfma_f32_16x16x32_bf16 v[88:91], v[32:35], a[164:167], v[88:91]
    v_mfma_f32_16x16x32_bf16 v[76:79], a[36:39], v[36:39], v[76:79]
    v_mfma_f32_16x16x32_bf16 v[92:95], v[36:39], a[164:167], v[92:95]
    ds_read_b128 v[32:35], v12 offset:512
    ds_read_b128 v[36:39], v16 offset:512
    s_waitcnt lgkmcnt(6)
    v_mfma_f32_16x16x32_bf16 v[64:67], a[40:43], v[40:43], v[64:67]
    v_mfma_f32_16x16x32_bf16 v[80:83], v[40:43], a[168:171], v[80:83]
    v_mfma_f32_16x16x32_bf16 v[68:71], a[40:43], v[44:47], v[68:71]
    v_mfma_f32_16x16x32_bf16 v[84:87], v[44:47], a[168:171], v[84:87]
    v_mfma_f32_16x16x32_bf16 v[72:75], a[44:47], v[40:43], v[72:75]
    v_mfma_f32_16x16x32_bf16 v[88:91], v[40:43], a[172:175], v[88:91]
    v_mfma_f32_16x16x32_bf16 v[76:79], a[44:47], v[44:47], v[76:79]
    v_mfma_f32_16x16x32_bf16 v[92:95], v[44:47], a[172:175], v[92:95]
    s_waitcnt vmcnt(0)
    s_barrier
    s_cmp_lg_u32 s57, 0
    s_nop 3
    s_cbranch_scc1 KVpub_41
    v_mov_b32 v20, s58
    s_mov_b64 exec, 1
    buffer_store_dword v20, v22, s[36:39], 0 offen sc1
    s_mov_b64 exec, -1
KVpub_41:
    s_add_u32 s74, s58, 1
    s_cmp_ge_u32 s74, s92
    s_cbranch_scc1 KVnopf_40
    s_cmp_lg_u32 s87, 0
    s_cbranch_scc1 Hok_42
    s_cmp_ge_u32 s74, 8
    s_cbranch_scc1 Hall_43
    s_and_b32 s59, s74, 7
    s_lshl_b32 s59, s59, 10
    s_add_u32 s59, s59, 0x610800
    v_and_b32 v24, 7, v0
    v_lshlrev_b32 v24, 7, v24
    v_add_u32 v24, s59, v24
    s_mov_b32 s61, 1
    s_nop 0
Lw_44:
    buffer_load_dword v20, v24, s[36:39], 0 offen sc1
    s_waitcnt vmcnt(0)
    v_cmp_le_u32 vcc, s61, v20
    s_nop 0
    s_cmp_eq_u64 vcc, exec
    s_nop 1
    s_cbranch_scc1 Lwd_45
    s_sleep 1
    s_branch Lw_44
Lwd_45:
    s_branch Hok_42
Hall_43:
    v_lshlrev_b32 v24, 7, v0
    v_add_u32 v24, 0x610800, v24
    s_mov_b32 s61, 8
    s_nop 0
Lw_46:
    buffer_load_dword v20, v24, s[36:39], 0 offen sc1
    s_waitcnt vmcnt(0)
    v_cmp_le_u32 vcc, s61, v20
    s_nop 0
    s_cmp_eq_u64 vcc, exec
    s_nop 1
    s_cbranch_scc1 Lwd_47
    s_sleep 1
    s_branch Lw_46
Lwd_47:
    s_mov_b32 s87, 1
Hok_42:
    s_lshl_b32 s75, s74, 15
    s_add_u32 s75, s75, 0x0
    s_xor_b32 s76, s72, 32768
    s_lshl_b32 s59, s57, 13
    s_add_u32 s60, s59, s75
    s_add_u32 s59, s59, s76
    s_mov_b32 m0, s59
    v_xor_b32 v20, 0, v2
    buffer_load_dwordx4 v20, s[36:39], s60 offen offset:0 sc1 lds
    v_xor_b32 v21, 16, v2
    buffer_load_dwordx4 v21, s[36:39], s60 offen offset:1024 sc1 lds
    v_xor_b32 v20, 32, v2
    buffer_load_dwordx4 v20, s[36:39], s60 offen offset:2048 sc1 lds
    v_xor_b32 v21, 48, v2
    buffer_load_dwordx4 v21, s[36:39], s60 offen offset:3072 sc1 lds
    s_add_u32 s59, s59, 4096
    s_add_u32 s60, s60, 4096
    s_mov_b32 m0, s59
    v_xor_b32 v20, 64, v2
    buffer_load_dwordx4 v20, s[36:39], s60 offen offset:0 sc1 lds
    v_xor_b32 v21, 80, v2
    buffer_load_dwordx4 v21, s[36:39], s60 offen offset:1024 sc1 lds
    v_xor_b32 v20, 96, v2
    buffer_load_dwordx4 v20, s[36:39], s60 offen offset:2048 sc1 lds
    v_xor_b32 v21, 112, v2
    buffer_load_dwordx4 v21, s[36:39], s60 offen offset:3072 sc1 lds
    s_nop 0
KVnopf_40:
    ds_read_b128 v[40:43], v13 offset:512
    ds_read_b128 v[44:47], v17 offset:512
    s_waitcnt lgkmcnt(6)
    v_mfma_f32_16x16x32_bf16 v[64:67], a[48:51], v[48:51], v[64:67]
    v_mfma_f32_16x16x32_bf16 v[80:83], v[48:51], a[176:179], v[80:83]
    v_mfma_f32_16x16x32_bf16 v[68:71], a[48:51], v[52:55], v[68:71]
    v_mfma_f32_16x16x32_bf16 v[84:87], v[52:55], a[176:179], v[84:87]
    v_mfma_f32_16x16x32_bf16 v[72:75], a[52:55], v[48:51], v[72:75]
    v_mfma_f32_16x16x32_bf16 v[88:91], v[48:51], a[180:183], v[88:91]
    v_mfma_f32_16x16x32_bf16 v[76:79], a[52:55], v[52:55], v[76:79]
    v_mfma_f32_16x16x32_bf16 v[92:95], v[52:55], a[180:183], v[92:95]
    ds_read_b128 v[48:51], v14 offset:512
    ds_read_b128 v[52:55], v18 offset:512
    s_waitcnt lgkmcnt(6)
    v_mfma_f32_16x16x32_bf16 v[64:67], a[56:59], v[56:59], v[64:67]
    v_mfma_f32_16x16x32_bf16 v[80:83], v[56:59], a[184:187], v[80:83]
    v_mfma_f32_16x16x32_bf16 v[68:71], a[56:59], v[60:63], v[68:71]
    v_mfma_f32_16x16x32_bf16 v[84:87], v[60:63], a[184:187], v[84:87]
    v_mfma_f32_16x16x32_bf16 v[72:75], a[60:63], v[56:59], v[72:75]
    v_mfma_f32_16x16x32_bf16 v[88:91], v[56:59], a[188:191], v[88:91]
    v_mfma_f32_16x16x32_bf16 v[76:79], a[60:63], v[60:63], v[76:79]
    v_mfma_f32_16x16x32_bf16 v[92:95], v[60:63], a[188:191], v[92:95]
    ds_read_b128 v[56:59], v15 offset:512
    ds_read_b128 v[60:63], v19 offset:512
    s_waitcnt lgkmcnt(6)
    v_mfma_f32_16x16x32_bf16 v[64:67], a[64:67], v[32:35], v[64:67]
    v_mfma_f32_16x16x32_bf16 v[80:83], v[32:35], a[192:195], v[80:83]
    v_mfma_f32_16x16x32_bf16 v[68:71], a[64:67], v[36:39], v[68:71]
    v_mfma_f32_16x16x32_bf16 v[84:87], v[36:39], a[192:195], v[84:87]
    v_mfma_f32_16x16x32_bf16 v[72:75], a[68:71], v[32:35], v[72:75]
    v_mfma_f32_16x16x32_bf16 v[88:91], v[32:35], a[196:199], v[88:91]
    v_mfma_f32_16x16x32_bf16 v[76:79], a[68:71], v[36:39], v[76:79]
    v_mfma_f32_16x16x32_bf16 v[92:95], v[36:39], a[196:199], v[92:95]
    ds_read_b128 v[32:35], v12 offset:768
    ds_read_b128 v[36:39], v16 offset:768
    s_waitcnt lgkmcnt(6)
    v_mfma_f32_16x16x32_bf16 v[64:67], a[72:75], v[40:43], v[64:67]
    v_mfma_f32_16x16x32_bf16 v[80:83], v[40:43], a[200:203], v[80:83]
    v_mfma_f32_16x16x32_bf16 v[68:71], a[72:75], v[44:47], v[68:71]
    v_mfma_f32_16x16x32_bf16 v[84:87], v[44:47], a[200:203], v[84:87]
    v_mfma_f32_16x16x32_bf16 v[72:75], a[76:79], v[40:43], v[72:75]
    v_mfma_f32_16x16x32_bf16 v[88:91], v[40:43], a[204:207], v[88:91]
    v_mfma_f32_16x16x32_bf16 v[76:79], a[76:79], v[44:47], v[76:79]
    v_mfma_f32_16x16x32_bf16 v[92:95], v[44:47], a[204:207], v[92:95]
    ds_read_b128 v[40:43], v13 offset:768
    ds_read_b128 v[44:47], v17 offset:768
    s_waitcnt lgkmcnt(6)
    v_mfma_f32_16x16x32_bf16 v[64:67], a[80:83], v[48:51], v[64:67]
    v_mfma_f32_16x16x32_bf16 v[80:83], v[48:51], a[208:211], v[80:83]
    v_mfma_f32_16x16x32_bf16 v[68:71], a[80:83], v[52:55], v[68:71]
    v_mfma_f32_16x16x32_bf16 v[84:87], v[52:55], a[208:211], v[84:87]
    v_mfma_f32_16x16x32_bf16 v[72:75], a[84:87], v[48:51], v[72:75]
    v_mfma_f32_16x16x32_bf16 v[88:91], v[48:51], a[212:215], v[88:91]
    v_mfma_f32_16x16x32_bf16 v[76:79], a[84:87], v[52:55], v[76:79]
    v_mfma_f32_16x16x32_bf16 v[92:95], v[52:55], a[212:215], v[92:95]
    ds_read_b128 v[48:51], v14 offset:768
    ds_read_b128 v[52:55], v18 offset:768
    s_waitcnt lgkmcnt(6)
    v_mfma_f32_16x16x32_bf16 v[64:67], a[88:91], v[56:59], v[64:67]
    v_mfma_f32_16x16x32_bf16 v[80:83], v[56:59], a[216:219], v[80:83]
    v_mfma_f32_16x16x32_bf16 v[68:71], a[88:91], v[60:63], v[68:71]
    v_mfma_f32_16x16x32_bf16 v[84:87], v[60:63], a[216:219], v[84:87]
    v_mfma_f32_16x16x32_bf16 v[72:75], a[92:95], v[56:59], v[72:75]
    v_mfma_f32_16x16x32_bf16 v[88:91], v[56:59], a[220:223], v[88:91]
    v_mfma_f32_16x16x32_bf16 v[76:79], a[92:95], v[60:63], v[76:79]
    v_mfma_f32_16x16x32_bf16 v[92:95], v[60:63], a[220:223], v[92:95]
    ds_read_b128 v[56:59], v15 offset:768
    ds_read_b128 v[60:63], v19 offset:768
    s_waitcnt lgkmcnt(6)
    v_mfma_f32_16x16x32_bf16 v[64:67], a[96:99], v[32:35], v[64:67]
    v_mfma_f32_16x16x32_bf16 v[80:83], v[32:35], a[224:227], v[80:83]
    v_mfma_f32_16x16x32_bf16 v[68:71], a[96:99], v[36:39], v[68:71]
    v_mfma_f32_16x16x32_bf16 v[84:87], v[36:39], a[224:227], v[84:87]
    v_mfma_f32_16x16x32_bf16 v[72:75], a[100:103], v[32:35], v[72:75]
    v_mfma_f32_16x16x32_bf16 v[88:91], v[32:35], a[228:231], v[88:91]
    v_mfma_f32_16x16x32_bf16 v[76:79], a[100:103], v[36:39], v[76:79]
    v_mfma_f32_16x16x32_bf16 v[92:95], v[36:39], a[228:231], v[92:95]
    s_waitcnt lgkmcnt(4)
    v_mfma_f32_16x16x32_bf16 v[64:67], a[104:107], v[40:43], v[64:67]
    v_mfma_f32_16x16x32_bf16 v[80:83], v[40:43], a[232:235], v[80:83]
    v_mfma_f32_16x16x32_bf16 v[68:71], a[104:107], v[44:47], v[68:71]
    v_mfma_f32_16x16x32_bf16 v[84:87], v[44:47], a[232:235], v[84:87]
    v_mfma_f32_16x16x32_bf16 v[72:75], a[108:111], v[40:43], v[72:75]
    v_mfma_f32_16x16x32_bf16 v[88:91], v[40:43], a[236:239], v[88:91]
    v_mfma_f32_16x16x32_bf16 v[76:79], a[108:111], v[44:47], v[76:79]
    v_mfma_f32_16x16x32_bf16 v[92:95], v[44:47], a[236:239], v[92:95]
    s_waitcnt lgkmcnt(2)
    v_mfma_f32_16x16x32_bf16 v[64:67], a[112:115], v[48:51], v[64:67]
    v_mfma_f32_16x16x32_bf16 v[80:83], v[48:51], a[240:243], v[80:83]
    v_mfma_f32_16x16x32_bf16 v[68:71], a[112:115], v[52:55], v[68:71]
    v_mfma_f32_16x16x32_bf16 v[84:87], v[52:55], a[240:243], v[84:87]
    v_mfma_f32_16x16x32_bf16 v[72:75], a[116:119], v[48:51], v[72:75]
    v_mfma_f32_16x16x32_bf16 v[88:91], v[48:51], a[244:247], v[88:91]
    v_mfma_f32_16x16x32_bf16 v[76:79], a[116:119], v[52:55], v[76:79]
    v_mfma_f32_16x16x32_bf16 v[92:95], v[52:55], a[244:247], v[92:95]
    s_waitcnt lgkmcnt(0)
    v_mfma_f32_16x16x32_bf16 v[64:67], a[120:123], v[56:59], v[64:67]
    v_mfma_f32_16x16x32_bf16 v[80:83], v[56:59], a[248:251], v[80:83]
    v_mfma_f32_16x16x32_bf16 v[68:71], a[120:123], v[60:63], v[68:71]
    v_mfma_f32_16x16x32_bf16 v[84:87], v[60:63], a[248:251], v[84:87]
    v_mfma_f32_16x16x32_bf16 v[72:75], a[124:127], v[56:59], v[72:75]
    v_mfma_f32_16x16x32_bf16 v[88:91], v[56:59], a[252:255], v[88:91]
    v_mfma_f32_16x16x32_bf16 v[76:79], a[124:127], v[60:63], v[76:79]
    v_mfma_f32_16x16x32_bf16 v[92:95], v[60:63], a[252:255], v[92:95]
    s_lshl_b32 s59, s58, 18
    s_add_u32 s59, s59, s77
    s_add_u32 s60, s59, 0x1000000
    s_nop 1
    v_cvt_pk_bf16_f32 v96, v64, v72
    v_cvt_pk_bf16_f32 v97, v65, v73
    v_cvt_pk_bf16_f32 v98, v66, v74
    v_cvt_pk_bf16_f32 v99, v67, v75
    buffer_store_dwordx4 v[96:99], v23, s[36:39], s59 offen offset:0 sc1
    v_cvt_pk_bf16_f32 v100, v68, v76
    v_cvt_pk_bf16_f32 v101, v69, v77
    v_cvt_pk_bf16_f32 v102, v70, v78
    v_cvt_pk_bf16_f32 v103, v71, v79
    buffer_store_dwordx4 v[100:103], v23, s[36:39], s59 offen offset:256 sc1
    v_cvt_pk_bf16_f32 v104, v80, v81
    v_cvt_pk_bf16_f32 v105, v82, v83
    v_cvt_pk_bf16_f32 v106, v84, v85
    v_cvt_pk_bf16_f32 v107, v86, v87
    buffer_store_dwordx4 v[104:107], v1, s[36:39], s60 offen offset:0 sc1
    v_cvt_pk_bf16_f32 v108, v88, v89
    v_cvt_pk_bf16_f32 v109, v90, v91
    v_cvt_pk_bf16_f32 v110, v92, v93
    v_cvt_pk_bf16_f32 v111, v94, v95
    buffer_store_dwordx4 v[108:111], v1, s[36:39], s60 offen offset:1024 sc1
    s_xor_b32 s72, s72, 32768
    s_add_u32 s58, s58, 1
    s_cmp_gt_u32 s58, 2
    s_cbranch_scc1 KVq_48
    s_waitcnt vmcnt(0)
    s_barrier
    s_cmp_lg_u32 s57, 0
    s_cbranch_scc1 KVq_48
    v_mov_b32 v20, s58
    s_mov_b64 exec, 1
    buffer_store_dword v20, v22, s[36:39], 0 offen sc1
    s_mov_b64 exec, -1
KVq_48:
    s_waitcnt vmcnt(4)
    s_cmp_lt_u32 s58, s92
    s_cbranch_scc1 KVtop_39
    s_waitcnt vmcnt(0)
    s_barrier
    s_cmp_lg_u32 s57, 0
    s_cbranch_scc1 KVpub_50
    v_mov_b32 v20, s58
    s_mov_b64 exec, 1
    buffer_store_dword v20, v22, s[36:39], 0 offen sc1
    s_mov_b64 exec, -1
KVpub_50:
    s_waitcnt vmcnt(0) lgkmcnt(0)
    s_barrier
    s_add_u32 s90, s91, 1
    s_branch Lpost_31
Lx3_6:
    s_add_u32 s56, s56, 32
Lx2_5:
    s_mov_b32 s40, s8
    s_and_b32 s41, s9, 0xffff
    s_mov_b32 s42, 0x400000
    s_mov_b32 s43, 0x20000
    s_lshr_b32 s78, s56, 1
    v_bfe_u32 v5, v0, 2, 2
    v_lshlrev_b32 v5, 3, v5
    v_lshrrev_b32 v3, 4, v0
    v_add_u32 v5, v5, v3
    s_mov_b32 s59, 8192
    v_mul_lo_u32 v3, v5, s59
    v_and_b32 v5, 3, v0
    v_lshl_add_u32 v3, v5, 4, v3
    s_lshl_b32 s79, s57, 15
    v_lshlrev_b32 v4, 2, v0
    v_add_u32 v4, s79, v4
    s_lshl_b32 s77, s78, 8
    s_lshl_b32 s59, s57, 6
    s_add_u32 s77, s77, s59
    s_add_u32 s60, s79, 0
    s_mov_b32 m0, s60
    s_add_u32 s59, s77, 0x0
    buffer_load_dwordx4 v3, s[40:43], s59 offen lds
    s_add_u32 s60, s60, 1024
    s_mov_b32 m0, s60
    s_add_u32 s59, s77, 0x8000
    buffer_load_dwordx4 v3, s[40:43], s59 offen lds
    s_add_u32 s60, s60, 1024
    s_mov_b32 m0, s60
    s_add_u32 s59, s77, 0x40000
    buffer_load_dwordx4 v3, s[40:43], s59 offen lds
    s_add_u32 s60, s60, 1024
    s_mov_b32 m0, s60
    s_add_u32 s59, s77, 0x48000
    buffer_load_dwordx4 v3, s[40:43], s59 offen lds
    s_add_u32 s60, s79, 4096
    s_mov_b32 m0, s60
    s_add_u32 s59, s77, 0x80000
    buffer_load_dwordx4 v3, s[40:43], s59 offen lds
    s_add_u32 s60, s60, 1024
    s_mov_b32 m0, s60
    s_add_u32 s59, s77, 0x88000
    buffer_load_dwordx4 v3, s[40:43], s59 offen lds
    s_add_u32 s60, s60, 1024
    s_mov_b32 m0, s60
    s_add_u32 s59, s77, 0xc0000
    buffer_load_dwordx4 v3, s[40:43], s59 offen lds
    s_add_u32 s60, s60, 1024
    s_mov_b32 m0, s60
    s_add_u32 s59, s77, 0xc8000
    buffer_load_dwordx4 v3, s[40:43], s59 offen lds
    s_add_u32 s60, s79, 8192
    s_mov_b32 m0, s60
    s_add_u32 s59, s77, 0x100000
    buffer_load_dwordx4 v3, s[40:43], s59 offen lds
    s_add_u32 s60, s60, 1024
    s_mov_b32 m0, s60
    s_add_u32 s59, s77, 0x108000
    buffer_load_dwordx4 v3, s[40:43], s59 offen lds
    s_add_u32 s60, s60, 1024
    s_mov_b32 m0, s60
    s_add_u32 s59, s77, 0x140000
    buffer_load_dwordx4 v3, s[40:43], s59 offen lds
    s_add_u32 s60, s60, 1024
    s_mov_b32 m0, s60
    s_add_u32 s59, s77, 0x148000
    buffer_load_dwordx4 v3, s[40:43], s59 offen lds
    s_add_u32 s60, s79, 12288
    s_mov_b32 m0, s60
    s_add_u32 s59, s77, 0x180000
    buffer_load_dwordx4 v3, s[40:43], s59 offen lds
    s_add_u32 s60, s60, 1024
    s_mov_b32 m0, s60
    s_add_u32 s59, s77, 0x188000
    buffer_load_dwordx4 v3, s[40:43], s59 offen lds
    s_add_u32 s60, s60, 1024
    s_mov_b32 m0, s60
    s_add_u32 s59, s77, 0x1c0000
    buffer_load_dwordx4 v3, s[40:43], s59 offen lds
    s_add_u32 s60, s60, 1024
    s_mov_b32 m0, s60
    s_add_u32 s59, s77, 0x1c8000
    buffer_load_dwordx4 v3, s[40:43], s59 offen lds
    s_add_u32 s60, s79, 16384
    s_mov_b32 m0, s60
    s_add_u32 s59, s77, 0x200000
    buffer_load_dwordx4 v3, s[40:43], s59 offen lds
    s_add_u32 s60, s60, 1024
    s_mov_b32 m0, s60
    s_add_u32 s59, s77, 0x208000
    buffer_load_dwordx4 v3, s[40:43], s59 offen lds
    s_add_u32 s60, s60, 1024
    s_mov_b32 m0, s60
    s_add_u32 s59, s77, 0x240000
    buffer_load_dwordx4 v3, s[40:43], s59 offen lds
    s_add_u32 s60, s60, 1024
    s_mov_b32 m0, s60
    s_add_u32 s59, s77, 0x248000
    buffer_load_dwordx4 v3, s[40:43], s59 offen lds
    s_add_u32 s60, s79, 20480
    s_mov_b32 m0, s60
    s_add_u32 s59, s77, 0x280000
    buffer_load_dwordx4 v3, s[40:43], s59 offen lds
    s_add_u32 s60, s60, 1024
    s_mov_b32 m0, s60
    s_add_u32 s59, s77, 0x288000
    buffer_load_dwordx4 v3, s[40:43], s59 offen lds
    s_add_u32 s60, s60, 1024
    s_mov_b32 m0, s60
    s_add_u32 s59, s77, 0x2c0000
    buffer_load_dwordx4 v3, s[40:43], s59 offen lds
    s_add_u32 s60, s60, 1024
    s_mov_b32 m0, s60
    s_add_u32 s59, s77, 0x2c8000
    buffer_load_dwordx4 v3, s[40:43], s59 offen lds
    s_add_u32 s60, s79, 24576
    s_mov_b32 m0, s60
    s_add_u32 s59, s77, 0x300000
    buffer_load_dwordx4 v3, s[40:43], s59 offen lds
    s_add_u32 s60, s60, 1024
    s_mov_b32 m0, s60
    s_add_u32 s59, s77, 0x308000
    buffer_load_dwordx4 v3, s[40:43], s59 offen lds
    s_add_u32 s60, s60, 1024
    s_mov_b32 m0, s60
    s_add_u32 s59, s77, 0x340000
    buffer_load_dwordx4 v3, s[40:43], s59 offen lds
    s_add_u32 s60, s60, 1024
    s_mov_b32 m0, s60
    s_add_u32 s59, s77, 0x348000
    buffer_load_dwordx4 v3, s[40:43], s59 offen lds
    s_add_u32 s60, s79, 28672
    s_mov_b32 m0, s60
    s_add_u32 s59, s77, 0x380000
    buffer_load_dwordx4 v3, s[40:43], s59 offen lds
    s_add_u32 s60, s60, 1024
    s_mov_b32 m0, s60
    s_add_u32 s59, s77, 0x388000
    buffer_load_dwordx4 v3, s[40:43], s59 offen lds
    s_add_u32 s60, s60, 1024
    s_mov_b32 m0, s60
    s_add_u32 s59, s77, 0x3c0000
    buffer_load_dwordx4 v3, s[40:43], s59 offen lds
    s_add_u32 s60, s60, 1024
    s_mov_b32 m0, s60
    s_add_u32 s59, s77, 0x3c8000
    buffer_load_dwordx4 v3, s[40:43], s59 offen lds
    s_waitcnt vmcnt(28)
    ds_read2st64_b32 v[128:129], v4 offset0:0 offset1:1
    ds_read2st64_b32 v[130:131], v4 offset0:2 offset1:3
    ds_read2st64_b32 v[132:133], v4 offset0:4 offset1:5
    ds_read2st64_b32 v[134:135], v4 offset0:6 offset1:7
    ds_read2st64_b32 v[136:137], v4 offset0:8 offset1:9
    ds_read2st64_b32 v[138:139], v4 offset0:10 offset1:11
    ds_read2st64_b32 v[140:141], v4 offset0:12 offset1:13
    ds_read2st64_b32 v[142:143], v4 offset0:14 offset1:15
    s_waitcnt lgkmcnt(7)
    v_perm_b32 v6, v129, v128, s66
    v_accvgpr_write_b32 a0, v6
    v_perm_b32 v7, v129, v128, s67
    v_accvgpr_write_b32 a4, v7
    s_waitcnt lgkmcnt(6)
    v_perm_b32 v6, v131, v130, s66
    v_accvgpr_write_b32 a1, v6
    v_perm_b32 v7, v131, v130, s67
    v_accvgpr_write_b32 a5, v7
    s_waitcnt lgkmcnt(5)
    v_perm_b32 v6, v133, v132, s66
    v_accvgpr_write_b32 a2, v6
    v_perm_b32 v7, v133, v132, s67
    v_accvgpr_write_b32 a6, v7
    s_waitcnt lgkmcnt(4)
    v_perm_b32 v6, v135, v134, s66
    v_accvgpr_write_b32 a3, v6
    v_perm_b32 v7, v135, v134, s67
    v_accvgpr_write_b32 a7, v7
    s_waitcnt lgkmcnt(3)
    v_perm_b32 v6, v137, v136, s66
    v_accvgpr_write_b32 a8, v6
    v_perm_b32 v7, v137, v136, s67
    v_accvgpr_write_b32 a12, v7
    s_waitcnt lgkmcnt(2)
    v_perm_b32 v6, v139, v138, s66
    v_accvgpr_write_b32 a9, v6
    v_perm_b32 v7, v139, v138, s67
    v_accvgpr_write_b32 a13, v7
    s_waitcnt lgkmcnt(1)
    v_perm_b32 v6, v141, v140, s66
    v_accvgpr_write_b32 a10, v6
    v_perm_b32 v7, v141, v140, s67
    v_accvgpr_write_b32 a14, v7
    s_waitcnt lgkmcnt(0)
    v_perm_b32 v6, v143, v142, s66
    v_accvgpr_write_b32 a11, v6
    v_perm_b32 v7, v143, v142, s67
    v_accvgpr_write_b32 a15, v7
    s_waitcnt vmcnt(24)
    ds_read2st64_b32 v[128:129], v4 offset0:16 offset1:17
    ds_read2st64_b32 v[130:131], v4 offset0:18 offset1:19
    ds_read2st64_b32 v[132:133], v4 offset0:20 offset1:21
    ds_read2st64_b32 v[134:135], v4 offset0:22 offset1:23
    ds_read2st64_b32 v[136:137], v4 offset0:24 offset1:25
    ds_read2st64_b32 v[138:139], v4 offset0:26 offset1:27
    ds_read2st64_b32 v[140:141], v4 offset0:28 offset1:29
    ds_read2st64_b32 v[142:143], v4 offset0:30 offset1:31
    s_waitcnt lgkmcnt(7)
    v_perm_b32 v6, v129, v128, s66
    v_accvgpr_write_b32 a16, v6
    v_perm_b32 v7, v129, v128, s67
    v_accvgpr_write_b32 a20, v7
    s_waitcnt lgkmcnt(6)
    v_perm_b32 v6, v131, v130, s66
    v_accvgpr_write_b32 a17, v6
    v_perm_b32 v7, v131, v130, s67
    v_accvgpr_write_b32 a21, v7
    s_waitcnt lgkmcnt(5)
    v_perm_b32 v6, v133, v132, s66
    v_accvgpr_write_b32 a18, v6
    v_perm_b32 v7, v133, v132, s67
    v_accvgpr_write_b32 a22, v7
    s_waitcnt lgkmcnt(4)
    v_perm_b32 v6, v135, v134, s66
    v_accvgpr_write_b32 a19, v6
    v_perm_b32 v7, v135, v134, s67
    v_accvgpr_write_b32 a23, v7
    s_waitcnt lgkmcnt(3)
    v_perm_b32 v6, v137, v136, s66
    v_accvgpr_write_b32 a24, v6
    v_perm_b32 v7, v137, v136, s67
    v_accvgpr_write_b32 a28, v7
    s_waitcnt lgkmcnt(2)
    v_perm_b32 v6, v139, v138, s66
    v_accvgpr_write_b32 a25, v6
    v_perm_b32 v7, v139, v138, s67
    v_accvgpr_write_b32 a29, v7
    s_waitcnt lgkmcnt(1)
    v_perm_b32 v6, v141, v140, s66
    v_accvgpr_write_b32 a26, v6
    v_perm_b32 v7, v141, v140, s67
    v_accvgpr_write_b32 a30, v7
    s_waitcnt lgkmcnt(0)
    v_perm_b32 v6, v143, v142, s66
    v_accvgpr_write_b32 a27, v6
    v_perm_b32 v7, v143, v142, s67
    v_accvgpr_write_b32 a31, v7
    s_waitcnt vmcnt(20)
    ds_read2st64_b32 v[128:129], v4 offset0:32 offset1:33
    ds_read2st64_b32 v[130:131], v4 offset0:34 offset1:35
    ds_read2st64_b32 v[132:133], v4 offset0:36 offset1:37
    ds_read2st64_b32 v[134:135], v4 offset0:38 offset1:39
    ds_read2st64_b32 v[136:137], v4 offset0:40 offset1:41
    ds_read2st64_b32 v[138:139], v4 offset0:42 offset1:43
    ds_read2st64_b32 v[140:141], v4 offset0:44 offset1:45
    ds_read2st64_b32 v[142:143], v4 offset0:46 offset1:47
    s_waitcnt lgkmcnt(7)
    v_perm_b32 v6, v129, v128, s66
    v_accvgpr_write_b32 a32, v6
    v_perm_b32 v7, v129, v128, s67
    v_accvgpr_write_b32 a36, v7
    s_waitcnt lgkmcnt(6)
    v_perm_b32 v6, v131, v130, s66
    v_accvgpr_write_b32 a33, v6
    v_perm_b32 v7, v131, v130, s67
    v_accvgpr_write_b32 a37, v7
    s_waitcnt lgkmcnt(5)
    v_perm_b32 v6, v133, v132, s66
    v_accvgpr_write_b32 a34, v6
    v_perm_b32 v7, v133, v132, s67
    v_accvgpr_write_b32 a38, v7
    s_waitcnt lgkmcnt(4)
    v_perm_b32 v6, v135, v134, s66
    v_accvgpr_write_b32 a35, v6
    v_perm_b32 v7, v135, v134, s67
    v_accvgpr_write_b32 a39, v7
    s_waitcnt lgkmcnt(3)
    v_perm_b32 v6, v137, v136, s66
    v_accvgpr_write_b32 a40, v6
    v_perm_b32 v7, v137, v136, s67
    v_accvgpr_write_b32 a44, v7
    s_waitcnt lgkmcnt(2)
    v_perm_b32 v6, v139, v138, s66
    v_accvgpr_write_b32 a41, v6
    v_perm_b32 v7, v139, v138, s67
    v_accvgpr_write_b32 a45, v7
    s_waitcnt lgkmcnt(1)
    v_perm_b32 v6, v141, v140, s66
    v_accvgpr_write_b32 a42, v6
    v_perm_b32 v7, v141, v140, s67
    v_accvgpr_write_b32 a46, v7
    s_waitcnt lgkmcnt(0)
    v_perm_b32 v6, v143, v142, s66
    v_accvgpr_write_b32 a43, v6
    v_perm_b32 v7, v143, v142, s67
    v_accvgpr_write_b32 a47, v7
    s_waitcnt vmcnt(16)
    ds_read2st64_b32 v[128:129], v4 offset0:48 offset1:49
    ds_read2st64_b32 v[130:131], v4 offset0:50 offset1:51
    ds_read2st64_b32 v[132:133], v4 offset0:52 offset1:53
    ds_read2st64_b32 v[134:135], v4 offset0:54 offset1:55
    ds_read2st64_b32 v[136:137], v4 offset0:56 offset1:57
    ds_read2st64_b32 v[138:139], v4 offset0:58 offset1:59
    ds_read2st64_b32 v[140:141], v4 offset0:60 offset1:61
    ds_read2st64_b32 v[142:143], v4 offset0:62 offset1:63
    s_waitcnt lgkmcnt(7)
    v_perm_b32 v6, v129, v128, s66
    v_accvgpr_write_b32 a48, v6
    v_perm_b32 v7, v129, v128, s67
    v_accvgpr_write_b32 a52, v7
    s_waitcnt lgkmcnt(6)
    v_perm_b32 v6, v131, v130, s66
    v_accvgpr_write_b32 a49, v6
    v_perm_b32 v7, v131, v130, s67
    v_accvgpr_write_b32 a53, v7
    s_waitcnt lgkmcnt(5)
    v_perm_b32 v6, v133, v132, s66
    v_accvgpr_write_b32 a50, v6
    v_perm_b32 v7, v133, v132, s67
    v_accvgpr_write_b32 a54, v7
    s_waitcnt lgkmcnt(4)
    v_perm_b32 v6, v135, v134, s66
    v_accvgpr_write_b32 a51, v6
    v_perm_b32 v7, v135, v134, s67
    v_accvgpr_write_b32 a55, v7
    s_waitcnt lgkmcnt(3)
    v_perm_b32 v6, v137, v136, s66
    v_accvgpr_write_b32 a56, v6
    v_perm_b32 v7, v137, v136, s67
    v_accvgpr_write_b32 a60, v7
    s_waitcnt lgkmcnt(2)
    v_perm_b32 v6, v139, v138, s66
    v_accvgpr_write_b32 a57, v6
    v_perm_b32 v7, v139, v138, s67
    v_accvgpr_write_b32 a61, v7
    s_waitcnt lgkmcnt(1)
    v_perm_b32 v6, v141, v140, s66
    v_accvgpr_write_b32 a58, v6
    v_perm_b32 v7, v141, v140, s67
    v_accvgpr_write_b32 a62, v7
    s_waitcnt lgkmcnt(0)
    v_perm_b32 v6, v143, v142, s66
    v_accvgpr_write_b32 a59, v6
    v_perm_b32 v7, v143, v142, s67
    v_accvgpr_write_b32 a63, v7
    s_waitcnt vmcnt(12)
    ds_read2st64_b32 v[128:129], v4 offset0:64 offset1:65
    ds_read2st64_b32 v[130:131], v4 offset0:66 offset1:67
    ds_read2st64_b32 v[132:133], v4 offset0:68 offset1:69
    ds_read2st64_b32 v[134:135], v4 offset0:70 offset1:71
    ds_read2st64_b32 v[136:137], v4 offset0:72 offset1:73
    ds_read2st64_b32 v[138:139], v4 offset0:74 offset1:75
    ds_read2st64_b32 v[140:141], v4 offset0:76 offset1:77
    ds_read2st64_b32 v[142:143], v4 offset0:78 offset1:79
    s_waitcnt lgkmcnt(7)
    v_perm_b32 v6, v129, v128, s66
    v_accvgpr_write_b32 a64, v6
    v_perm_b32 v7, v129, v128, s67
    v_accvgpr_write_b32 a68, v7
    s_waitcnt lgkmcnt(6)
    v_perm_b32 v6, v131, v130, s66
    v_accvgpr_write_b32 a65, v6
    v_perm_b32 v7, v131, v130, s67
    v_accvgpr_write_b32 a69, v7
    s_waitcnt lgkmcnt(5)
    v_perm_b32 v6, v133, v132, s66
    v_accvgpr_write_b32 a66, v6
    v_perm_b32 v7, v133, v132, s67
    v_accvgpr_write_b32 a70, v7
    s_waitcnt lgkmcnt(4)
    v_perm_b32 v6, v135, v134, s66
    v_accvgpr_write_b32 a67, v6
    v_perm_b32 v7, v135, v134, s67
    v_accvgpr_write_b32 a71, v7
    s_waitcnt lgkmcnt(3)
    v_perm_b32 v6, v137, v136, s66
    v_accvgpr_write_b32 a72, v6
    v_perm_b32 v7, v137, v136, s67
    v_accvgpr_write_b32 a76, v7
    s_waitcnt lgkmcnt(2)
    v_perm_b32 v6, v139, v138, s66
    v_accvgpr_write_b32 a73, v6
    v_perm_b32 v7, v139, v138, s67
    v_accvgpr_write_b32 a77, v7
    s_waitcnt lgkmcnt(1)
    v_perm_b32 v6, v141, v140, s66
    v_accvgpr_write_b32 a74, v6
    v_perm_b32 v7, v141, v140, s67
    v_accvgpr_write_b32 a78, v7
    s_waitcnt lgkmcnt(0)
    v_perm_b32 v6, v143, v142, s66
    v_accvgpr_write_b32 a75, v6
    v_perm_b32 v7, v143, v142, s67
    v_accvgpr_write_b32 a79, v7
    s_waitcnt vmcnt(8)
    ds_read2st64_b32 v[128:129], v4 offset0:80 offset1:81
    ds_read2st64_b32 v[130:131], v4 offset0:82 offset1:83
    ds_read2st64_b32 v[132:133], v4 offset0:84 offset1:85
    ds_read2st64_b32 v[134:135], v4 offset0:86 offset1:87
    ds_read2st64_b32 v[136:137], v4 offset0:88 offset1:89
    ds_read2st64_b32 v[138:139], v4 offset0:90 offset1:91
    ds_read2st64_b32 v[140:141], v4 offset0:92 offset1:93
    ds_read2st64_b32 v[142:143], v4 offset0:94 offset1:95
    s_waitcnt lgkmcnt(7)
    v_perm_b32 v6, v129, v128, s66
    v_accvgpr_write_b32 a80, v6
    v_perm_b32 v7, v129, v128, s67
    v_accvgpr_write_b32 a84, v7
    s_waitcnt lgkmcnt(6)
    v_perm_b32 v6, v131, v130, s66
    v_accvgpr_write_b32 a81, v6
    v_perm_b32 v7, v131, v130, s67
    v_accvgpr_write_b32 a85, v7
    s_waitcnt lgkmcnt(5)
    v_perm_b32 v6, v133, v132, s66
    v_accvgpr_write_b32 a82, v6
    v_perm_b32 v7, v133, v132, s67
    v_accvgpr_write_b32 a86, v7
    s_waitcnt lgkmcnt(4)
    v_perm_b32 v6, v135, v134, s66
    v_accvgpr_write_b32 a83, v6
    v_perm_b32 v7, v135, v134, s67
    v_accvgpr_write_b32 a87, v7
    s_waitcnt lgkmcnt(3)
    v_perm_b32 v6, v137, v136, s66
    v_accvgpr_write_b32 a88, v6
    v_perm_b32 v7, v137, v136, s67
    v_accvgpr_write_b32 a92, v7
    s_waitcnt lgkmcnt(2)
    v_perm_b32 v6, v139, v138, s66
    v_accvgpr_write_b32 a89, v6
    v_perm_b32 v7, v139, v138, s67
    v_accvgpr_write_b32 a93, v7
    s_waitcnt lgkmcnt(1)
    v_perm_b32 v6, v141, v140, s66
    v_accvgpr_write_b32 a90, v6
    v_perm_b32 v7, v141, v140, s67
    v_accvgpr_write_b32 a94, v7
    s_waitcnt lgkmcnt(0)
    v_perm_b32 v6, v143, v142, s66
    v_accvgpr_write_b32 a91, v6
    v_perm_b32 v7, v143, v142, s67
    v_accvgpr_write_b32 a95, v7
    s_waitcnt vmcnt(4)
    ds_read2st64_b32 v[128:129], v4 offset0:96 offset1:97
    ds_read2st64_b32 v[130:131], v4 offset0:98 offset1:99
    ds_read2st64_b32 v[132:133], v4 offset0:100 offset1:101
    ds_read2st64_b32 v[134:135], v4 offset0:102 offset1:103
    ds_read2st64_b32 v[136:137], v4 offset0:104 offset1:105
    ds_read2st64_b32 v[138:139], v4 offset0:106 offset1:107
    ds_read2st64_b32 v[140:141], v4 offset0:108 offset1:109
    ds_read2st64_b32 v[142:143], v4 offset0:110 offset1:111
    s_waitcnt lgkmcnt(7)
    v_perm_b32 v6, v129, v128, s66
    v_accvgpr_write_b32 a96, v6
    v_perm_b32 v7, v129, v128, s67
    v_accvgpr_write_b32 a100, v7
    s_waitcnt lgkmcnt(6)
    v_perm_b32 v6, v131, v130, s66
    v_accvgpr_write_b32 a97, v6
    v_perm_b32 v7, v131, v130, s67
    v_accvgpr_write_b32 a101, v7
    s_waitcnt lgkmcnt(5)
    v_perm_b32 v6, v133, v132, s66
    v_accvgpr_write_b32 a98, v6
    v_perm_b32 v7, v133, v132, s67
    v_accvgpr_write_b32 a102, v7
    s_waitcnt lgkmcnt(4)
    v_perm_b32 v6, v135, v134, s66
    v_accvgpr_write_b32 a99, v6
    v_perm_b32 v7, v135, v134, s67
    v_accvgpr_write_b32 a103, v7
    s_waitcnt lgkmcnt(3)
    v_perm_b32 v6, v137, v136, s66
    v_accvgpr_write_b32 a104, v6
    v_perm_b32 v7, v137, v136, s67
    v_accvgpr_write_b32 a108, v7
    s_waitcnt lgkmcnt(2)
    v_perm_b32 v6, v139, v138, s66
    v_accvgpr_write_b32 a105, v6
    v_perm_b32 v7, v139, v138, s67
    v_accvgpr_write_b32 a109, v7
    s_waitcnt lgkmcnt(1)
    v_perm_b32 v6, v141, v140, s66
    v_accvgpr_write_b32 a106, v6
    v_perm_b32 v7, v141, v140, s67
    v_accvgpr_write_b32 a110, v7
    s_waitcnt lgkmcnt(0)
    v_perm_b32 v6, v143, v142, s66
    v_accvgpr_write_b32 a107, v6
    v_perm_b32 v7, v143, v142, s67
    v_accvgpr_write_b32 a111, v7
    s_waitcnt vmcnt(0)
    ds_read2st64_b32 v[128:129], v4 offset0:112 offset1:113
    ds_read2st64_b32 v[130:131], v4 offset0:114 offset1:115
    ds_read2st64_b32 v[132:133], v4 offset0:116 offset1:117
    ds_read2st64_b32 v[134:135], v4 offset0:118 offset1:119
    ds_read2st64_b32 v[136:137], v4 offset0:120 offset1:121
    ds_read2st64_b32 v[138:139], v4 offset0:122 offset1:123
    ds_read2st64_b32 v[140:141], v4 offset0:124 offset1:125
    ds_read2st64_b32 v[142:143], v4 offset0:126 offset1:127
    s_waitcnt lgkmcnt(7)
    v_perm_b32 v6, v129, v128, s66
    v_accvgpr_write_b32 a112, v6
    v_perm_b32 v7, v129, v128, s67
    v_accvgpr_write_b32 a116, v7
    s_waitcnt lgkmcnt(6)
    v_perm_b32 v6, v131, v130, s66
    v_accvgpr_write_b32 a113, v6
    v_perm_b32 v7, v131, v130, s67
    v_accvgpr_write_b32 a117, v7
    s_waitcnt lgkmcnt(5)
    v_perm_b32 v6, v133, v132, s66
    v_accvgpr_write_b32 a114, v6
    v_perm_b32 v7, v133, v132, s67
    v_accvgpr_write_b32 a118, v7
    s_waitcnt lgkmcnt(4)
    v_perm_b32 v6, v135, v134, s66
    v_accvgpr_write_b32 a115, v6
    v_perm_b32 v7, v135, v134, s67
    v_accvgpr_write_b32 a119, v7
    s_waitcnt lgkmcnt(3)
    v_perm_b32 v6, v137, v136, s66
    v_accvgpr_write_b32 a120, v6
    v_perm_b32 v7, v137, v136, s67
    v_accvgpr_write_b32 a124, v7
    s_waitcnt lgkmcnt(2)
    v_perm_b32 v6, v139, v138, s66
    v_accvgpr_write_b32 a121, v6
    v_perm_b32 v7, v139, v138, s67
    v_accvgpr_write_b32 a125, v7
    s_waitcnt lgkmcnt(1)
    v_perm_b32 v6, v141, v140, s66
    v_accvgpr_write_b32 a122, v6
    v_perm_b32 v7, v141, v140, s67
    v_accvgpr_write_b32 a126, v7
    s_waitcnt lgkmcnt(0)
    v_perm_b32 v6, v143, v142, s66
    v_accvgpr_write_b32 a123, v6
    v_perm_b32 v7, v143, v142, s67
    v_accvgpr_write_b32 a127, v7
    s_barrier
    s_and_b32 s59, s57, 1
    s_lshl_b32 s60, s59, 7
    v_xor_b32 v2, s60, v1
    v_and_b32 v11, 15, v0
    v_lshrrev_b32 v10, 4, v0
    v_xor_b32 v10, v10, v11
    v_lshlrev_b32 v10, 4, v10
    v_lshl_or_b32 v11, v11, 10, v10
    v_xor_b32 v4, 0, v11
    v_xor_b32 v5, 64, v11
    v_xor_b32 v6, 128, v11
    v_xor_b32 v7, 192, v11
    v_xor_b32 v11, 0x4000, v7
    v_xor_b32 v10, 0x4000, v6
    v_xor_b32 v9, 0x4000, v5
    v_xor_b32 v8, 0x4000, v4
    s_lshl_b32 s59, s56, 7
    s_add_u32 s59, s59, 0x616800
    v_mov_b32 v22, s59
    v_lshrrev_b32 v224, 4, v0
    v_and_b32 v225, 15, v0
    v_lshlrev_b32 v26, 9, v224
    v_lshl_add_u32 v26, v225, 4, v26
    s_lshl_b32 s59, s57, 11
    s_add_u32 s59, s59, 65536
    v_add_u32 v23, s59, v26
    s_and_b32 s79, s57, 1
    s_lshr_b32 s80, s57, 1
    s_lshl_b32 s59, s79, 8
    s_add_u32 s60, s59, 65536
    v_add_u32 v25, s60, v26
    s_lshl_b32 s60, s80, 12
    s_add_u32 s60, s60, s59
    v_add_u32 v29, s60, v26
    v_lshrrev_b32 v226, 2, v225
    v_lshlrev_b32 v226, 9, v226
    v_lshl_add_u32 v27, v224, 5, v226
    s_mov_b32 s4, 0xaaaaaaaa
    s_mov_b32 s5, 0xaaaaaaaa
    v_lshlrev_b32 v28, 4, v225
    v_lshl_add_u32 v28, v224, 2, v28
    s_lshl_b32 s59, s80, 10
    v_add_u32 v28, s59, v28
    v_and_b32 v226, 1, v0
    v_lshlrev_b32 v226, 12, v226
    s_lshl_b32 s59, s78, 7
    s_add_u32 s60, s59, 0x628000
    v_mov_b32 v30, s60
    s_add_u32 s60, s59, 0x614800
    v_mov_b32 v31, s60
    s_lshl_b32 s59, s79, 4
    v_lshlrev_b32 v226, 2, v224
    v_sub_u32 v226, v225, v226
    v_add_u32 v226, s59, v226
    v_cmp_le_i32 s[82:83], 0, v226
    v_cmp_le_i32 s[84:85], 1, v226
    v_cmp_le_i32 s[86:87], 2, v226
    v_cmp_le_i32 s[88:89], 3, v226
    v_cmp_le_i32 s[90:91], 16, v226
    v_cmp_le_i32 s[92:93], 17, v226
    v_cmp_le_i32 s[94:95], 18, v226
    v_cmp_le_i32 s[96:97], 19, v226
    v_mov_b32 v205, 0
    s_and_b32 s58, s56, 1
    v_mov_b32 v24, 0
    s_nop 1
Lrdy_51:
    global_load_dword v20, v24, s[32:33] offset:4 sc1
    s_waitcnt vmcnt(0)
    v_cmp_ne_u32 vcc, 0, v20
    s_nop 0
    s_cmp_eq_u64 vcc, exec
    s_nop 1
    s_cbranch_scc0 Lrdy_51
    s_mov_b32 s72, 0
    s_mov_b32 s73, 0
QAtop_52:
    s_cmp_lg_u32 s73, 0
    s_cbranch_scc1 QAhave_53
    s_and_b32 s59, s58, 7
    s_lshl_b32 s59, s59, 10
    s_add_u32 s59, s59, 0x610800
    v_and_b32 v24, 7, v0
    v_lshlrev_b32 v24, 7, v24
    v_add_u32 v24, s59, v24
    s_lshr_b32 s61, s58, 3
    s_add_u32 s61, s61, 1
Lw_56:
    buffer_load_dword v20, v24, s[36:39], 0 offen sc1
    s_waitcnt vmcnt(0)
    v_cmp_le_u32 vcc, s61, v20
    s_nop 0
    s_cmp_eq_u64 vcc, exec
    s_nop 1
    s_cbranch_scc1 Lwd_57
    s_sleep 1
    s_branch Lw_56
Lwd_57:
    s_lshl_b32 s75, s58, 15
    s_add_u32 s75, s75, 0x0
    s_lshl_b32 s59, s57, 13
    s_add_u32 s60, s59, s75
    s_add_u32 s59, s59, s72
    s_mov_b32 m0, s59
    v_xor_b32 v20, 0, v2
    buffer_load_dwordx4 v20, s[36:39], s60 offen offset:0 sc1 lds
    v_xor_b32 v21, 16, v2
    buffer_load_dwordx4 v21, s[36:39], s60 offen offset:1024 sc1 lds
    v_xor_b32 v20, 32, v2
    buffer_load_dwordx4 v20, s[36:39], s60 offen offset:2048 sc1 lds
    v_xor_b32 v21, 48, v2
    buffer_load_dwordx4 v21, s[36:39], s60 offen offset:3072 sc1 lds
    s_add_u32 s59, s59, 4096
    s_add_u32 s60, s60, 4096
    s_mov_b32 m0, s59
    v_xor_b32 v20, 64, v2
    buffer_load_dwordx4 v20, s[36:39], s60 offen offset:0 sc1 lds
    v_xor_b32 v21, 80, v2
    buffer_load_dwordx4 v21, s[36:39], s60 offen offset:1024 sc1 lds
    v_xor_b32 v20, 96, v2
    buffer_load_dwordx4 v20, s[36:39], s60 offen offset:2048 sc1 lds
    v_xor_b32 v21, 112, v2
    buffer_load_dwordx4 v21, s[36:39], s60 offen offset:3072 sc1 lds
    s_nop 0
QAhave_53:
    s_waitcnt vmcnt(0)
    s_barrier
    v_add_u32 v12, s72, v4
    v_add_u32 v13, s72, v5
    v_add_u32 v14, s72, v6
    v_add_u32 v15, s72, v7
    v_add_u32 v16, s72, v8
    v_add_u32 v17, s72, v9
    v_add_u32 v18, s72, v10
    v_add_u32 v19, s72, v11
    s_mov_b32 s73, 0
    s_add_u32 s74, s58, 2
    s_cmp_ge_u32 s74, 64
    s_cbranch_scc1 QAnopf_54
    s_and_b32 s59, s74, 7
    s_lshl_b32 s59, s59, 10
    s_add_u32 s59, s59, 0x610800
    v_and_b32 v24, 7, v0
    v_lshlrev_b32 v24, 7, v24
    v_add_u32 v24, s59, v24
    s_lshr_b32 s61, s74, 3
    s_add_u32 s61, s61, 1
    buffer_load_dword v20, v24, s[36:39], 0 offen sc1
    s_waitcnt vmcnt(0)
    v_cmp_le_u32 vcc, s61, v20
    s_nop 0
    s_cmp_eq_u64 vcc, exec
    s_nop 1
    s_cbranch_scc0 QAnopf_54
    s_lshl_b32 s75, s74, 15
    s_add_u32 s75, s75, 0x0
    s_xor_b32 s76, s72, 32768
    s_lshl_b32 s59, s57, 13
    s_add_u32 s60, s59, s75
    s_add_u32 s59, s59, s76
    s_mov_b32 m0, s59
    v_xor_b32 v20, 0, v2
    buffer_load_dwordx4 v20, s[36:39], s60 offen offset:0 sc1 lds
    v_xor_b32 v21, 16, v2
    buffer_load_dwordx4 v21, s[36:39], s60 offen offset:1024 sc1 lds
    v_xor_b32 v20, 32, v2
    buffer_load_dwordx4 v20, s[36:39], s60 offen offset:2048 sc1 lds
    v_xor_b32 v21, 48, v2
    buffer_load_dwordx4 v21, s[36:39], s60 offen offset:3072 sc1 lds
    s_add_u32 s59, s59, 4096
    s_add_u32 s60, s60, 4096
    s_mov_b32 m0, s59
    v_xor_b32 v20, 64, v2
    buffer_load_dwordx4 v20, s[36:39], s60 offen offset:0 sc1 lds
    v_xor_b32 v21, 80, v2
    buffer_load_dwordx4 v21, s[36:39], s60 offen offset:1024 sc1 lds
    v_xor_b32 v20, 96, v2
    buffer_load_dwordx4 v20, s[36:39], s60 offen offset:2048 sc1 lds
    v_xor_b32 v21, 112, v2
    buffer_load_dwordx4 v21, s[36:39], s60 offen offset:3072 sc1 lds
    s_mov_b32 s73, 1
QAnopf_54:
    s_add_u32 s61, s58, 1
    s_and_b32 s59, s58, 48
    s_lshl_b32 s59, s59, 8
    v_add_u32 v24, s59, v30
    s_nop 1
Lw_58:
    buffer_load_dword v20, v24, s[36:39], 0 offen sc1
    s_waitcnt vmcnt(0)
    v_cmp_le_u32 vcc, s61, v20
    s_nop 0
    s_cmp_eq_u64 vcc, exec
    s_nop 1
    s_cbranch_scc1 Lwd_59
    s_sleep 1
    s_branch Lw_58
Lwd_59:
    s_lshl_b32 s81, s58, 18
    s_lshl_b32 s59, s78, 13
    s_add_u32 s81, s81, s59
    s_add_u32 s59, s81, 0x1000000
    s_add_u32 s60, s59, 4096
    buffer_load_dwordx4 v[96:99], v26, s[36:39], s59 offen offset:0 sc1
    buffer_load_dwordx4 v[100:103], v26, s[36:39], s59 offen offset:2048 sc1
    buffer_load_dwordx4 v[104:107], v26, s[36:39], s60 offen offset:0 sc1
    buffer_load_dwordx4 v[108:111], v26, s[36:39], s60 offen offset:2048 sc1
    buffer_load_dwordx4 v[112:115], v26, s[36:39], s59 offen offset:256 sc1
    buffer_load_dwordx4 v[116:119], v26, s[36:39], s59 offen offset:2304 sc1
    buffer_load_dwordx4 v[120:123], v26, s[36:39], s60 offen offset:256 sc1
    buffer_load_dwordx4 v[124:127], v26, s[36:39], s60 offen offset:2304 sc1
    s_lshl_b32 s59, s80, 12
    s_add_u32 s59, s59, s81
    s_add_u32 s59, s59, 0x2000000
    buffer_load_dwordx4 v[128:131], v1, s[36:39], s59 offen offset:0 sc1
    buffer_load_dwordx4 v[132:135], v1, s[36:39], s59 offen offset:1024 sc1
    buffer_load_dwordx4 v[136:139], v1, s[36:39], s59 offen offset:2048 sc1
    buffer_load_dwordx4 v[140:143], v1, s[36:39], s59 offen offset:3072 sc1
    ds_read_b128 v[32:35], v12 offset:0
    ds_read_b128 v[36:39], v16 offset:0
    ds_read_b128 v[40:43], v13 offset:0
    ds_read_b128 v[44:47], v17 offset:0
    ds_read_b128 v[48:51], v14 offset:0
    ds_read_b128 v[52:55], v18 offset:0
    ds_read_b128 v[56:59], v15 offset:0
    ds_read_b128 v[60:63], v19 offset:0
    s_waitcnt lgkmcnt(6)
    v_mfma_f32_16x16x32_bf16 v[64:67], a[0:3], v[32:35], 0
    v_mfma_f32_16x16x32_bf16 v[68:71], a[0:3], v[36:39], 0
    v_mfma_f32_16x16x32_bf16 v[72:75], a[4:7], v[32:35], 0
    v_mfma_f32_16x16x32_bf16 v[76:79], a[4:7], v[36:39], 0
    ds_read_b128 v[32:35], v12 offset:256
    ds_read_b128 v[36:39], v16 offset:256
    s_waitcnt lgkmcnt(6)
    v_mfma_f32_16x16x32_bf16 v[64:67], a[8:11], v[40:43], v[64:67]
    v_mfma_f32_16x16x32_bf16 v[68:71], a[8:11], v[44:47], v[68:71]
    v_mfma_f32_16x16x32_bf16 v[72:75], a[12:15], v[40:43], v[72:75]
    v_mfma_f32_16x16x32_bf16 v[76:79], a[12:15], v[44:47], v[76:79]
    ds_read_b128 v[40:43], v13 offset:256
    ds_read_b128 v[44:47], v17 offset:256
    s_waitcnt lgkmcnt(6)
    v_mfma_f32_16x16x32_bf16 v[64:67], a[16:19], v[48:51], v[64:67]
    v_mfma_f32_16x16x32_bf16 v[68:71], a[16:19], v[52:55], v[68:71]
    v_mfma_f32_16x16x32_bf16 v[72:75], a[20:23], v[48:51], v[72:75]
    v_mfma_f32_16x16x32_bf16 v[76:79], a[20:23], v[52:55], v[76:79]
    ds_read_b128 v[48:51], v14 offset:256
    ds_read_b128 v[52:55], v18 offset:256
    s_waitcnt lgkmcnt(6)
    v_mfma_f32_16x16x32_bf16 v[64:67], a[24:27], v[56:59], v[64:67]
    v_mfma_f32_16x16x32_bf16 v[68:71], a[24:27], v[60:63], v[68:71]
    v_mfma_f32_16x16x32_bf16 v[72:75], a[28:31], v[56:59], v[72:75]
    v_mfma_f32_16x16x32_bf16 v[76:79], a[28:31], v[60:63], v[76:79]
    ds_read_b128 v[56:59], v15 offset:256
    ds_read_b128 v[60:63], v19 offset:256
    s_waitcnt lgkmcnt(6)
    v_mfma_f32_16x16x32_bf16 v[64:67], a[32:35], v[32:35], v[64:67]
    v_mfma_f32_16x16x32_bf16 v[68:71], a[32:35], v[36:39], v[68:71]
    v_mfma_f32_16x16x32_bf16 v[72:75], a[36:39], v[32:35], v[72:75]
    v_mfma_f32_16x16x32_bf16 v[76:79], a[36:39], v[36:39], v[76:79]
    ds_read_b128 v[32:35], v12 offset:512
    ds_read_b128 v[36:39], v16 offset:512
    s_waitcnt lgkmcnt(6)
    v_mfma_f32_16x16x32_bf16 v[64:67], a[40:43], v[40:43], v[64:67]
    v_mfma_f32_16x16x32_bf16 v[68:71], a[40:43], v[44:47], v[68:71]
    v_mfma_f32_16x16x32_bf16 v[72:75], a[44:47], v[40:43], v[72:75]
    v_mfma_f32_16x16x32_bf16 v[76:79], a[44:47], v[44:47], v[76:79]
    ds_read_b128 v[40:43], v13 offset:512
    ds_read_b128 v[44:47], v17 offset:512
    s_waitcnt lgkmcnt(6)
    v_mfma_f32_16x16x32_bf16 v[64:67], a[48:51], v[48:51], v[64:67]
    v_mfma_f32_16x16x32_bf16 v[68:71], a[48:51], v[52:55], v[68:71]
    v_mfma_f32_16x16x32_bf16 v[72:75], a[52:55], v[48:51], v[72:75]
    v_mfma_f32_16x16x32_bf16 v[76:79], a[52:55], v[52:55], v[76:79]
    ds_read_b128 v[48:51], v14 offset:512
    ds_read_b128 v[52:55], v18 offset:512
    s_waitcnt lgkmcnt(6)
    v_mfma_f32_16x16x32_bf16 v[64:67], a[56:59], v[56:59], v[64:67]
    v_mfma_f32_16x16x32_bf16 v[68:71], a[56:59], v[60:63], v[68:71]
    v_mfma_f32_16x16x32_bf16 v[72:75], a[60:63], v[56:59], v[72:75]
    v_mfma_f32_16x16x32_bf16 v[76:79], a[60:63], v[60:63], v[76:79]
    ds_read_b128 v[56:59], v15 offset:512
    ds_read_b128 v[60:63], v19 offset:512
    s_waitcnt lgkmcnt(6)
    v_mfma_f32_16x16x32_bf16 v[64:67], a[64:67], v[32:35], v[64:67]
    v_mfma_f32_16x16x32_bf16 v[68:71], a[64:67], v[36:39], v[68:71]
    v_mfma_f32_16x16x32_bf16 v[72:75], a[68:71], v[32:35], v[72:75]
    v_mfma_f32_16x16x32_bf16 v[76:79], a[68:71], v[36:39], v[76:79]
    ds_read_b128 v[32:35], v12 offset:768
    ds_read_b128 v[36:39], v16 offset:768
    s_waitcnt lgkmcnt(6)
    v_mfma_f32_16x16x32_bf16 v[64:67], a[72:75], v[40:43], v[64:67]
    v_mfma_f32_16x16x32_bf16 v[68:71], a[72:75], v[44:47], v[68:71]
    v_mfma_f32_16x16x32_bf16 v[72:75], a[76:79], v[40:43], v[72:75]
    v_mfma_f32_16x16x32_bf16 v[76:79], a[76:79], v[44:47], v[76:79]
    ds_read_b128 v[40:43], v13 offset:768
    ds_read_b128 v[44:47], v17 offset:768
    s_waitcnt lgkmcnt(6)
    v_mfma_f32_16x16x32_bf16 v[64:67], a[80:83], v[48:51], v[64:67]
    v_mfma_f32_16x16x32_bf16 v[68:71], a[80:83], v[52:55], v[68:71]
    v_mfma_f32_16x16x32_bf16 v[72:75], a[84:87], v[48:51], v[72:75]
    v_mfma_f32_16x16x32_bf16 v[76:79], a[84:87], v[52:55], v[76:79]
    ds_read_b128 v[48:51], v14 offset:768
    ds_read_b128 v[52:55], v18 offset:768
    s_waitcnt lgkmcnt(6)
    v_mfma_f32_16x16x32_bf16 v[64:67], a[88:91], v[56:59], v[64:67]
    v_mfma_f32_16x16x32_bf16 v[68:71], a[88:91], v[60:63], v[68:71]
    v_mfma_f32_16x16x32_bf16 v[72:75], a[92:95], v[56:59], v[72:75]
    v_mfma_f32_16x16x32_bf16 v[76:79], a[92:95], v[60:63], v[76:79]
    ds_read_b128 v[56:59], v15 offset:768
    ds_read_b128 v[60:63], v19 offset:768
    s_waitcnt lgkmcnt(6)
    v_mfma_f32_16x16x32_bf16 v[64:67], a[96:99], v[32:35], v[64:67]
    v_mfma_f32_16x16x32_bf16 v[68:71], a[96:99], v[36:39], v[68:71]
    v_mfma_f32_16x16x32_bf16 v[72:75], a[100:103], v[32:35], v[72:75]
    v_mfma_f32_16x16x32_bf16 v[76:79], a[100:103], v[36:39], v[76:79]
    s_waitcnt lgkmcnt(4)
    v_mfma_f32_16x16x32_bf16 v[64:67], a[104:107], v[40:43], v[64:67]
    v_mfma_f32_16x16x32_bf16 v[68:71], a[104:107], v[44:47], v[68:71]
    v_mfma_f32_16x16x32_bf16 v[72:75], a[108:111], v[40:43], v[72:75]
    v_mfma_f32_16x16x32_bf16 v[76:79], a[108:111], v[44:47], v[76:79]
    s_waitcnt lgkmcnt(2)
    v_mfma_f32_16x16x32_bf16 v[64:67], a[112:115], v[48:51], v[64:67]
    v_mfma_f32_16x16x32_bf16 v[68:71], a[112:115], v[52:55], v[68:71]
    v_mfma_f32_16x16x32_bf16 v[72:75], a[116:119], v[48:51], v[72:75]
    v_mfma_f32_16x16x32_bf16 v[76:79], a[116:119], v[52:55], v[76:79]
    s_waitcnt lgkmcnt(0)
    v_mfma_f32_16x16x32_bf16 v[64:67], a[120:123], v[56:59], v[64:67]
    v_mfma_f32_16x16x32_bf16 v[68:71], a[120:123], v[60:63], v[68:71]
    v_mfma_f32_16x16x32_bf16 v[72:75], a[124:127], v[56:59], v[72:75]
    v_mfma_f32_16x16x32_bf16 v[76:79], a[124:127], v[60:63], v[76:79]
    s_nop 6
    v_cvt_pk_bf16_f32 v80, v64, v72
    v_cvt_pk_bf16_f32 v81, v65, v73
    v_cvt_pk_bf16_f32 v82, v66, v74
    v_cvt_pk_bf16_f32 v83, v67, v75
    ds_write_b128 v23, v[80:83] offset:0
    v_cvt_pk_bf16_f32 v84, v68, v76
    v_cvt_pk_bf16_f32 v85, v69, v77
    v_cvt_pk_bf16_f32 v86, v70, v78
    v_cvt_pk_bf16_f32 v87, v71, v79
    ds_write_b128 v23, v[84:87] offset:256
    s_waitcnt lgkmcnt(0)
    s_barrier
    ds_read_b128 v[144:147], v25 offset:0
    ds_read_b128 v[148:151], v25 offset:2048
    ds_read_b128 v[152:155], v25 offset:4096
    ds_read_b128 v[156:159], v25 offset:6144
    s_waitcnt vmcnt(0) lgkmcnt(0)
    v_mfma_f32_16x16x32_bf16 v[184:187], v[96:99], v[144:147], 0
    v_mfma_f32_16x16x32_bf16 v[184:187], v[100:103], v[148:151], v[184:187]
    v_mfma_f32_16x16x32_bf16 v[184:187], v[104:107], v[152:155], v[184:187]
    v_mfma_f32_16x16x32_bf16 v[184:187], v[108:111], v[156:159], v[184:187]
    v_mfma_f32_16x16x32_bf16 v[188:191], v[112:115], v[144:147], 0
    v_mfma_f32_16x16x32_bf16 v[188:191], v[116:119], v[148:151], v[188:191]
    v_mfma_f32_16x16x32_bf16 v[188:191], v[120:123], v[152:155], v[188:191]
    v_mfma_f32_16x16x32_bf16 v[188:191], v[124:127], v[156:159], v[188:191]
    s_nop 3
    v_cvt_pk_bf16_f32 v224, v184, v185
    v_lshlrev_b32 v184, 16, v224
    v_and_b32 v185, s68, v224
    v_cvt_pk_bf16_f32 v224, v186, v187
    v_lshlrev_b32 v186, 16, v224
    v_and_b32 v187, s68, v224
    v_cvt_pk_bf16_f32 v224, v188, v189
    v_lshlrev_b32 v188, 16, v224
    v_and_b32 v189, s68, v224
    v_cvt_pk_bf16_f32 v224, v190, v191
    v_lshlrev_b32 v190, 16, v224
    v_and_b32 v191, s68, v224
    v_mul_f32 v184, s70, v184
    v_mul_f32 v185, s70, v185
    v_mul_f32 v186, s70, v186
    v_mul_f32 v187, s70, v187
    v_mul_f32 v188, s70, v188
    v_mul_f32 v189, s70, v189
    v_mul_f32 v190, s70, v190
    v_mul_f32 v191, s70, v191
    v_cvt_pk_bf16_f32 v224, v184, v185
    v_lshlrev_b32 v184, 16, v224
    v_and_b32 v185, s68, v224
    v_cvt_pk_bf16_f32 v224, v186, v187
    v_lshlrev_b32 v186, 16, v224
    v_and_b32 v187, s68, v224
    v_cvt_pk_bf16_f32 v224, v188, v189
    v_lshlrev_b32 v188, 16, v224
    v_and_b32 v189, s68, v224
    v_cvt_pk_bf16_f32 v224, v190, v191
    v_lshlrev_b32 v190, 16, v224
    v_and_b32 v191, s68, v224
    v_mov_b32 v224, 0xce6e6b28
    v_cndmask_b32 v184, v224, v184, s[82:83]
    v_cndmask_b32 v185, v224, v185, s[84:85]
    v_cndmask_b32 v186, v224, v186, s[86:87]
    v_cndmask_b32 v187, v224, v187, s[88:89]
    v_cndmask_b32 v188, v224, v188, s[90:91]
    v_cndmask_b32 v189, v224, v189, s[92:93]
    v_cndmask_b32 v190, v224, v190, s[94:95]
    v_cndmask_b32 v191, v224, v191, s[96:97]
    v_max3_f32 v226, v184, v185, v186
    v_max3_f32 v226, v226, v187, v188
    v_max3_f32 v226, v226, v189, v190
    v_max_f32 v226, v226, v191
    s_add_u32 s61, s58, 1
    s_nop 0
Lw_60:
    buffer_load_dword v20, v31, s[36:39], 0 offen sc1
    s_waitcnt vmcnt(0)
    v_cmp_le_u32 vcc, s61, v20
    s_nop 0
    s_cmp_eq_u64 vcc, exec
    s_nop 1
    s_cbranch_scc1 Lwd_61
    s_sleep 1
    s_branch Lw_60
Lwd_61:
    s_lshr_b32 s59, s81, 2
    s_add_u32 s60, s59, 0xc00000
    s_add_u32 s59, s59, 0x800000
    buffer_load_dwordx4 v[96:99], v27, s[36:39], s59 offen offset:0 sc1
    buffer_load_dwordx4 v[100:103], v27, s[36:39], s59 offen offset:16 sc1
    buffer_load_dwordx4 v[104:107], v27, s[36:39], s59 offen offset:128 sc1
    buffer_load_dwordx4 v[108:111], v27, s[36:39], s59 offen offset:144 sc1
    buffer_load_dwordx4 v[112:115], v27, s[36:39], s59 offen offset:256 sc1
    buffer_load_dwordx4 v[116:119], v27, s[36:39], s59 offen offset:272 sc1
    buffer_load_dwordx4 v[120:123], v27, s[36:39], s59 offen offset:384 sc1
    buffer_load_dwordx4 v[124:127], v27, s[36:39], s59 offen offset:400 sc1
    buffer_load_dword v176, v28, s[36:39], s60 offen offset:0 sc1
    v_mov_b32 v177, 0
    buffer_load_dword v178, v28, s[36:39], s60 offen offset:256 sc1
    v_mov_b32 v179, 0
    buffer_load_dword v180, v28, s[36:39], s60 offen offset:512 sc1
    v_mov_b32 v181, 0
    buffer_load_dword v182, v28, s[36:39], s60 offen offset:768 sc1
    v_mov_b32 v183, 0
    s_waitcnt vmcnt(10)
    v_cndmask_b32 v160, v96, v97, s[4:5]
    v_cndmask_b32 v161, v98, v99, s[4:5]
    v_cndmask_b32 v162, v100, v101, s[4:5]
    v_cndmask_b32 v163, v102, v103, s[4:5]
    s_nop 1
    v_mfma_f32_16x16x32_bf16 v[192:195], v[160:163], v[144:147], 0
    s_waitcnt vmcnt(8)
    v_cndmask_b32 v164, v104, v105, s[4:5]
    v_cndmask_b32 v165, v106, v107, s[4:5]
    v_cndmask_b32 v166, v108, v109, s[4:5]
    v_cndmask_b32 v167, v110, v111, s[4:5]
    s_nop 1
    v_mfma_f32_16x16x32_bf16 v[192:195], v[164:167], v[148:151], v[192:195]
    s_waitcnt vmcnt(6)
    v_cndmask_b32 v168, v112, v113, s[4:5]
    v_cndmask_b32 v169, v114, v115, s[4:5]
    v_cndmask_b32 v170, v116, v117, s[4:5]
    v_cndmask_b32 v171, v118, v119, s[4:5]
    s_nop 1
    v_mfma_f32_16x16x32_bf16 v[192:195], v[168:171], v[152:155], v[192:195]
    s_waitcnt vmcnt(4)
    v_cndmask_b32 v172, v120, v121, s[4:5]
    v_cndmask_b32 v173, v122, v123, s[4:5]
    v_cndmask_b32 v174, v124, v125, s[4:5]
    v_cndmask_b32 v175, v126, v127, s[4:5]
    s_nop 1
    v_mfma_f32_16x16x32_bf16 v[192:195], v[172:175], v[156:159], v[192:195]
    s_nop 7
    v_cvt_pk_bf16_f32 v224, v192, v193
    v_lshlrev_b32 v192, 16, v224
    v_and_b32 v193, s68, v224
    v_mul_f32 v192, s70, v192
    v_mul_f32 v193, s70, v193
    v_cvt_pk_bf16_f32 v224, v192, v193
    v_lshlrev_b32 v192, 16, v224
    v_and_b32 v193, s68, v224
    v_max3_f32 v226, v226, v192, v193
    v_mov_b32 v227, v226
    s_nop 1
    v_permlane32_swap_b32 v226, v227
    v_max_f32 v226, v226, v227
    v_mov_b32 v227, v226
    s_nop 1
    v_permlane16_swap_b32 v226, v227
    v_max_f32 v226, v226, v227
    v_mul_f32 v226, s69, v226
    v_fma_f32 v184, v184, s69, -v226
    v_fma_f32 v185, v185, s69, -v226
    v_fma_f32 v186, v186, s69, -v226
    v_fma_f32 v187, v187, s69, -v226
    v_fma_f32 v188, v188, s69, -v226
    v_fma_f32 v189, v189, s69, -v226
    v_fma_f32 v190, v190, s69, -v226
    v_fma_f32 v191, v191, s69, -v226
    v_fma_f32 v192, v192, s69, -v226
    v_fma_f32 v193, v193, s69, -v226
    v_exp_f32 v184, v184
    v_exp_f32 v185, v185
    v_exp_f32 v186, v186
    v_exp_f32 v187, v187
    v_exp_f32 v188, v188
    v_exp_f32 v189, v189
    v_exp_f32 v190, v190
    v_exp_f32 v191, v191
    v_exp_f32 v192, v192
    v_exp_f32 v193, v193
    v_add_f32 v226, v184, v185
    v_add_f32 v228, v186, v187
    v_add_f32 v226, v226, v188
    v_add_f32 v228, v228, v189
    v_add_f32 v226, v226, v190
    v_add_f32 v228, v228, v191
    v_add_f32 v226, v226, v192
    v_add_f32 v228, v228, v193
    v_add_f32 v226, v226, v228
    v_mov_b32 v227, v226
    s_nop 1
    v_permlane32_swap_b32 v226, v227
    v_add_f32 v226, v226, v227
    v_mov_b32 v227, v226
    s_nop 1
    v_permlane16_swap_b32 v226, v227
    v_add_f32 v226, v226, v227
    v_rcp_f32 v226, v226
    s_nop 0
    v_mul_f32 v184, v184, v226
    v_mul_f32 v185, v185, v226
    v_mul_f32 v186, v186, v226
    v_mul_f32 v187, v187, v226
    v_mul_f32 v188, v188, v226
    v_mul_f32 v189, v189, v226
    v_mul_f32 v190, v190, v226
    v_mul_f32 v191, v191, v226
    v_mul_f32 v192, v192, v226
    v_mul_f32 v193, v193, v226
    v_cvt_pk_bf16_f32 v196, v184, v185
    v_cvt_pk_bf16_f32 v197, v186, v187
    v_cvt_pk_bf16_f32 v198, v188, v189
    v_cvt_pk_bf16_f32 v199, v190, v191
    v_cvt_pk_bf16_f32 v204, v192, v193
    s_waitcnt vmcnt(0)
    v_mfma_f32_16x16x32_bf16 v[208:211], v[128:131], v[196:199], 0
    v_mfma_f32_16x16x32_bf16 v[212:215], v[132:135], v[196:199], 0
    v_mfma_f32_16x16x32_bf16 v[216:219], v[136:139], v[196:199], 0
    v_mfma_f32_16x16x32_bf16 v[220:223], v[140:143], v[196:199], 0
    v_mfma_f32_16x16x16_bf16 v[208:211], v[176:177], v[204:205], v[208:211]
    v_mfma_f32_16x16x16_bf16 v[212:215], v[178:179], v[204:205], v[212:215]
    v_mfma_f32_16x16x16_bf16 v[216:219], v[180:181], v[204:205], v[216:219]
    v_mfma_f32_16x16x16_bf16 v[220:223], v[182:183], v[204:205], v[220:223]
    s_add_u32 s59, s81, 0x3000000
    s_nop 4
    v_cvt_pk_bf16_f32 v80, v208, v212
    v_cvt_pk_bf16_f32 v81, v209, v213
    v_cvt_pk_bf16_f32 v82, v210, v214
    v_cvt_pk_bf16_f32 v83, v211, v215
    buffer_store_dwordx4 v[80:83], v29, s[36:39], s59 offen offset:0 sc1
    v_cvt_pk_bf16_f32 v84, v216, v220
    v_cvt_pk_bf16_f32 v85, v217, v221
    v_cvt_pk_bf16_f32 v86, v218, v222
    v_cvt_pk_bf16_f32 v87, v219, v223
    buffer_store_dwordx4 v[84:87], v29, s[36:39], s59 offen offset:2048 sc1
    s_waitcnt vmcnt(0)
    s_barrier
    s_cmp_lg_u32 s57, 0
    s_cbranch_scc1 QApub_62
    s_add_u32 s59, s58, 1
    v_mov_b32 v20, s59
    s_mov_b64 exec, 1
    buffer_store_dword v20, v22, s[36:39], 0 offen sc1
    s_mov_b64 exec, -1
QApub_62:
    s_xor_b32 s72, s72, 32768
    s_add_u32 s58, s58, 2
    s_cmp_lt_u32 s58, 64
    s_cbranch_scc1 QAtop_52
QAend_55:
    s_branch Lend_1
Lx5_8:
    s_add_u32 s56, s56, 32
Lx4_7:
    s_mov_b32 s90, s62
    s_mov_b32 s40, s4
    s_and_b32 s41, s5, 0xffff
    s_mov_b32 s42, 0x200000
    s_mov_b32 s43, 0x20000
    v_lshlrev_b32 v2, 5, v0
    s_lshl_b32 s60, s56, 2
    s_add_u32 s60, s60, s57
    s_lshl_b32 s60, s60, 10
    s_add_u32 s59, s60, 0x0
    buffer_load_dwordx4 v[64:67], v1, s[40:43], s59 offen
    s_add_u32 s59, s60, 0x40000
    buffer_load_dwordx4 v[68:71], v1, s[40:43], s59 offen
    s_add_u32 s59, s60, 0x80000
    buffer_load_dwordx4 v[72:75], v1, s[40:43], s59 offen
    s_add_u32 s59, s60, 0xc0000
    buffer_load_dwordx4 v[76:79], v1, s[40:43], s59 offen
    s_add_u32 s59, s60, 0x100000
    buffer_load_dwordx4 v[80:83], v1, s[40:43], s59 offen
    s_add_u32 s59, s60, 0x140000
    buffer_load_dwordx4 v[84:87], v1, s[40:43], s59 offen
    s_add_u32 s59, s60, 0x180000
    buffer_load_dwordx4 v[88:91], v1, s[40:43], s59 offen
    s_add_u32 s59, s60, 0x1c0000
    buffer_load_dwordx4 v[92:95], v1, s[40:43], s59 offen
    v_mov_b32 v3, 0
    s_nop 1
Lrdy_63:
    global_load_dword v4, v3, s[32:33] offset:4 sc1
    s_waitcnt vmcnt(0)
    v_cmp_ne_u32 vcc, 0, v4
    s_nop 0
    s_cmp_eq_u64 vcc, exec
    s_nop 1
    s_cbranch_scc0 Lrdy_63
    v_min_u32 v3, 15, v0
    v_lshlrev_b32 v3, 7, v3
    v_add_u32 v3, 0x624800, v3
    s_mov_b32 s61, 1
    s_nop 0
Lw_64:
    buffer_load_dword v4, v3, s[36:39], 0 offen sc1
    s_waitcnt vmcnt(0)
    v_cmp_le_u32 vcc, s61, v4
    s_nop 0
    s_cmp_eq_u64 vcc, exec
    s_nop 1
    s_cbranch_scc1 Lwd_65
    s_sleep 1
    s_branch Lw_64
Lwd_65:
    s_mov_b32 s59, 0x600800
    buffer_load_dwordx4 v[8:11], v2, s[36:39], s59 offen sc1
    buffer_load_dwordx4 v[12:15], v2, s[36:39], s59 offen offset:16 sc1
    s_mov_b32 s59, 0x600000
    buffer_load_dwordx4 v[16:19], v2, s[36:39], s59 offen sc1
    buffer_load_dwordx4 v[20:23], v2, s[36:39], s59 offen offset:16 sc1
    s_lshl_b32 s59, s56, 7
    s_add_u32 s59, s59, 0x610800
    v_mov_b32 v3, s59
    s_waitcnt vmcnt(0)
    v_add_f32 v8, 1.0, v8
    v_add_f32 v9, 1.0, v9
    v_add_f32 v10, 1.0, v10
    v_add_f32 v11, 1.0, v11
    v_add_f32 v12, 1.0, v12
    v_add_f32 v13, 1.0, v13
    v_add_f32 v14, 1.0, v14
    v_add_f32 v15, 1.0, v15
    v_cvt_pk_bf16_f32 v4, v8, v9
    v_lshlrev_b32 v8, 16, v4
    v_and_b32 v9, s68, v4
    v_cvt_pk_bf16_f32 v4, v10, v11
    v_lshlrev_b32 v10, 16, v4
    v_and_b32 v11, s68, v4
    v_cvt_pk_bf16_f32 v4, v12, v13
    v_lshlrev_b32 v12, 16, v4
    v_and_b32 v13, s68, v4
    v_cvt_pk_bf16_f32 v4, v14, v15
    v_lshlrev_b32 v14, 16, v4
    v_and_b32 v15, s68, v4
    v_lshlrev_b32 v24, 16, v64
    v_and_b32 v25, s68, v64
    v_lshlrev_b32 v26, 16, v65
    v_and_b32 v27, s68, v65
    v_lshlrev_b32 v28, 16, v66
    v_and_b32 v29, s68, v66
    v_lshlrev_b32 v30, 16, v67
    v_and_b32 v31, s68, v67
    v_add_f32 v32, v24, v25
    v_add_f32 v33, v26, v27
    v_add_f32 v34, v28, v29
    v_add_f32 v35, v30, v31
    v_add_f32 v32, v32, v33
    v_add_f32 v34, v34, v35
    v_add_f32 v32, v32, v34
    s_nop 1
    v_add_f32_dpp v32, v32, v32 row_shr:1 row_mask:0xf bank_mask:0xf bound_ctrl:0
    s_nop 1
    v_add_f32_dpp v32, v32, v32 row_shr:2 row_mask:0xf bank_mask:0xf bound_ctrl:0
    s_nop 1
    v_add_f32_dpp v32, v32, v32 row_shr:4 row_mask:0xf bank_mask:0xf bound_ctrl:0
    s_nop 1
    v_add_f32_dpp v32, v32, v32 row_shr:8 row_mask:0xf bank_mask:0xf bound_ctrl:0
    s_nop 1
    v_add_f32_dpp v32, v32, v32 row_bcast:15 row_mask:0xa bank_mask:0xf
    s_nop 1
    v_add_f32_dpp v32, v32, v32 row_bcast:31 row_mask:0xc bank_mask:0xf
    s_nop 0
    v_readlane_b32 s63, v32, 63
    v_mov_b32 v40, 0x3b000000
    s_nop 0
    v_mul_f32 v41, s63, v40
    v_sub_f32 v32, v24, v41
    v_sub_f32 v33, v25, v41
    v_sub_f32 v34, v26, v41
    v_sub_f32 v35, v27, v41
    v_sub_f32 v36, v28, v41
    v_sub_f32 v37, v29, v41
    v_sub_f32 v38, v30, v41
    v_sub_f32 v39, v31, v41
    v_mul_f32 v32, v32, v32
    v_mul_f32 v33, v33, v33
    v_fmac_f32 v32, v34, v34
    v_fmac_f32 v33, v35, v35
    v_fmac_f32 v32, v36, v36
    v_fmac_f32 v33, v37, v37
    v_fmac_f32 v32, v38, v38
    v_fmac_f32 v33, v39, v39
    v_add_f32 v32, v32, v33
    s_nop 1
    v_add_f32_dpp v32, v32, v32 row_shr:1 row_mask:0xf bank_mask:0xf bound_ctrl:0
    s_nop 1
    v_add_f32_dpp v32, v32, v32 row_shr:2 row_mask:0xf bank_mask:0xf bound_ctrl:0
    s_nop 1
    v_add_f32_dpp v32, v32, v32 row_shr:4 row_mask:0xf bank_mask:0xf bound_ctrl:0
    s_nop 1
    v_add_f32_dpp v32, v32, v32 row_shr:8 row_mask:0xf bank_mask:0xf bound_ctrl:0
    s_nop 1
    v_add_f32_dpp v32, v32, v32 row_bcast:15 row_mask:0xa bank_mask:0xf
    s_nop 1
    v_add_f32_dpp v32, v32, v32 row_bcast:31 row_mask:0xc bank_mask:0xf
    s_nop 0
    v_readlane_b32 s63, v32, 63
    s_nop 1
    v_mul_f32 v40, s63, v40
    v_cvt_pk_bf16_f32 v32, v40, v41
    v_lshlrev_b32 v40, 16, v32
    v_and_b32 v41, s68, v32
    v_add_f32 v40, 0x3727c5ac, v40
    v_cvt_pk_bf16_f32 v40, v40, v40
    v_lshlrev_b32 v40, 16, v40
    v_sqrt_f32 v40, v40
    s_nop 0
    v_cvt_pk_bf16_f32 v40, v40, v40
    v_lshlrev_b32 v40, 16, v40
    v_rcp_f32 v40, v40
    v_sub_f32 v24, v24, v41
    v_sub_f32 v25, v25, v41
    v_sub_f32 v26, v26, v41
    v_sub_f32 v27, v27, v41
    v_sub_f32 v28, v28, v41
    v_sub_f32 v29, v29, v41
    v_sub_f32 v30, v30, v41
    v_sub_f32 v31, v31, v41
    v_cvt_pk_bf16_f32 v32, v24, v25
    v_lshlrev_b32 v24, 16, v32
    v_and_b32 v25, s68, v32
    v_cvt_pk_bf16_f32 v33, v26, v27
    v_lshlrev_b32 v26, 16, v33
    v_and_b32 v27, s68, v33
    v_cvt_pk_bf16_f32 v34, v28, v29
    v_lshlrev_b32 v28, 16, v34
    v_and_b32 v29, s68, v34
    v_cvt_pk_bf16_f32 v35, v30, v31
    v_lshlrev_b32 v30, 16, v35
    v_and_b32 v31, s68, v35
    v_mul_f32 v24, v24, v40
    v_mul_f32 v25, v25, v40
    v_mul_f32 v26, v26, v40
    v_mul_f32 v27, v27, v40
    v_mul_f32 v28, v28, v40
    v_mul_f32 v29, v29, v40
    v_mul_f32 v30, v30, v40
    v_mul_f32 v31, v31, v40
    v_cvt_pk_bf16_f32 v32, v24, v25
    v_lshlrev_b32 v24, 16, v32
    v_and_b32 v25, s68, v32
    v_cvt_pk_bf16_f32 v33, v26, v27
    v_lshlrev_b32 v26, 16, v33
    v_and_b32 v27, s68, v33
    v_cvt_pk_bf16_f32 v34, v28, v29
    v_lshlrev_b32 v28, 16, v34
    v_and_b32 v29, s68, v34
    v_cvt_pk_bf16_f32 v35, v30, v31
    v_lshlrev_b32 v30, 16, v35
    v_and_b32 v31, s68, v35
    v_mul_f32 v24, v24, v8
    v_mul_f32 v25, v25, v9
    v_mul_f32 v26, v26, v10
    v_mul_f32 v27, v27, v11
    v_mul_f32 v28, v28, v12
    v_mul_f32 v29, v29, v13
    v_mul_f32 v30, v30, v14
    v_mul_f32 v31, v31, v15
    v_cvt_pk_bf16_f32 v32, v24, v25
    v_lshlrev_b32 v24, 16, v32
    v_and_b32 v25, s68, v32
    v_cvt_pk_bf16_f32 v33, v26, v27
    v_lshlrev_b32 v26, 16, v33
    v_and_b32 v27, s68, v33
    v_cvt_pk_bf16_f32 v34, v28, v29
    v_lshlrev_b32 v28, 16, v34
    v_and_b32 v29, s68, v34
    v_cvt_pk_bf16_f32 v35, v30, v31
    v_lshlrev_b32 v30, 16, v35
    v_and_b32 v31, s68, v35
    v_add_f32 v24, v24, v16
    v_add_f32 v25, v25, v17
    v_add_f32 v26, v26, v18
    v_add_f32 v27, v27, v19
    v_add_f32 v28, v28, v20
    v_add_f32 v29, v29, v21
    v_add_f32 v30, v30, v22
    v_add_f32 v31, v31, v23
    v_cvt_pk_bf16_f32 v44, v24, v25
    v_cvt_pk_bf16_f32 v45, v26, v27
    v_cvt_pk_bf16_f32 v46, v28, v29
    v_cvt_pk_bf16_f32 v47, v30, v31
    s_add_u32 s59, s60, 0x0
    buffer_store_dwordx4 v[44:47], v1, s[36:39], s59 offen sc1
    s_waitcnt vmcnt(0)
    s_barrier
    s_cmp_lg_u32 s57, 0
    s_cbranch_scc1 Lln_66
    s_mov_b32 s59, 1
    v_mov_b32 v4, s59
    s_mov_b64 exec, 1
    buffer_store_dword v4, v3, s[36:39], 0 offen sc1
    s_mov_b64 exec, -1
Lln_66:
    v_lshlrev_b32 v24, 16, v68
    v_and_b32 v25, s68, v68
    v_lshlrev_b32 v26, 16, v69
    v_and_b32 v27, s68, v69
    v_lshlrev_b32 v28, 16, v70
    v_and_b32 v29, s68, v70
    v_lshlrev_b32 v30, 16, v71
    v_and_b32 v31, s68, v71
    v_add_f32 v32, v24, v25
    v_add_f32 v33, v26, v27
    v_add_f32 v34, v28, v29
    v_add_f32 v35, v30, v31
    v_add_f32 v32, v32, v33
    v_add_f32 v34, v34, v35
    v_add_f32 v32, v32, v34
    s_nop 1
    v_add_f32_dpp v32, v32, v32 row_shr:1 row_mask:0xf bank_mask:0xf bound_ctrl:0
    s_nop 1
    v_add_f32_dpp v32, v32, v32 row_shr:2 row_mask:0xf bank_mask:0xf bound_ctrl:0
    s_nop 1
    v_add_f32_dpp v32, v32, v32 row_shr:4 row_mask:0xf bank_mask:0xf bound_ctrl:0
    s_nop 1
    v_add_f32_dpp v32, v32, v32 row_shr:8 row_mask:0xf bank_mask:0xf bound_ctrl:0
    s_nop 1
    v_add_f32_dpp v32, v32, v32 row_bcast:15 row_mask:0xa bank_mask:0xf
    s_nop 1
    v_add_f32_dpp v32, v32, v32 row_bcast:31 row_mask:0xc bank_mask:0xf
    s_nop 0
    v_readlane_b32 s63, v32, 63
    v_mov_b32 v40, 0x3b000000
    s_nop 0
    v_mul_f32 v41, s63, v40
    v_sub_f32 v32, v24, v41
    v_sub_f32 v33, v25, v41
    v_sub_f32 v34, v26, v41
    v_sub_f32 v35, v27, v41
    v_sub_f32 v36, v28, v41
    v_sub_f32 v37, v29, v41
    v_sub_f32 v38, v30, v41
    v_sub_f32 v39, v31, v41
    v_mul_f32 v32, v32, v32
    v_mul_f32 v33, v33, v33
    v_fmac_f32 v32, v34, v34
    v_fmac_f32 v33, v35, v35
    v_fmac_f32 v32, v36, v36
    v_fmac_f32 v33, v37, v37
    v_fmac_f32 v32, v38, v38
    v_fmac_f32 v33, v39, v39
    v_add_f32 v32, v32, v33
    s_nop 1
    v_add_f32_dpp v32, v32, v32 row_shr:1 row_mask:0xf bank_mask:0xf bound_ctrl:0
    s_nop 1
    v_add_f32_dpp v32, v32, v32 row_shr:2 row_mask:0xf bank_mask:0xf bound_ctrl:0
    s_nop 1
    v_add_f32_dpp v32, v32, v32 row_shr:4 row_mask:0xf bank_mask:0xf bound_ctrl:0
    s_nop 1
    v_add_f32_dpp v32, v32, v32 row_shr:8 row_mask:0xf bank_mask:0xf bound_ctrl:0
    s_nop 1
    v_add_f32_dpp v32, v32, v32 row_bcast:15 row_mask:0xa bank_mask:0xf
    s_nop 1
    v_add_f32_dpp v32, v32, v32 row_bcast:31 row_mask:0xc bank_mask:0xf
    s_nop 0
    v_readlane_b32 s63, v32, 63
    s_nop 1
    v_mul_f32 v40, s63, v40
    v_cvt_pk_bf16_f32 v32, v40, v41
    v_lshlrev_b32 v40, 16, v32
    v_and_b32 v41, s68, v32
    v_add_f32 v40, 0x3727c5ac, v40
    v_cvt_pk_bf16_f32 v40, v40, v40
    v_lshlrev_b32 v40, 16, v40
    v_sqrt_f32 v40, v40
    s_nop 0
    v_cvt_pk_bf16_f32 v40, v40, v40
    v_lshlrev_b32 v40, 16, v40
    v_rcp_f32 v40, v40
    v_sub_f32 v24, v24, v41
    v_sub_f32 v25, v25, v41
    v_sub_f32 v26, v26, v41
    v_sub_f32 v27, v27, v41
    v_sub_f32 v28, v28, v41
    v_sub_f32 v29, v29, v41
    v_sub_f32 v30, v30, v41
    v_sub_f32 v31, v31, v41
    v_cvt_pk_bf16_f32 v32, v24, v25
    v_lshlrev_b32 v24, 16, v32
    v_and_b32 v25, s68, v32
    v_cvt_pk_bf16_f32 v33, v26, v27
    v_lshlrev_b32 v26, 16, v33
    v_and_b32 v27, s68, v33
    v_cvt_pk_bf16_f32 v34, v28, v29
    v_lshlrev_b32 v28, 16, v34
    v_and_b32 v29, s68, v34
    v_cvt_pk_bf16_f32 v35, v30, v31
    v_lshlrev_b32 v30, 16, v35
    v_and_b32 v31, s68, v35
    v_mul_f32 v24, v24, v40
    v_mul_f32 v25, v25, v40
    v_mul_f32 v26, v26, v40
    v_mul_f32 v27, v27, v40
    v_mul_f32 v28, v28, v40
    v_mul_f32 v29, v29, v40
    v_mul_f32 v30, v30, v40
    v_mul_f32 v31, v31, v40
    v_cvt_pk_bf16_f32 v32, v24, v25
    v_lshlrev_b32 v24, 16, v32
    v_and_b32 v25, s68, v32
    v_cvt_pk_bf16_f32 v33, v26, v27
    v_lshlrev_b32 v26, 16, v33
    v_and_b32 v27, s68, v33
    v_cvt_pk_bf16_f32 v34, v28, v29
    v_lshlrev_b32 v28, 16, v34
    v_and_b32 v29, s68, v34
    v_cvt_pk_bf16_f32 v35, v30, v31
    v_lshlrev_b32 v30, 16, v35
    v_and_b32 v31, s68, v35
    v_mul_f32 v24, v24, v8
    v_mul_f32 v25, v25, v9
    v_mul_f32 v26, v26, v10
    v_mul_f32 v27, v27, v11
    v_mul_f32 v28, v28, v12
    v_mul_f32 v29, v29, v13
    v_mul_f32 v30, v30, v14
    v_mul_f32 v31, v31, v15
    v_cvt_pk_bf16_f32 v32, v24, v25
    v_lshlrev_b32 v24, 16, v32
    v_and_b32 v25, s68, v32
    v_cvt_pk_bf16_f32 v33, v26, v27
    v_lshlrev_b32 v26, 16, v33
    v_and_b32 v27, s68, v33
    v_cvt_pk_bf16_f32 v34, v28, v29
    v_lshlrev_b32 v28, 16, v34
    v_and_b32 v29, s68, v34
    v_cvt_pk_bf16_f32 v35, v30, v31
    v_lshlrev_b32 v30, 16, v35
    v_and_b32 v31, s68, v35
    v_add_f32 v24, v24, v16
    v_add_f32 v25, v25, v17
    v_add_f32 v26, v26, v18
    v_add_f32 v27, v27, v19
    v_add_f32 v28, v28, v20
    v_add_f32 v29, v29, v21
    v_add_f32 v30, v30, v22
    v_add_f32 v31, v31, v23
    v_cvt_pk_bf16_f32 v48, v24, v25
    v_cvt_pk_bf16_f32 v49, v26, v27
    v_cvt_pk_bf16_f32 v50, v28, v29
    v_cvt_pk_bf16_f32 v51, v30, v31
    s_add_u32 s59, s60, 0x40000
    buffer_store_dwordx4 v[48:51], v1, s[36:39], s59 offen sc1
    v_lshlrev_b32 v24, 16, v72
    v_and_b32 v25, s68, v72
    v_lshlrev_b32 v26, 16, v73
    v_and_b32 v27, s68, v73
    v_lshlrev_b32 v28, 16, v74
    v_and_b32 v29, s68, v74
    v_lshlrev_b32 v30, 16, v75
    v_and_b32 v31, s68, v75
    v_add_f32 v32, v24, v25
    v_add_f32 v33, v26, v27
    v_add_f32 v34, v28, v29
    v_add_f32 v35, v30, v31
    v_add_f32 v32, v32, v33
    v_add_f32 v34, v34, v35
    v_add_f32 v32, v32, v34
    s_nop 1
    v_add_f32_dpp v32, v32, v32 row_shr:1 row_mask:0xf bank_mask:0xf bound_ctrl:0
    s_nop 1
    v_add_f32_dpp v32, v32, v32 row_shr:2 row_mask:0xf bank_mask:0xf bound_ctrl:0
    s_nop 1
    v_add_f32_dpp v32, v32, v32 row_shr:4 row_mask:0xf bank_mask:0xf bound_ctrl:0
    s_nop 1
    v_add_f32_dpp v32, v32, v32 row_shr:8 row_mask:0xf bank_mask:0xf bound_ctrl:0
    s_nop 1
    v_add_f32_dpp v32, v32, v32 row_bcast:15 row_mask:0xa bank_mask:0xf
    s_nop 1
    v_add_f32_dpp v32, v32, v32 row_bcast:31 row_mask:0xc bank_mask:0xf
    s_nop 0
    v_readlane_b32 s63, v32, 63
    v_mov_b32 v40, 0x3b000000
    s_nop 0
    v_mul_f32 v41, s63, v40
    v_sub_f32 v32, v24, v41
    v_sub_f32 v33, v25, v41
    v_sub_f32 v34, v26, v41
    v_sub_f32 v35, v27, v41
    v_sub_f32 v36, v28, v41
    v_sub_f32 v37, v29, v41
    v_sub_f32 v38, v30, v41
    v_sub_f32 v39, v31, v41
    v_mul_f32 v32, v32, v32
    v_mul_f32 v33, v33, v33
    v_fmac_f32 v32, v34, v34
    v_fmac_f32 v33, v35, v35
    v_fmac_f32 v32, v36, v36
    v_fmac_f32 v33, v37, v37
    v_fmac_f32 v32, v38, v38
    v_fmac_f32 v33, v39, v39
    v_add_f32 v32, v32, v33
    s_nop 1
    v_add_f32_dpp v32, v32, v32 row_shr:1 row_mask:0xf bank_mask:0xf bound_ctrl:0
    s_nop 1
    v_add_f32_dpp v32, v32, v32 row_shr:2 row_mask:0xf bank_mask:0xf bound_ctrl:0
    s_nop 1
    v_add_f32_dpp v32, v32, v32 row_shr:4 row_mask:0xf bank_mask:0xf bound_ctrl:0
    s_nop 1
    v_add_f32_dpp v32, v32, v32 row_shr:8 row_mask:0xf bank_mask:0xf bound_ctrl:0
    s_nop 1
    v_add_f32_dpp v32, v32, v32 row_bcast:15 row_mask:0xa bank_mask:0xf
    s_nop 1
    v_add_f32_dpp v32, v32, v32 row_bcast:31 row_mask:0xc bank_mask:0xf
    s_nop 0
    v_readlane_b32 s63, v32, 63
    s_nop 1
    v_mul_f32 v40, s63, v40
    v_cvt_pk_bf16_f32 v32, v40, v41
    v_lshlrev_b32 v40, 16, v32
    v_and_b32 v41, s68, v32
    v_add_f32 v40, 0x3727c5ac, v40
    v_cvt_pk_bf16_f32 v40, v40, v40
    v_lshlrev_b32 v40, 16, v40
    v_sqrt_f32 v40, v40
    s_nop 0
    v_cvt_pk_bf16_f32 v40, v40, v40
    v_lshlrev_b32 v40, 16, v40
    v_rcp_f32 v40, v40
    v_sub_f32 v24, v24, v41
    v_sub_f32 v25, v25, v41
    v_sub_f32 v26, v26, v41
    v_sub_f32 v27, v27, v41
    v_sub_f32 v28, v28, v41
    v_sub_f32 v29, v29, v41
    v_sub_f32 v30, v30, v41
    v_sub_f32 v31, v31, v41
    v_cvt_pk_bf16_f32 v32, v24, v25
    v_lshlrev_b32 v24, 16, v32
    v_and_b32 v25, s68, v32
    v_cvt_pk_bf16_f32 v33, v26, v27
    v_lshlrev_b32 v26, 16, v33
    v_and_b32 v27, s68, v33
    v_cvt_pk_bf16_f32 v34, v28, v29
    v_lshlrev_b32 v28, 16, v34
    v_and_b32 v29, s68, v34
    v_cvt_pk_bf16_f32 v35, v30, v31
    v_lshlrev_b32 v30, 16, v35
    v_and_b32 v31, s68, v35
    v_mul_f32 v24, v24, v40
    v_mul_f32 v25, v25, v40
    v_mul_f32 v26, v26, v40
    v_mul_f32 v27, v27, v40
    v_mul_f32 v28, v28, v40
    v_mul_f32 v29, v29, v40
    v_mul_f32 v30, v30, v40
    v_mul_f32 v31, v31, v40
    v_cvt_pk_bf16_f32 v32, v24, v25
    v_lshlrev_b32 v24, 16, v32
    v_and_b32 v25, s68, v32
    v_cvt_pk_bf16_f32 v33, v26, v27
    v_lshlrev_b32 v26, 16, v33
    v_and_b32 v27, s68, v33
    v_cvt_pk_bf16_f32 v34, v28, v29
    v_lshlrev_b32 v28, 16, v34
    v_and_b32 v29, s68, v34
    v_cvt_pk_bf16_f32 v35, v30, v31
    v_lshlrev_b32 v30, 16, v35
    v_and_b32 v31, s68, v35
    v_mul_f32 v24, v24, v8
    v_mul_f32 v25, v25, v9
    v_mul_f32 v26, v26, v10
    v_mul_f32 v27, v27, v11
    v_mul_f32 v28, v28, v12
    v_mul_f32 v29, v29, v13
    v_mul_f32 v30, v30, v14
    v_mul_f32 v31, v31, v15
    v_cvt_pk_bf16_f32 v32, v24, v25
    v_lshlrev_b32 v24, 16, v32
    v_and_b32 v25, s68, v32
    v_cvt_pk_bf16_f32 v33, v26, v27
    v_lshlrev_b32 v26, 16, v33
    v_and_b32 v27, s68, v33
    v_cvt_pk_bf16_f32 v34, v28, v29
    v_lshlrev_b32 v28, 16, v34
    v_and_b32 v29, s68, v34
    v_cvt_pk_bf16_f32 v35, v30, v31
    v_lshlrev_b32 v30, 16, v35
    v_and_b32 v31, s68, v35
    v_add_f32 v24, v24, v16
    v_add_f32 v25, v25, v17
    v_add_f32 v26, v26, v18
    v_add_f32 v27, v27, v19
    v_add_f32 v28, v28, v20
    v_add_f32 v29, v29, v21
    v_add_f32 v30, v30, v22
    v_add_f32 v31, v31, v23
    v_cvt_pk_bf16_f32 v44, v24, v25
    v_cvt_pk_bf16_f32 v45, v26, v27
    v_cvt_pk_bf16_f32 v46, v28, v29
    v_cvt_pk_bf16_f32 v47, v30, v31
    s_add_u32 s59, s60, 0x80000
    buffer_store_dwordx4 v[44:47], v1, s[36:39], s59 offen sc1
    v_lshlrev_b32 v24, 16, v76
    v_and_b32 v25, s68, v76
    v_lshlrev_b32 v26, 16, v77
    v_and_b32 v27, s68, v77
    v_lshlrev_b32 v28, 16, v78
    v_and_b32 v29, s68, v78
    v_lshlrev_b32 v30, 16, v79
    v_and_b32 v31, s68, v79
    v_add_f32 v32, v24, v25
    v_add_f32 v33, v26, v27
    v_add_f32 v34, v28, v29
    v_add_f32 v35, v30, v31
    v_add_f32 v32, v32, v33
    v_add_f32 v34, v34, v35
    v_add_f32 v32, v32, v34
    s_nop 1
    v_add_f32_dpp v32, v32, v32 row_shr:1 row_mask:0xf bank_mask:0xf bound_ctrl:0
    s_nop 1
    v_add_f32_dpp v32, v32, v32 row_shr:2 row_mask:0xf bank_mask:0xf bound_ctrl:0
    s_nop 1
    v_add_f32_dpp v32, v32, v32 row_shr:4 row_mask:0xf bank_mask:0xf bound_ctrl:0
    s_nop 1
    v_add_f32_dpp v32, v32, v32 row_shr:8 row_mask:0xf bank_mask:0xf bound_ctrl:0
    s_nop 1
    v_add_f32_dpp v32, v32, v32 row_bcast:15 row_mask:0xa bank_mask:0xf
    s_nop 1
    v_add_f32_dpp v32, v32, v32 row_bcast:31 row_mask:0xc bank_mask:0xf
    s_nop 0
    v_readlane_b32 s63, v32, 63
    v_mov_b32 v40, 0x3b000000
    s_nop 0
    v_mul_f32 v41, s63, v40
    v_sub_f32 v32, v24, v41
    v_sub_f32 v33, v25, v41
    v_sub_f32 v34, v26, v41
    v_sub_f32 v35, v27, v41
    v_sub_f32 v36, v28, v41
    v_sub_f32 v37, v29, v41
    v_sub_f32 v38, v30, v41
    v_sub_f32 v39, v31, v41
    v_mul_f32 v32, v32, v32
    v_mul_f32 v33, v33, v33
    v_fmac_f32 v32, v34, v34
    v_fmac_f32 v33, v35, v35
    v_fmac_f32 v32, v36, v36
    v_fmac_f32 v33, v37, v37
    v_fmac_f32 v32, v38, v38
    v_fmac_f32 v33, v39, v39
    v_add_f32 v32, v32, v33
    s_nop 1
    v_add_f32_dpp v32, v32, v32 row_shr:1 row_mask:0xf bank_mask:0xf bound_ctrl:0
    s_nop 1
    v_add_f32_dpp v32, v32, v32 row_shr:2 row_mask:0xf bank_mask:0xf bound_ctrl:0
    s_nop 1
    v_add_f32_dpp v32, v32, v32 row_shr:4 row_mask:0xf bank_mask:0xf bound_ctrl:0
    s_nop 1
    v_add_f32_dpp v32, v32, v32 row_shr:8 row_mask:0xf bank_mask:0xf bound_ctrl:0
    s_nop 1
    v_add_f32_dpp v32, v32, v32 row_bcast:15 row_mask:0xa bank_mask:0xf
    s_nop 1
    v_add_f32_dpp v32, v32, v32 row_bcast:31 row_mask:0xc bank_mask:0xf
    s_nop 0
    v_readlane_b32 s63, v32, 63
    s_nop 1
    v_mul_f32 v40, s63, v40
    v_cvt_pk_bf16_f32 v32, v40, v41
    v_lshlrev_b32 v40, 16, v32
    v_and_b32 v41, s68, v32
    v_add_f32 v40, 0x3727c5ac, v40
    v_cvt_pk_bf16_f32 v40, v40, v40
    v_lshlrev_b32 v40, 16, v40
    v_sqrt_f32 v40, v40
    s_nop 0
    v_cvt_pk_bf16_f32 v40, v40, v40
    v_lshlrev_b32 v40, 16, v40
    v_rcp_f32 v40, v40
    v_sub_f32 v24, v24, v41
    v_sub_f32 v25, v25, v41
    v_sub_f32 v26, v26, v41
    v_sub_f32 v27, v27, v41
    v_sub_f32 v28, v28, v41
    v_sub_f32 v29, v29, v41
    v_sub_f32 v30, v30, v41
    v_sub_f32 v31, v31, v41
    v_cvt_pk_bf16_f32 v32, v24, v25
    v_lshlrev_b32 v24, 16, v32
    v_and_b32 v25, s68, v32
    v_cvt_pk_bf16_f32 v33, v26, v27
    v_lshlrev_b32 v26, 16, v33
    v_and_b32 v27, s68, v33
    v_cvt_pk_bf16_f32 v34, v28, v29
    v_lshlrev_b32 v28, 16, v34
    v_and_b32 v29, s68, v34
    v_cvt_pk_bf16_f32 v35, v30, v31
    v_lshlrev_b32 v30, 16, v35
    v_and_b32 v31, s68, v35
    v_mul_f32 v24, v24, v40
    v_mul_f32 v25, v25, v40
    v_mul_f32 v26, v26, v40
    v_mul_f32 v27, v27, v40
    v_mul_f32 v28, v28, v40
    v_mul_f32 v29, v29, v40
    v_mul_f32 v30, v30, v40
    v_mul_f32 v31, v31, v40
    v_cvt_pk_bf16_f32 v32, v24, v25
    v_lshlrev_b32 v24, 16, v32
    v_and_b32 v25, s68, v32
    v_cvt_pk_bf16_f32 v33, v26, v27
    v_lshlrev_b32 v26, 16, v33
    v_and_b32 v27, s68, v33
    v_cvt_pk_bf16_f32 v34, v28, v29
    v_lshlrev_b32 v28, 16, v34
    v_and_b32 v29, s68, v34
    v_cvt_pk_bf16_f32 v35, v30, v31
    v_lshlrev_b32 v30, 16, v35
    v_and_b32 v31, s68, v35
    v_mul_f32 v24, v24, v8
    v_mul_f32 v25, v25, v9
    v_mul_f32 v26, v26, v10
    v_mul_f32 v27, v27, v11
    v_mul_f32 v28, v28, v12
    v_mul_f32 v29, v29, v13
    v_mul_f32 v30, v30, v14
    v_mul_f32 v31, v31, v15
    v_cvt_pk_bf16_f32 v32, v24, v25
    v_lshlrev_b32 v24, 16, v32
    v_and_b32 v25, s68, v32
    v_cvt_pk_bf16_f32 v33, v26, v27
    v_lshlrev_b32 v26, 16, v33
    v_and_b32 v27, s68, v33
    v_cvt_pk_bf16_f32 v34, v28, v29
    v_lshlrev_b32 v28, 16, v34
    v_and_b32 v29, s68, v34
    v_cvt_pk_bf16_f32 v35, v30, v31
    v_lshlrev_b32 v30, 16, v35
    v_and_b32 v31, s68, v35
    v_add_f32 v24, v24, v16
    v_add_f32 v25, v25, v17
    v_add_f32 v26, v26, v18
    v_add_f32 v27, v27, v19
    v_add_f32 v28, v28, v20
    v_add_f32 v29, v29, v21
    v_add_f32 v30, v30, v22
    v_add_f32 v31, v31, v23
    v_cvt_pk_bf16_f32 v48, v24, v25
    v_cvt_pk_bf16_f32 v49, v26, v27
    v_cvt_pk_bf16_f32 v50, v28, v29
    v_cvt_pk_bf16_f32 v51, v30, v31
    s_add_u32 s59, s60, 0xc0000
    buffer_store_dwordx4 v[48:51], v1, s[36:39], s59 offen sc1
    s_waitcnt vmcnt(0)
    s_barrier
    s_cmp_lg_u32 s57, 0
    s_cbranch_scc1 Lln_67
    s_mov_b32 s59, 4
    v_mov_b32 v4, s59
    s_mov_b64 exec, 1
    buffer_store_dword v4, v3, s[36:39], 0 offen sc1
    s_mov_b64 exec, -1
Lln_67:
    v_lshlrev_b32 v24, 16, v80
    v_and_b32 v25, s68, v80
    v_lshlrev_b32 v26, 16, v81
    v_and_b32 v27, s68, v81
    v_lshlrev_b32 v28, 16, v82
    v_and_b32 v29, s68, v82
    v_lshlrev_b32 v30, 16, v83
    v_and_b32 v31, s68, v83
    v_add_f32 v32, v24, v25
    v_add_f32 v33, v26, v27
    v_add_f32 v34, v28, v29
    v_add_f32 v35, v30, v31
    v_add_f32 v32, v32, v33
    v_add_f32 v34, v34, v35
    v_add_f32 v32, v32, v34
    s_nop 1
    v_add_f32_dpp v32, v32, v32 row_shr:1 row_mask:0xf bank_mask:0xf bound_ctrl:0
    s_nop 1
    v_add_f32_dpp v32, v32, v32 row_shr:2 row_mask:0xf bank_mask:0xf bound_ctrl:0
    s_nop 1
    v_add_f32_dpp v32, v32, v32 row_shr:4 row_mask:0xf bank_mask:0xf bound_ctrl:0
    s_nop 1
    v_add_f32_dpp v32, v32, v32 row_shr:8 row_mask:0xf bank_mask:0xf bound_ctrl:0
    s_nop 1
    v_add_f32_dpp v32, v32, v32 row_bcast:15 row_mask:0xa bank_mask:0xf
    s_nop 1
    v_add_f32_dpp v32, v32, v32 row_bcast:31 row_mask:0xc bank_mask:0xf
    s_nop 0
    v_readlane_b32 s63, v32, 63
    v_mov_b32 v40, 0x3b000000
    s_nop 0
    v_mul_f32 v41, s63, v40
    v_sub_f32 v32, v24, v41
    v_sub_f32 v33, v25, v41
    v_sub_f32 v34, v26, v41
    v_sub_f32 v35, v27, v41
    v_sub_f32 v36, v28, v41
    v_sub_f32 v37, v29, v41
    v_sub_f32 v38, v30, v41
    v_sub_f32 v39, v31, v41
    v_mul_f32 v32, v32, v32
    v_mul_f32 v33, v33, v33
    v_fmac_f32 v32, v34, v34
    v_fmac_f32 v33, v35, v35
    v_fmac_f32 v32, v36, v36
    v_fmac_f32 v33, v37, v37
    v_fmac_f32 v32, v38, v38
    v_fmac_f32 v33, v39, v39
    v_add_f32 v32, v32, v33
    s_nop 1
    v_add_f32_dpp v32, v32, v32 row_shr:1 row_mask:0xf bank_mask:0xf bound_ctrl:0
    s_nop 1
    v_add_f32_dpp v32, v32, v32 row_shr:2 row_mask:0xf bank_mask:0xf bound_ctrl:0
    s_nop 1
    v_add_f32_dpp v32, v32, v32 row_shr:4 row_mask:0xf bank_mask:0xf bound_ctrl:0
    s_nop 1
    v_add_f32_dpp v32, v32, v32 row_shr:8 row_mask:0xf bank_mask:0xf bound_ctrl:0
    s_nop 1
    v_add_f32_dpp v32, v32, v32 row_bcast:15 row_mask:0xa bank_mask:0xf
    s_nop 1
    v_add_f32_dpp v32, v32, v32 row_bcast:31 row_mask:0xc bank_mask:0xf
    s_nop 0
    v_readlane_b32 s63, v32, 63
    s_nop 1
    v_mul_f32 v40, s63, v40
    v_cvt_pk_bf16_f32 v32, v40, v41
    v_lshlrev_b32 v40, 16, v32
    v_and_b32 v41, s68, v32
    v_add_f32 v40, 0x3727c5ac, v40
    v_cvt_pk_bf16_f32 v40, v40, v40
    v_lshlrev_b32 v40, 16, v40
    v_sqrt_f32 v40, v40
    s_nop 0
    v_cvt_pk_bf16_f32 v40, v40, v40
    v_lshlrev_b32 v40, 16, v40
    v_rcp_f32 v40, v40
    v_sub_f32 v24, v24, v41
    v_sub_f32 v25, v25, v41
    v_sub_f32 v26, v26, v41
    v_sub_f32 v27, v27, v41
    v_sub_f32 v28, v28, v41
    v_sub_f32 v29, v29, v41
    v_sub_f32 v30, v30, v41
    v_sub_f32 v31, v31, v41
    v_cvt_pk_bf16_f32 v32, v24, v25
    v_lshlrev_b32 v24, 16, v32
    v_and_b32 v25, s68, v32
    v_cvt_pk_bf16_f32 v33, v26, v27
    v_lshlrev_b32 v26, 16, v33
    v_and_b32 v27, s68, v33
    v_cvt_pk_bf16_f32 v34, v28, v29
    v_lshlrev_b32 v28, 16, v34
    v_and_b32 v29, s68, v34
    v_cvt_pk_bf16_f32 v35, v30, v31
    v_lshlrev_b32 v30, 16, v35
    v_and_b32 v31, s68, v35
    v_mul_f32 v24, v24, v40
    v_mul_f32 v25, v25, v40
    v_mul_f32 v26, v26, v40
    v_mul_f32 v27, v27, v40
    v_mul_f32 v28, v28, v40
    v_mul_f32 v29, v29, v40
    v_mul_f32 v30, v30, v40
    v_mul_f32 v31, v31, v40
    v_cvt_pk_bf16_f32 v32, v24, v25
    v_lshlrev_b32 v24, 16, v32
    v_and_b32 v25, s68, v32
    v_cvt_pk_bf16_f32 v33, v26, v27
    v_lshlrev_b32 v26, 16, v33
    v_and_b32 v27, s68, v33
    v_cvt_pk_bf16_f32 v34, v28, v29
    v_lshlrev_b32 v28, 16, v34
    v_and_b32 v29, s68, v34
    v_cvt_pk_bf16_f32 v35, v30, v31
    v_lshlrev_b32 v30, 16, v35
    v_and_b32 v31, s68, v35
    v_mul_f32 v24, v24, v8
    v_mul_f32 v25, v25, v9
    v_mul_f32 v26, v26, v10
    v_mul_f32 v27, v27, v11
    v_mul_f32 v28, v28, v12
    v_mul_f32 v29, v29, v13
    v_mul_f32 v30, v30, v14
    v_mul_f32 v31, v31, v15
    v_cvt_pk_bf16_f32 v32, v24, v25
    v_lshlrev_b32 v24, 16, v32
    v_and_b32 v25, s68, v32
    v_cvt_pk_bf16_f32 v33, v26, v27
    v_lshlrev_b32 v26, 16, v33
    v_and_b32 v27, s68, v33
    v_cvt_pk_bf16_f32 v34, v28, v29
    v_lshlrev_b32 v28, 16, v34
    v_and_b32 v29, s68, v34
    v_cvt_pk_bf16_f32 v35, v30, v31
    v_lshlrev_b32 v30, 16, v35
    v_and_b32 v31, s68, v35
    v_add_f32 v24, v24, v16
    v_add_f32 v25, v25, v17
    v_add_f32 v26, v26, v18
    v_add_f32 v27, v27, v19
    v_add_f32 v28, v28, v20
    v_add_f32 v29, v29, v21
    v_add_f32 v30, v30, v22
    v_add_f32 v31, v31, v23
    v_cvt_pk_bf16_f32 v44, v24, v25
    v_cvt_pk_bf16_f32 v45, v26, v27
    v_cvt_pk_bf16_f32 v46, v28, v29
    v_cvt_pk_bf16_f32 v47, v30, v31
    s_add_u32 s59, s60, 0x100000
    buffer_store_dwordx4 v[44:47], v1, s[36:39], s59 offen sc1
    v_lshlrev_b32 v24, 16, v84
    v_and_b32 v25, s68, v84
    v_lshlrev_b32 v26, 16, v85
    v_and_b32 v27, s68, v85
    v_lshlrev_b32 v28, 16, v86
    v_and_b32 v29, s68, v86
    v_lshlrev_b32 v30, 16, v87
    v_and_b32 v31, s68, v87
    v_add_f32 v32, v24, v25
    v_add_f32 v33, v26, v27
    v_add_f32 v34, v28, v29
    v_add_f32 v35, v30, v31
    v_add_f32 v32, v32, v33
    v_add_f32 v34, v34, v35
    v_add_f32 v32, v32, v34
    s_nop 1
    v_add_f32_dpp v32, v32, v32 row_shr:1 row_mask:0xf bank_mask:0xf bound_ctrl:0
    s_nop 1
    v_add_f32_dpp v32, v32, v32 row_shr:2 row_mask:0xf bank_mask:0xf bound_ctrl:0
    s_nop 1
    v_add_f32_dpp v32, v32, v32 row_shr:4 row_mask:0xf bank_mask:0xf bound_ctrl:0
    s_nop 1
    v_add_f32_dpp v32, v32, v32 row_shr:8 row_mask:0xf bank_mask:0xf bound_ctrl:0
    s_nop 1
    v_add_f32_dpp v32, v32, v32 row_bcast:15 row_mask:0xa bank_mask:0xf
    s_nop 1
    v_add_f32_dpp v32, v32, v32 row_bcast:31 row_mask:0xc bank_mask:0xf
    s_nop 0
    v_readlane_b32 s63, v32, 63
    v_mov_b32 v40, 0x3b000000
    s_nop 0
    v_mul_f32 v41, s63, v40
    v_sub_f32 v32, v24, v41
    v_sub_f32 v33, v25, v41
    v_sub_f32 v34, v26, v41
    v_sub_f32 v35, v27, v41
    v_sub_f32 v36, v28, v41
    v_sub_f32 v37, v29, v41
    v_sub_f32 v38, v30, v41
    v_sub_f32 v39, v31, v41
    v_mul_f32 v32, v32, v32
    v_mul_f32 v33, v33, v33
    v_fmac_f32 v32, v34, v34
    v_fmac_f32 v33, v35, v35
    v_fmac_f32 v32, v36, v36
    v_fmac_f32 v33, v37, v37
    v_fmac_f32 v32, v38, v38
    v_fmac_f32 v33, v39, v39
    v_add_f32 v32, v32, v33
    s_nop 1
    v_add_f32_dpp v32, v32, v32 row_shr:1 row_mask:0xf bank_mask:0xf bound_ctrl:0
    s_nop 1
    v_add_f32_dpp v32, v32, v32 row_shr:2 row_mask:0xf bank_mask:0xf bound_ctrl:0
    s_nop 1
    v_add_f32_dpp v32, v32, v32 row_shr:4 row_mask:0xf bank_mask:0xf bound_ctrl:0
    s_nop 1
    v_add_f32_dpp v32, v32, v32 row_shr:8 row_mask:0xf bank_mask:0xf bound_ctrl:0
    s_nop 1
    v_add_f32_dpp v32, v32, v32 row_bcast:15 row_mask:0xa bank_mask:0xf
    s_nop 1
    v_add_f32_dpp v32, v32, v32 row_bcast:31 row_mask:0xc bank_mask:0xf
    s_nop 0
    v_readlane_b32 s63, v32, 63
    s_nop 1
    v_mul_f32 v40, s63, v40
    v_cvt_pk_bf16_f32 v32, v40, v41
    v_lshlrev_b32 v40, 16, v32
    v_and_b32 v41, s68, v32
    v_add_f32 v40, 0x3727c5ac, v40
    v_cvt_pk_bf16_f32 v40, v40, v40
    v_lshlrev_b32 v40, 16, v40
    v_sqrt_f32 v40, v40
    s_nop 0
    v_cvt_pk_bf16_f32 v40, v40, v40
    v_lshlrev_b32 v40, 16, v40
    v_rcp_f32 v40, v40
    v_sub_f32 v24, v24, v41
    v_sub_f32 v25, v25, v41
    v_sub_f32 v26, v26, v41
    v_sub_f32 v27, v27, v41
    v_sub_f32 v28, v28, v41
    v_sub_f32 v29, v29, v41
    v_sub_f32 v30, v30, v41
    v_sub_f32 v31, v31, v41
    v_cvt_pk_bf16_f32 v32, v24, v25
    v_lshlrev_b32 v24, 16, v32
    v_and_b32 v25, s68, v32
    v_cvt_pk_bf16_f32 v33, v26, v27
    v_lshlrev_b32 v26, 16, v33
    v_and_b32 v27, s68, v33
    v_cvt_pk_bf16_f32 v34, v28, v29
    v_lshlrev_b32 v28, 16, v34
    v_and_b32 v29, s68, v34
    v_cvt_pk_bf16_f32 v35, v30, v31
    v_lshlrev_b32 v30, 16, v35
    v_and_b32 v31, s68, v35
    v_mul_f32 v24, v24, v40
    v_mul_f32 v25, v25, v40
    v_mul_f32 v26, v26, v40
    v_mul_f32 v27, v27, v40
    v_mul_f32 v28, v28, v40
    v_mul_f32 v29, v29, v40
    v_mul_f32 v30, v30, v40
    v_mul_f32 v31, v31, v40
    v_cvt_pk_bf16_f32 v32, v24, v25
    v_lshlrev_b32 v24, 16, v32
    v_and_b32 v25, s68, v32
    v_cvt_pk_bf16_f32 v33, v26, v27
    v_lshlrev_b32 v26, 16, v33
    v_and_b32 v27, s68, v33
    v_cvt_pk_bf16_f32 v34, v28, v29
    v_lshlrev_b32 v28, 16, v34
    v_and_b32 v29, s68, v34
    v_cvt_pk_bf16_f32 v35, v30, v31
    v_lshlrev_b32 v30, 16, v35
    v_and_b32 v31, s68, v35
    v_mul_f32 v24, v24, v8
    v_mul_f32 v25, v25, v9
    v_mul_f32 v26, v26, v10
    v_mul_f32 v27, v27, v11
    v_mul_f32 v28, v28, v12
    v_mul_f32 v29, v29, v13
    v_mul_f32 v30, v30, v14
    v_mul_f32 v31, v31, v15
    v_cvt_pk_bf16_f32 v32, v24, v25
    v_lshlrev_b32 v24, 16, v32
    v_and_b32 v25, s68, v32
    v_cvt_pk_bf16_f32 v33, v26, v27
    v_lshlrev_b32 v26, 16, v33
    v_and_b32 v27, s68, v33
    v_cvt_pk_bf16_f32 v34, v28, v29
    v_lshlrev_b32 v28, 16, v34
    v_and_b32 v29, s68, v34
    v_cvt_pk_bf16_f32 v35, v30, v31
    v_lshlrev_b32 v30, 16, v35
    v_and_b32 v31, s68, v35
    v_add_f32 v24, v24, v16
    v_add_f32 v25, v25, v17
    v_add_f32 v26, v26, v18
    v_add_f32 v27, v27, v19
    v_add_f32 v28, v28, v20
    v_add_f32 v29, v29, v21
    v_add_f32 v30, v30, v22
    v_add_f32 v31, v31, v23
    v_cvt_pk_bf16_f32 v48, v24, v25
    v_cvt_pk_bf16_f32 v49, v26, v27
    v_cvt_pk_bf16_f32 v50, v28, v29
    v_cvt_pk_bf16_f32 v51, v30, v31
    s_add_u32 s59, s60, 0x140000
    buffer_store_dwordx4 v[48:51], v1, s[36:39], s59 offen sc1
    v_lshlrev_b32 v24, 16, v88
    v_and_b32 v25, s68, v88
    v_lshlrev_b32 v26, 16, v89
    v_and_b32 v27, s68, v89
    v_lshlrev_b32 v28, 16, v90
    v_and_b32 v29, s68, v90
    v_lshlrev_b32 v30, 16, v91
    v_and_b32 v31, s68, v91
    v_add_f32 v32, v24, v25
    v_add_f32 v33, v26, v27
    v_add_f32 v34, v28, v29
    v_add_f32 v35, v30, v31
    v_add_f32 v32, v32, v33
    v_add_f32 v34, v34, v35
    v_add_f32 v32, v32, v34
    s_nop 1
    v_add_f32_dpp v32, v32, v32 row_shr:1 row_mask:0xf bank_mask:0xf bound_ctrl:0
    s_nop 1
    v_add_f32_dpp v32, v32, v32 row_shr:2 row_mask:0xf bank_mask:0xf bound_ctrl:0
    s_nop 1
    v_add_f32_dpp v32, v32, v32 row_shr:4 row_mask:0xf bank_mask:0xf bound_ctrl:0
    s_nop 1
    v_add_f32_dpp v32, v32, v32 row_shr:8 row_mask:0xf bank_mask:0xf bound_ctrl:0
    s_nop 1
    v_add_f32_dpp v32, v32, v32 row_bcast:15 row_mask:0xa bank_mask:0xf
    s_nop 1
    v_add_f32_dpp v32, v32, v32 row_bcast:31 row_mask:0xc bank_mask:0xf
    s_nop 0
    v_readlane_b32 s63, v32, 63
    v_mov_b32 v40, 0x3b000000
    s_nop 0
    v_mul_f32 v41, s63, v40
    v_sub_f32 v32, v24, v41
    v_sub_f32 v33, v25, v41
    v_sub_f32 v34, v26, v41
    v_sub_f32 v35, v27, v41
    v_sub_f32 v36, v28, v41
    v_sub_f32 v37, v29, v41
    v_sub_f32 v38, v30, v41
    v_sub_f32 v39, v31, v41
    v_mul_f32 v32, v32, v32
    v_mul_f32 v33, v33, v33
    v_fmac_f32 v32, v34, v34
    v_fmac_f32 v33, v35, v35
    v_fmac_f32 v32, v36, v36
    v_fmac_f32 v33, v37, v37
    v_fmac_f32 v32, v38, v38
    v_fmac_f32 v33, v39, v39
    v_add_f32 v32, v32, v33
    s_nop 1
    v_add_f32_dpp v32, v32, v32 row_shr:1 row_mask:0xf bank_mask:0xf bound_ctrl:0
    s_nop 1
    v_add_f32_dpp v32, v32, v32 row_shr:2 row_mask:0xf bank_mask:0xf bound_ctrl:0
    s_nop 1
    v_add_f32_dpp v32, v32, v32 row_shr:4 row_mask:0xf bank_mask:0xf bound_ctrl:0
    s_nop 1
    v_add_f32_dpp v32, v32, v32 row_shr:8 row_mask:0xf bank_mask:0xf bound_ctrl:0
    s_nop 1
    v_add_f32_dpp v32, v32, v32 row_bcast:15 row_mask:0xa bank_mask:0xf
    s_nop 1
    v_add_f32_dpp v32, v32, v32 row_bcast:31 row_mask:0xc bank_mask:0xf
    s_nop 0
    v_readlane_b32 s63, v32, 63
    s_nop 1
    v_mul_f32 v40, s63, v40
    v_cvt_pk_bf16_f32 v32, v40, v41
    v_lshlrev_b32 v40, 16, v32
    v_and_b32 v41, s68, v32
    v_add_f32 v40, 0x3727c5ac, v40
    v_cvt_pk_bf16_f32 v40, v40, v40
    v_lshlrev_b32 v40, 16, v40
    v_sqrt_f32 v40, v40
    s_nop 0
    v_cvt_pk_bf16_f32 v40, v40, v40
    v_lshlrev_b32 v40, 16, v40
    v_rcp_f32 v40, v40
    v_sub_f32 v24, v24, v41
    v_sub_f32 v25, v25, v41
    v_sub_f32 v26, v26, v41
    v_sub_f32 v27, v27, v41
    v_sub_f32 v28, v28, v41
    v_sub_f32 v29, v29, v41
    v_sub_f32 v30, v30, v41
    v_sub_f32 v31, v31, v41
    v_cvt_pk_bf16_f32 v32, v24, v25
    v_lshlrev_b32 v24, 16, v32
    v_and_b32 v25, s68, v32
    v_cvt_pk_bf16_f32 v33, v26, v27
    v_lshlrev_b32 v26, 16, v33
    v_and_b32 v27, s68, v33
    v_cvt_pk_bf16_f32 v34, v28, v29
    v_lshlrev_b32 v28, 16, v34
    v_and_b32 v29, s68, v34
    v_cvt_pk_bf16_f32 v35, v30, v31
    v_lshlrev_b32 v30, 16, v35
    v_and_b32 v31, s68, v35
    v_mul_f32 v24, v24, v40
    v_mul_f32 v25, v25, v40
    v_mul_f32 v26, v26, v40
    v_mul_f32 v27, v27, v40
    v_mul_f32 v28, v28, v40
    v_mul_f32 v29, v29, v40
    v_mul_f32 v30, v30, v40
    v_mul_f32 v31, v31, v40
    v_cvt_pk_bf16_f32 v32, v24, v25
    v_lshlrev_b32 v24, 16, v32
    v_and_b32 v25, s68, v32
    v_cvt_pk_bf16_f32 v33, v26, v27
    v_lshlrev_b32 v26, 16, v33
    v_and_b32 v27, s68, v33
    v_cvt_pk_bf16_f32 v34, v28, v29
    v_lshlrev_b32 v28, 16, v34
    v_and_b32 v29, s68, v34
    v_cvt_pk_bf16_f32 v35, v30, v31
    v_lshlrev_b32 v30, 16, v35
    v_and_b32 v31, s68, v35
    v_mul_f32 v24, v24, v8
    v_mul_f32 v25, v25, v9
    v_mul_f32 v26, v26, v10
    v_mul_f32 v27, v27, v11
    v_mul_f32 v28, v28, v12
    v_mul_f32 v29, v29, v13
    v_mul_f32 v30, v30, v14
    v_mul_f32 v31, v31, v15
    v_cvt_pk_bf16_f32 v32, v24, v25
    v_lshlrev_b32 v24, 16, v32
    v_and_b32 v25, s68, v32
    v_cvt_pk_bf16_f32 v33, v26, v27
    v_lshlrev_b32 v26, 16, v33
    v_and_b32 v27, s68, v33
    v_cvt_pk_bf16_f32 v34, v28, v29
    v_lshlrev_b32 v28, 16, v34
    v_and_b32 v29, s68, v34
    v_cvt_pk_bf16_f32 v35, v30, v31
    v_lshlrev_b32 v30, 16, v35
    v_and_b32 v31, s68, v35
    v_add_f32 v24, v24, v16
    v_add_f32 v25, v25, v17
    v_add_f32 v26, v26, v18
    v_add_f32 v27, v27, v19
    v_add_f32 v28, v28, v20
    v_add_f32 v29, v29, v21
    v_add_f32 v30, v30, v22
    v_add_f32 v31, v31, v23
    v_cvt_pk_bf16_f32 v44, v24, v25
    v_cvt_pk_bf16_f32 v45, v26, v27
    v_cvt_pk_bf16_f32 v46, v28, v29
    v_cvt_pk_bf16_f32 v47, v30, v31
    s_add_u32 s59, s60, 0x180000
    buffer_store_dwordx4 v[44:47], v1, s[36:39], s59 offen sc1
    v_lshlrev_b32 v24, 16, v92
    v_and_b32 v25, s68, v92
    v_lshlrev_b32 v26, 16, v93
    v_and_b32 v27, s68, v93
    v_lshlrev_b32 v28, 16, v94
    v_and_b32 v29, s68, v94
    v_lshlrev_b32 v30, 16, v95
    v_and_b32 v31, s68, v95
    v_add_f32 v32, v24, v25
    v_add_f32 v33, v26, v27
    v_add_f32 v34, v28, v29
    v_add_f32 v35, v30, v31
    v_add_f32 v32, v32, v33
    v_add_f32 v34, v34, v35
    v_add_f32 v32, v32, v34
    s_nop 1
    v_add_f32_dpp v32, v32, v32 row_shr:1 row_mask:0xf bank_mask:0xf bound_ctrl:0
    s_nop 1
    v_add_f32_dpp v32, v32, v32 row_shr:2 row_mask:0xf bank_mask:0xf bound_ctrl:0
    s_nop 1
    v_add_f32_dpp v32, v32, v32 row_shr:4 row_mask:0xf bank_mask:0xf bound_ctrl:0
    s_nop 1
    v_add_f32_dpp v32, v32, v32 row_shr:8 row_mask:0xf bank_mask:0xf bound_ctrl:0
    s_nop 1
    v_add_f32_dpp v32, v32, v32 row_bcast:15 row_mask:0xa bank_mask:0xf
    s_nop 1
    v_add_f32_dpp v32, v32, v32 row_bcast:31 row_mask:0xc bank_mask:0xf
    s_nop 0
    v_readlane_b32 s63, v32, 63
    v_mov_b32 v40, 0x3b000000
    s_nop 0
    v_mul_f32 v41, s63, v40
    v_sub_f32 v32, v24, v41
    v_sub_f32 v33, v25, v41
    v_sub_f32 v34, v26, v41
    v_sub_f32 v35, v27, v41
    v_sub_f32 v36, v28, v41
    v_sub_f32 v37, v29, v41
    v_sub_f32 v38, v30, v41
    v_sub_f32 v39, v31, v41
    v_mul_f32 v32, v32, v32
    v_mul_f32 v33, v33, v33
    v_fmac_f32 v32, v34, v34
    v_fmac_f32 v33, v35, v35
    v_fmac_f32 v32, v36, v36
    v_fmac_f32 v33, v37, v37
    v_fmac_f32 v32, v38, v38
    v_fmac_f32 v33, v39, v39
    v_add_f32 v32, v32, v33
    s_nop 1
    v_add_f32_dpp v32, v32, v32 row_shr:1 row_mask:0xf bank_mask:0xf bound_ctrl:0
    s_nop 1
    v_add_f32_dpp v32, v32, v32 row_shr:2 row_mask:0xf bank_mask:0xf bound_ctrl:0
    s_nop 1
    v_add_f32_dpp v32, v32, v32 row_shr:4 row_mask:0xf bank_mask:0xf bound_ctrl:0
    s_nop 1
    v_add_f32_dpp v32, v32, v32 row_shr:8 row_mask:0xf bank_mask:0xf bound_ctrl:0
    s_nop 1
    v_add_f32_dpp v32, v32, v32 row_bcast:15 row_mask:0xa bank_mask:0xf
    s_nop 1
    v_add_f32_dpp v32, v32, v32 row_bcast:31 row_mask:0xc bank_mask:0xf
    s_nop 0
    v_readlane_b32 s63, v32, 63
    s_nop 1
    v_mul_f32 v40, s63, v40
    v_cvt_pk_bf16_f32 v32, v40, v41
    v_lshlrev_b32 v40, 16, v32
    v_and_b32 v41, s68, v32
    v_add_f32 v40, 0x3727c5ac, v40
    v_cvt_pk_bf16_f32 v40, v40, v40
    v_lshlrev_b32 v40, 16, v40
    v_sqrt_f32 v40, v40
    s_nop 0
    v_cvt_pk_bf16_f32 v40, v40, v40
    v_lshlrev_b32 v40, 16, v40
    v_rcp_f32 v40, v40
    v_sub_f32 v24, v24, v41
    v_sub_f32 v25, v25, v41
    v_sub_f32 v26, v26, v41
    v_sub_f32 v27, v27, v41
    v_sub_f32 v28, v28, v41
    v_sub_f32 v29, v29, v41
    v_sub_f32 v30, v30, v41
    v_sub_f32 v31, v31, v41
    v_cvt_pk_bf16_f32 v32, v24, v25
    v_lshlrev_b32 v24, 16, v32
    v_and_b32 v25, s68, v32
    v_cvt_pk_bf16_f32 v33, v26, v27
    v_lshlrev_b32 v26, 16, v33
    v_and_b32 v27, s68, v33
    v_cvt_pk_bf16_f32 v34, v28, v29
    v_lshlrev_b32 v28, 16, v34
    v_and_b32 v29, s68, v34
    v_cvt_pk_bf16_f32 v35, v30, v31
    v_lshlrev_b32 v30, 16, v35
    v_and_b32 v31, s68, v35
    v_mul_f32 v24, v24, v40
    v_mul_f32 v25, v25, v40
    v_mul_f32 v26, v26, v40
    v_mul_f32 v27, v27, v40
    v_mul_f32 v28, v28, v40
    v_mul_f32 v29, v29, v40
    v_mul_f32 v30, v30, v40
    v_mul_f32 v31, v31, v40
    v_cvt_pk_bf16_f32 v32, v24, v25
    v_lshlrev_b32 v24, 16, v32
    v_and_b32 v25, s68, v32
    v_cvt_pk_bf16_f32 v33, v26, v27
    v_lshlrev_b32 v26, 16, v33
    v_and_b32 v27, s68, v33
    v_cvt_pk_bf16_f32 v34, v28, v29
    v_lshlrev_b32 v28, 16, v34
    v_and_b32 v29, s68, v34
    v_cvt_pk_bf16_f32 v35, v30, v31
    v_lshlrev_b32 v30, 16, v35
    v_and_b32 v31, s68, v35
    v_mul_f32 v24, v24, v8
    v_mul_f32 v25, v25, v9
    v_mul_f32 v26, v26, v10
    v_mul_f32 v27, v27, v11
    v_mul_f32 v28, v28, v12
    v_mul_f32 v29, v29, v13
    v_mul_f32 v30, v30, v14
    v_mul_f32 v31, v31, v15
    v_cvt_pk_bf16_f32 v32, v24, v25
    v_lshlrev_b32 v24, 16, v32
    v_and_b32 v25, s68, v32
    v_cvt_pk_bf16_f32 v33, v26, v27
    v_lshlrev_b32 v26, 16, v33
    v_and_b32 v27, s68, v33
    v_cvt_pk_bf16_f32 v34, v28, v29
    v_lshlrev_b32 v28, 16, v34
    v_and_b32 v29, s68, v34
    v_cvt_pk_bf16_f32 v35, v30, v31
    v_lshlrev_b32 v30, 16, v35
    v_and_b32 v31, s68, v35
    v_add_f32 v24, v24, v16
    v_add_f32 v25, v25, v17
    v_add_f32 v26, v26, v18
    v_add_f32 v27, v27, v19
    v_add_f32 v28, v28, v20
    v_add_f32 v29, v29, v21
    v_add_f32 v30, v30, v22
    v_add_f32 v31, v31, v23
    v_cvt_pk_bf16_f32 v48, v24, v25
    v_cvt_pk_bf16_f32 v49, v26, v27
    v_cvt_pk_bf16_f32 v50, v28, v29
    v_cvt_pk_bf16_f32 v51, v30, v31
    s_add_u32 s59, s60, 0x1c0000
    buffer_store_dwordx4 v[48:51], v1, s[36:39], s59 offen sc1
    s_waitcnt vmcnt(0)
    s_barrier
    s_cmp_lg_u32 s57, 0
    s_cbranch_scc1 Lln_68
    s_mov_b32 s59, 8
    v_mov_b32 v4, s59
    s_mov_b64 exec, 1
    buffer_store_dword v4, v3, s[36:39], 0 offen sc1
    s_mov_b64 exec, -1
Lln_68:
    s_and_b32 s56, s56, 31
    s_mov_b32 s91, 1
    s_cmp_eq_u32 s90, 5
    s_cbranch_scc1 Lkv_30
    s_mov_b32 s90, 0
    s_branch Lpost_31
Lx7_10:
    s_add_u32 s56, s56, 32
Lx6_9:
    s_mov_b32 s90, s62
    s_cmp_ge_u32 s56, 48
    s_cbranch_scc1 Lnomod_69
    s_mov_b32 s40, s26
    s_and_b32 s41, s27, 0xffff
    s_mov_b32 s42, 0x400
    s_mov_b32 s43, 0x20000
    s_mov_b32 s44, s28
    s_and_b32 s45, s29, 0xffff
    s_mov_b32 s46, 0x300000
    s_mov_b32 s47, 0x20000
    s_lshl_b32 s59, s57, 6
    v_add_u32 v2, s59, v0
    v_and_b32 v3, 7, v2
    v_lshrrev_b32 v4, 3, v2
    v_lshlrev_b32 v5, 5, v4
    buffer_load_dwordx4 v[8:11], v5, s[40:43], 0 offen
    buffer_load_dwordx4 v[12:15], v5, s[40:43], 0 offen offset:16
    s_mov_b32 s60, 98304
    v_mul_lo_u32 v6, v4, s60
    v_lshl_add_u32 v6, v3, 4, v6
    s_lshl_b32 s60, s56, 7
    s_add_u32 s59, s60, 0
    buffer_load_dwordx4 v[64:67], v6, s[44:47], s59 offen
    s_add_u32 s59, s60, 6144
    buffer_load_dwordx4 v[68:71], v6, s[44:47], s59 offen
    s_add_u32 s59, s60, 12288
    buffer_load_dwordx4 v[72:75], v6, s[44:47], s59 offen
    s_add_u32 s59, s60, 18432
    buffer_load_dwordx4 v[76:79], v6, s[44:47], s59 offen
    s_add_u32 s59, s60, 24576
    buffer_load_dwordx4 v[80:83], v6, s[44:47], s59 offen
    s_add_u32 s59, s60, 30720
    buffer_load_dwordx4 v[84:87], v6, s[44:47], s59 offen
    s_add_u32 s59, s60, 36864
    buffer_load_dwordx4 v[88:91], v6, s[44:47], s59 offen
    s_add_u32 s59, s60, 43008
    buffer_load_dwordx4 v[92:95], v6, s[44:47], s59 offen
    s_add_u32 s59, s60, 49152
    buffer_load_dwordx4 v[96:99], v6, s[44:47], s59 offen
    s_add_u32 s59, s60, 55296
    buffer_load_dwordx4 v[100:103], v6, s[44:47], s59 offen
    s_add_u32 s59, s60, 61440
    buffer_load_dwordx4 v[104:107], v6, s[44:47], s59 offen
    s_add_u32 s59, s60, 67584
    buffer_load_dwordx4 v[108:111], v6, s[44:47], s59 offen
    s_add_u32 s59, s60, 73728
    buffer_load_dwordx4 v[112:115], v6, s[44:47], s59 offen
    s_add_u32 s59, s60, 79872
    buffer_load_dwordx4 v[116:119], v6, s[44:47], s59 offen
    s_add_u32 s59, s60, 86016
    buffer_load_dwordx4 v[120:123], v6, s[44:47], s59 offen
    s_add_u32 s59, s60, 92160
    buffer_load_dwordx4 v[124:127], v6, s[44:47], s59 offen
    s_waitcnt vmcnt(16)
    v_lshlrev_b32 v16, 16, v8
    v_and_b32 v17, s68, v8
    v_lshlrev_b32 v18, 16, v9
    v_and_b32 v19, s68, v9
    v_lshlrev_b32 v20, 16, v10
    v_and_b32 v21, s68, v10
    v_lshlrev_b32 v22, 16, v11
    v_and_b32 v23, s68, v11
    v_lshlrev_b32 v24, 16, v12
    v_and_b32 v25, s68, v12
    v_lshlrev_b32 v26, 16, v13
    v_and_b32 v27, s68, v13
    v_lshlrev_b32 v28, 16, v14
    v_and_b32 v29, s68, v14
    v_lshlrev_b32 v30, 16, v15
    v_and_b32 v31, s68, v15
    v_mul_f32 v32, s69, v16
    v_mul_f32 v33, s69, v17
    v_mul_f32 v34, s69, v18
    v_mul_f32 v35, s69, v19
    v_mul_f32 v36, s69, v20
    v_mul_f32 v37, s69, v21
    v_mul_f32 v38, s69, v22
    v_mul_f32 v39, s69, v23
    v_mul_f32 v40, s69, v24
    v_mul_f32 v41, s69, v25
    v_mul_f32 v42, s69, v26
    v_mul_f32 v43, s69, v27
    v_mul_f32 v44, s69, v28
    v_mul_f32 v45, s69, v29
    v_mul_f32 v46, s69, v30
    v_mul_f32 v47, s69, v31
    v_exp_f32 v32, -v32
    v_exp_f32 v33, -v33
    v_exp_f32 v34, -v34
    v_exp_f32 v35, -v35
    v_exp_f32 v36, -v36
    v_exp_f32 v37, -v37
    v_exp_f32 v38, -v38
    v_exp_f32 v39, -v39
    v_exp_f32 v40, -v40
    v_exp_f32 v41, -v41
    v_exp_f32 v42, -v42
    v_exp_f32 v43, -v43
    v_exp_f32 v44, -v44
    v_exp_f32 v45, -v45
    v_exp_f32 v46, -v46
    v_exp_f32 v47, -v47
    v_add_f32 v32, 1.0, v32
    v_add_f32 v33, 1.0, v33
    v_add_f32 v34, 1.0, v34
    v_add_f32 v35, 1.0, v35
    v_add_f32 v36, 1.0, v36
    v_add_f32 v37, 1.0, v37
    v_add_f32 v38, 1.0, v38
    v_add_f32 v39, 1.0, v39
    v_add_f32 v40, 1.0, v40
    v_add_f32 v41, 1.0, v41
    v_add_f32 v42, 1.0, v42
    v_add_f32 v43, 1.0, v43
    v_add_f32 v44, 1.0, v44
    v_add_f32 v45, 1.0, v45
    v_add_f32 v46, 1.0, v46
    v_add_f32 v47, 1.0, v47
    v_rcp_f32 v32, v32
    v_rcp_f32 v33, v33
    v_rcp_f32 v34, v34
    v_rcp_f32 v35, v35
    v_rcp_f32 v36, v36
    v_rcp_f32 v37, v37
    v_rcp_f32 v38, v38
    v_rcp_f32 v39, v39
    v_rcp_f32 v40, v40
    v_rcp_f32 v41, v41
    v_rcp_f32 v42, v42
    v_rcp_f32 v43, v43
    v_rcp_f32 v44, v44
    v_rcp_f32 v45, v45
    v_rcp_f32 v46, v46
    v_rcp_f32 v47, v47
    v_mul_f32 v16, v16, v32
    v_mul_f32 v17, v17, v33
    v_mul_f32 v18, v18, v34
    v_mul_f32 v19, v19, v35
    v_mul_f32 v20, v20, v36
    v_mul_f32 v21, v21, v37
    v_mul_f32 v22, v22, v38
    v_mul_f32 v23, v23, v39
    v_mul_f32 v24, v24, v40
    v_mul_f32 v25, v25, v41
    v_mul_f32 v26, v26, v42
    v_mul_f32 v27, v27, v43
    v_mul_f32 v28, v28, v44
    v_mul_f32 v29, v29, v45
    v_mul_f32 v30, v30, v46
    v_mul_f32 v31, v31, v47
    v_cvt_pk_bf16_f32 v48, v16, v17
    v_lshlrev_b32 v16, 16, v48
    v_and_b32 v17, s68, v48
    v_cvt_pk_bf16_f32 v48, v18, v19
    v_lshlrev_b32 v18, 16, v48
    v_and_b32 v19, s68, v48
    v_cvt_pk_bf16_f32 v48, v20, v21
    v_lshlrev_b32 v20, 16, v48
    v_and_b32 v21, s68, v48
    v_cvt_pk_bf16_f32 v48, v22, v23
    v_lshlrev_b32 v22, 16, v48
    v_and_b32 v23, s68, v48
    v_cvt_pk_bf16_f32 v48, v24, v25
    v_lshlrev_b32 v24, 16, v48
    v_and_b32 v25, s68, v48
    v_cvt_pk_bf16_f32 v48, v26, v27
    v_lshlrev_b32 v26, 16, v48
    v_and_b32 v27, s68, v48
    v_cvt_pk_bf16_f32 v48, v28, v29
    v_lshlrev_b32 v28, 16, v48
    v_and_b32 v29, s68, v48
    v_cvt_pk_bf16_f32 v48, v30, v31
    v_lshlrev_b32 v30, 16, v48
    v_and_b32 v31, s68, v48
    v_mov_b32 v32, 0
    v_mov_b32 v33, 0
    v_mov_b32 v34, 0
    v_mov_b32 v35, 0
    v_mov_b32 v36, 0
    v_mov_b32 v37, 0
    v_mov_b32 v38, 0
    v_mov_b32 v39, 0
    s_waitcnt vmcnt(15)
    v_lshlrev_b32 v48, 16, v64
    v_and_b32 v49, s68, v64
    v_fmac_f32 v32, v16, v48
    v_fmac_f32 v33, v16, v49
    v_lshlrev_b32 v48, 16, v65
    v_and_b32 v49, s68, v65
    v_fmac_f32 v34, v16, v48
    v_fmac_f32 v35, v16, v49
    v_lshlrev_b32 v48, 16, v66
    v_and_b32 v49, s68, v66
    v_fmac_f32 v36, v16, v48
    v_fmac_f32 v37, v16, v49
    v_lshlrev_b32 v48, 16, v67
    v_and_b32 v49, s68, v67
    v_fmac_f32 v38, v16, v48
    v_fmac_f32 v39, v16, v49
    s_waitcnt vmcnt(14)
    v_lshlrev_b32 v48, 16, v68
    v_and_b32 v49, s68, v68
    v_fmac_f32 v32, v17, v48
    v_fmac_f32 v33, v17, v49
    v_lshlrev_b32 v48, 16, v69
    v_and_b32 v49, s68, v69
    v_fmac_f32 v34, v17, v48
    v_fmac_f32 v35, v17, v49
    v_lshlrev_b32 v48, 16, v70
    v_and_b32 v49, s68, v70
    v_fmac_f32 v36, v17, v48
    v_fmac_f32 v37, v17, v49
    v_lshlrev_b32 v48, 16, v71
    v_and_b32 v49, s68, v71
    v_fmac_f32 v38, v17, v48
    v_fmac_f32 v39, v17, v49
    s_waitcnt vmcnt(13)
    v_lshlrev_b32 v48, 16, v72
    v_and_b32 v49, s68, v72
    v_fmac_f32 v32, v18, v48
    v_fmac_f32 v33, v18, v49
    v_lshlrev_b32 v48, 16, v73
    v_and_b32 v49, s68, v73
    v_fmac_f32 v34, v18, v48
    v_fmac_f32 v35, v18, v49
    v_lshlrev_b32 v48, 16, v74
    v_and_b32 v49, s68, v74
    v_fmac_f32 v36, v18, v48
    v_fmac_f32 v37, v18, v49
    v_lshlrev_b32 v48, 16, v75
    v_and_b32 v49, s68, v75
    v_fmac_f32 v38, v18, v48
    v_fmac_f32 v39, v18, v49
    s_waitcnt vmcnt(12)
    v_lshlrev_b32 v48, 16, v76
    v_and_b32 v49, s68, v76
    v_fmac_f32 v32, v19, v48
    v_fmac_f32 v33, v19, v49
    v_lshlrev_b32 v48, 16, v77
    v_and_b32 v49, s68, v77
    v_fmac_f32 v34, v19, v48
    v_fmac_f32 v35, v19, v49
    v_lshlrev_b32 v48, 16, v78
    v_and_b32 v49, s68, v78
    v_fmac_f32 v36, v19, v48
    v_fmac_f32 v37, v19, v49
    v_lshlrev_b32 v48, 16, v79
    v_and_b32 v49, s68, v79
    v_fmac_f32 v38, v19, v48
    v_fmac_f32 v39, v19, v49
    s_waitcnt vmcnt(11)
    v_lshlrev_b32 v48, 16, v80
    v_and_b32 v49, s68, v80
    v_fmac_f32 v32, v20, v48
    v_fmac_f32 v33, v20, v49
    v_lshlrev_b32 v48, 16, v81
    v_and_b32 v49, s68, v81
    v_fmac_f32 v34, v20, v48
    v_fmac_f32 v35, v20, v49
    v_lshlrev_b32 v48, 16, v82
    v_and_b32 v49, s68, v82
    v_fmac_f32 v36, v20, v48
    v_fmac_f32 v37, v20, v49
    v_lshlrev_b32 v48, 16, v83
    v_and_b32 v49, s68, v83
    v_fmac_f32 v38, v20, v48
    v_fmac_f32 v39, v20, v49
    s_waitcnt vmcnt(10)
    v_lshlrev_b32 v48, 16, v84
    v_and_b32 v49, s68, v84
    v_fmac_f32 v32, v21, v48
    v_fmac_f32 v33, v21, v49
    v_lshlrev_b32 v48, 16, v85
    v_and_b32 v49, s68, v85
    v_fmac_f32 v34, v21, v48
    v_fmac_f32 v35, v21, v49
    v_lshlrev_b32 v48, 16, v86
    v_and_b32 v49, s68, v86
    v_fmac_f32 v36, v21, v48
    v_fmac_f32 v37, v21, v49
    v_lshlrev_b32 v48, 16, v87
    v_and_b32 v49, s68, v87
    v_fmac_f32 v38, v21, v48
    v_fmac_f32 v39, v21, v49
    s_waitcnt vmcnt(9)
    v_lshlrev_b32 v48, 16, v88
    v_and_b32 v49, s68, v88
    v_fmac_f32 v32, v22, v48
    v_fmac_f32 v33, v22, v49
    v_lshlrev_b32 v48, 16, v89
    v_and_b32 v49, s68, v89
    v_fmac_f32 v34, v22, v48
    v_fmac_f32 v35, v22, v49
    v_lshlrev_b32 v48, 16, v90
    v_and_b32 v49, s68, v90
    v_fmac_f32 v36, v22, v48
    v_fmac_f32 v37, v22, v49
    v_lshlrev_b32 v48, 16, v91
    v_and_b32 v49, s68, v91
    v_fmac_f32 v38, v22, v48
    v_fmac_f32 v39, v22, v49
    s_waitcnt vmcnt(8)
    v_lshlrev_b32 v48, 16, v92
    v_and_b32 v49, s68, v92
    v_fmac_f32 v32, v23, v48
    v_fmac_f32 v33, v23, v49
    v_lshlrev_b32 v48, 16, v93
    v_and_b32 v49, s68, v93
    v_fmac_f32 v34, v23, v48
    v_fmac_f32 v35, v23, v49
    v_lshlrev_b32 v48, 16, v94
    v_and_b32 v49, s68, v94
    v_fmac_f32 v36, v23, v48
    v_fmac_f32 v37, v23, v49
    v_lshlrev_b32 v48, 16, v95
    v_and_b32 v49, s68, v95
    v_fmac_f32 v38, v23, v48
    v_fmac_f32 v39, v23, v49
    s_waitcnt vmcnt(7)
    v_lshlrev_b32 v48, 16, v96
    v_and_b32 v49, s68, v96
    v_fmac_f32 v32, v24, v48
    v_fmac_f32 v33, v24, v49
    v_lshlrev_b32 v48, 16, v97
    v_and_b32 v49, s68, v97
    v_fmac_f32 v34, v24, v48
    v_fmac_f32 v35, v24, v49
    v_lshlrev_b32 v48, 16, v98
    v_and_b32 v49, s68, v98
    v_fmac_f32 v36, v24, v48
    v_fmac_f32 v37, v24, v49
    v_lshlrev_b32 v48, 16, v99
    v_and_b32 v49, s68, v99
    v_fmac_f32 v38, v24, v48
    v_fmac_f32 v39, v24, v49
    s_waitcnt vmcnt(6)
    v_lshlrev_b32 v48, 16, v100
    v_and_b32 v49, s68, v100
    v_fmac_f32 v32, v25, v48
    v_fmac_f32 v33, v25, v49
    v_lshlrev_b32 v48, 16, v101
    v_and_b32 v49, s68, v101
    v_fmac_f32 v34, v25, v48
    v_fmac_f32 v35, v25, v49
    v_lshlrev_b32 v48, 16, v102
    v_and_b32 v49, s68, v102
    v_fmac_f32 v36, v25, v48
    v_fmac_f32 v37, v25, v49
    v_lshlrev_b32 v48, 16, v103
    v_and_b32 v49, s68, v103
    v_fmac_f32 v38, v25, v48
    v_fmac_f32 v39, v25, v49
    s_waitcnt vmcnt(5)
    v_lshlrev_b32 v48, 16, v104
    v_and_b32 v49, s68, v104
    v_fmac_f32 v32, v26, v48
    v_fmac_f32 v33, v26, v49
    v_lshlrev_b32 v48, 16, v105
    v_and_b32 v49, s68, v105
    v_fmac_f32 v34, v26, v48
    v_fmac_f32 v35, v26, v49
    v_lshlrev_b32 v48, 16, v106
    v_and_b32 v49, s68, v106
    v_fmac_f32 v36, v26, v48
    v_fmac_f32 v37, v26, v49
    v_lshlrev_b32 v48, 16, v107
    v_and_b32 v49, s68, v107
    v_fmac_f32 v38, v26, v48
    v_fmac_f32 v39, v26, v49
    s_waitcnt vmcnt(4)
    v_lshlrev_b32 v48, 16, v108
    v_and_b32 v49, s68, v108
    v_fmac_f32 v32, v27, v48
    v_fmac_f32 v33, v27, v49
    v_lshlrev_b32 v48, 16, v109
    v_and_b32 v49, s68, v109
    v_fmac_f32 v34, v27, v48
    v_fmac_f32 v35, v27, v49
    v_lshlrev_b32 v48, 16, v110
    v_and_b32 v49, s68, v110
    v_fmac_f32 v36, v27, v48
    v_fmac_f32 v37, v27, v49
    v_lshlrev_b32 v48, 16, v111
    v_and_b32 v49, s68, v111
    v_fmac_f32 v38, v27, v48
    v_fmac_f32 v39, v27, v49
    s_waitcnt vmcnt(3)
    v_lshlrev_b32 v48, 16, v112
    v_and_b32 v49, s68, v112
    v_fmac_f32 v32, v28, v48
    v_fmac_f32 v33, v28, v49
    v_lshlrev_b32 v48, 16, v113
    v_and_b32 v49, s68, v113
    v_fmac_f32 v34, v28, v48
    v_fmac_f32 v35, v28, v49
    v_lshlrev_b32 v48, 16, v114
    v_and_b32 v49, s68, v114
    v_fmac_f32 v36, v28, v48
    v_fmac_f32 v37, v28, v49
    v_lshlrev_b32 v48, 16, v115
    v_and_b32 v49, s68, v115
    v_fmac_f32 v38, v28, v48
    v_fmac_f32 v39, v28, v49
    s_waitcnt vmcnt(2)
    v_lshlrev_b32 v48, 16, v116
    v_and_b32 v49, s68, v116
    v_fmac_f32 v32, v29, v48
    v_fmac_f32 v33, v29, v49
    v_lshlrev_b32 v48, 16, v117
    v_and_b32 v49, s68, v117
    v_fmac_f32 v34, v29, v48
    v_fmac_f32 v35, v29, v49
    v_lshlrev_b32 v48, 16, v118
    v_and_b32 v49, s68, v118
    v_fmac_f32 v36, v29, v48
    v_fmac_f32 v37, v29, v49
    v_lshlrev_b32 v48, 16, v119
    v_and_b32 v49, s68, v119
    v_fmac_f32 v38, v29, v48
    v_fmac_f32 v39, v29, v49
    s_waitcnt vmcnt(1)
    v_lshlrev_b32 v48, 16, v120
    v_and_b32 v49, s68, v120
    v_fmac_f32 v32, v30, v48
    v_fmac_f32 v33, v30, v49
    v_lshlrev_b32 v48, 16, v121
    v_and_b32 v49, s68, v121
    v_fmac_f32 v34, v30, v48
    v_fmac_f32 v35, v30, v49
    v_lshlrev_b32 v48, 16, v122
    v_and_b32 v49, s68, v122
    v_fmac_f32 v36, v30, v48
    v_fmac_f32 v37, v30, v49
    v_lshlrev_b32 v48, 16, v123
    v_and_b32 v49, s68, v123
    v_fmac_f32 v38, v30, v48
    v_fmac_f32 v39, v30, v49
    s_waitcnt vmcnt(0)
    v_lshlrev_b32 v48, 16, v124
    v_and_b32 v49, s68, v124
    v_fmac_f32 v32, v31, v48
    v_fmac_f32 v33, v31, v49
    v_lshlrev_b32 v48, 16, v125
    v_and_b32 v49, s68, v125
    v_fmac_f32 v34, v31, v48
    v_fmac_f32 v35, v31, v49
    v_lshlrev_b32 v48, 16, v126
    v_and_b32 v49, s68, v126
    v_fmac_f32 v36, v31, v48
    v_fmac_f32 v37, v31, v49
    v_lshlrev_b32 v48, 16, v127
    v_and_b32 v49, s68, v127
    v_fmac_f32 v38, v31, v48
    v_fmac_f32 v39, v31, v49
    v_lshlrev_b32 v5, 8, v4
    v_lshl_add_u32 v5, v3, 5, v5
    ds_write_b128 v5, v[32:35]
    ds_write_b128 v5, v[36:39] offset:16
    s_waitcnt lgkmcnt(0)
    s_barrier
    s_cmp_lg_u32 s57, 0
    s_cbranch_scc1 Lmodend_71
    v_lshlrev_b32 v5, 2, v0
    ds_read_b32 v64, v5 offset:0
    ds_read_b32 v65, v5 offset:256
    ds_read_b32 v66, v5 offset:512
    ds_read_b32 v67, v5 offset:768
    ds_read_b32 v68, v5 offset:1024
    ds_read_b32 v69, v5 offset:1280
    ds_read_b32 v70, v5 offset:1536
    ds_read_b32 v71, v5 offset:1792
    ds_read_b32 v72, v5 offset:2048
    ds_read_b32 v73, v5 offset:2304
    ds_read_b32 v74, v5 offset:2560
    ds_read_b32 v75, v5 offset:2816
    ds_read_b32 v76, v5 offset:3072
    ds_read_b32 v77, v5 offset:3328
    ds_read_b32 v78, v5 offset:3584
    s_waitcnt lgkmcnt(0)
    ds_read_b32 v79, v5 offset:3840
    ds_read_b32 v80, v5 offset:4096
    ds_read_b32 v81, v5 offset:4352
    ds_read_b32 v82, v5 offset:4608
    ds_read_b32 v83, v5 offset:4864
    ds_read_b32 v84, v5 offset:5120
    ds_read_b32 v85, v5 offset:5376
    ds_read_b32 v86, v5 offset:5632
    ds_read_b32 v87, v5 offset:5888
    ds_read_b32 v88, v5 offset:6144
    ds_read_b32 v89, v5 offset:6400
    ds_read_b32 v90, v5 offset:6656
    ds_read_b32 v91, v5 offset:6912
    ds_read_b32 v92, v5 offset:7168
    ds_read_b32 v93, v5 offset:7424
    s_waitcnt lgkmcnt(0)
    ds_read_b32 v94, v5 offset:7680
    ds_read_b32 v95, v5 offset:7936
    s_waitcnt lgkmcnt(0)
    v_add_f32 v64, v64, v80
    v_add_f32 v65, v65, v81
    v_add_f32 v66, v66, v82
    v_add_f32 v67, v67, v83
    v_add_f32 v68, v68, v84
    v_add_f32 v69, v69, v85
    v_add_f32 v70, v70, v86
    v_add_f32 v71, v71, v87
    v_add_f32 v72, v72, v88
    v_add_f32 v73, v73, v89
    v_add_f32 v74, v74, v90
    v_add_f32 v75, v75, v91
    v_add_f32 v76, v76, v92
    v_add_f32 v77, v77, v93
    v_add_f32 v78, v78, v94
    v_add_f32 v79, v79, v95
    v_add_f32 v64, v64, v72
    v_add_f32 v65, v65, v73
    v_add_f32 v66, v66, v74
    v_add_f32 v67, v67, v75
    v_add_f32 v68, v68, v76
    v_add_f32 v69, v69, v77
    v_add_f32 v70, v70, v78
    v_add_f32 v71, v71, v79
    v_add_f32 v64, v64, v68
    v_add_f32 v65, v65, v69
    v_add_f32 v66, v66, v70
    v_add_f32 v67, v67, v71
    v_add_f32 v64, v64, v66
    v_add_f32 v65, v65, v67
    v_add_f32 v64, v64, v65
    v_cvt_pk_bf16_f32 v64, v64, v64
    v_lshlrev_b32 v64, 16, v64
    s_lshl_b32 s59, s56, 8
    s_add_u32 s59, s59, 0x600000
    buffer_store_dword v64, v5, s[36:39], s59 offen sc1
    v_mov_b32 v6, 0
    s_nop 1
Lrdy_72:
    global_load_dword v7, v6, s[32:33] offset:4 sc1
    s_waitcnt vmcnt(0)
    v_cmp_ne_u32 vcc, 0, v7
    s_nop 0
    s_cmp_eq_u64 vcc, exec
    s_nop 1
    s_cbranch_scc0 Lrdy_72
    s_lshl_b32 s59, s56, 7
    s_add_u32 s59, s59, 0x624800
    v_mov_b32 v6, 1
    s_mov_b64 exec, 1
    buffer_store_dword v6, off, s[36:39], s59 sc1
    s_mov_b64 exec, -1
Lmodend_71:
    s_barrier
Lnomod_69:
    s_cmp_lg_u32 s56, 48
    s_cbranch_scc1 Lnoz_70
    v_mov_b32 v4, 0
    v_mov_b32 v5, 0
    v_mov_b32 v6, 0
    v_mov_b32 v7, 0
    s_lshl_b32 s59, s57, 10
    s_add_u32 s59, s59, 0x610000
    buffer_store_dwordx4 v[4:7], v1, s[36:39], s59 offen sc1
    s_add_u32 s59, s59, 4096
    buffer_store_dwordx4 v[4:7], v1, s[36:39], s59 offen sc1
    s_add_u32 s59, s59, 4096
    buffer_store_dwordx4 v[4:7], v1, s[36:39], s59 offen sc1
    s_add_u32 s59, s59, 4096
    buffer_store_dwordx4 v[4:7], v1, s[36:39], s59 offen sc1
    s_add_u32 s59, s59, 4096
    buffer_store_dwordx4 v[4:7], v1, s[36:39], s59 offen sc1
    s_add_u32 s59, s59, 4096
    buffer_store_dwordx4 v[4:7], v1, s[36:39], s59 offen sc1
    s_add_u32 s59, s59, 4096
    buffer_store_dwordx4 v[4:7], v1, s[36:39], s59 offen sc1
    s_add_u32 s59, s59, 4096
    buffer_store_dwordx4 v[4:7], v1, s[36:39], s59 offen sc1
    s_add_u32 s59, s59, 4096
    buffer_store_dwordx4 v[4:7], v1, s[36:39], s59 offen sc1
    s_add_u32 s59, s59, 4096
    buffer_store_dwordx4 v[4:7], v1, s[36:39], s59 offen sc1
    s_add_u32 s59, s59, 4096
    buffer_store_dwordx4 v[4:7], v1, s[36:39], s59 offen sc1
    s_add_u32 s59, s59, 4096
    buffer_store_dwordx4 v[4:7], v1, s[36:39], s59 offen sc1
    s_add_u32 s59, s59, 4096
    buffer_store_dwordx4 v[4:7], v1, s[36:39], s59 offen sc1
    s_add_u32 s59, s59, 4096
    buffer_store_dwordx4 v[4:7], v1, s[36:39], s59 offen sc1
    s_add_u32 s59, s59, 4096
    buffer_store_dwordx4 v[4:7], v1, s[36:39], s59 offen sc1
    s_add_u32 s59, s59, 4096
    buffer_store_dwordx4 v[4:7], v1, s[36:39], s59 offen sc1
    s_add_u32 s59, s59, 4096
    buffer_store_dwordx4 v[4:7], v1, s[36:39], s59 offen sc1
    s_add_u32 s59, s59, 4096
    buffer_store_dwordx4 v[4:7], v1, s[36:39], s59 offen sc1
    s_add_u32 s59, s59, 4096
    buffer_store_dwordx4 v[4:7], v1, s[36:39], s59 offen sc1
    s_add_u32 s59, s59, 4096
    buffer_store_dwordx4 v[4:7], v1, s[36:39], s59 offen sc1
    s_add_u32 s59, s59, 4096
    buffer_store_dwordx4 v[4:7], v1, s[36:39], s59 offen sc1
    s_add_u32 s59, s59, 4096
    buffer_store_dwordx4 v[4:7], v1, s[36:39], s59 offen sc1
    s_add_u32 s59, s59, 4096
    buffer_store_dwordx4 v[4:7], v1, s[36:39], s59 offen sc1
    s_add_u32 s59, s59, 4096
    buffer_store_dwordx4 v[4:7], v1, s[36:39], s59 offen sc1
    s_add_u32 s59, s59, 4096
    buffer_store_dwordx4 v[4:7], v1, s[36:39], s59 offen sc1
    s_add_u32 s59, s59, 4096
    buffer_store_dwordx4 v[4:7], v1, s[36:39], s59 offen sc1
    s_add_u32 s59, s59, 4096
    buffer_store_dwordx4 v[4:7], v1, s[36:39], s59 offen sc1
    s_add_u32 s59, s59, 4096
    buffer_store_dwordx4 v[4:7], v1, s[36:39], s59 offen sc1
    s_add_u32 s59, s59, 4096
    buffer_store_dwordx4 v[4:7], v1, s[36:39], s59 offen sc1
    s_add_u32 s59, s59, 4096
    buffer_store_dwordx4 v[4:7], v1, s[36:39], s59 offen sc1
    s_add_u32 s59, s59, 4096
    buffer_store_dwordx4 v[4:7], v1, s[36:39], s59 offen sc1
    s_add_u32 s59, s59, 4096
    buffer_store_dwordx4 v[4:7], v1, s[36:39], s59 offen sc1
    s_add_u32 s59, s59, 4096
    buffer_store_dwordx4 v[4:7], v1, s[36:39], s59 offen sc1
    s_add_u32 s59, s59, 4096
    buffer_store_dwordx4 v[4:7], v1, s[36:39], s59 offen sc1
    s_add_u32 s59, s59, 4096
    buffer_store_dwordx4 v[4:7], v1, s[36:39], s59 offen sc1
    s_add_u32 s59, s59, 4096
    buffer_store_dwordx4 v[4:7], v1, s[36:39], s59 offen sc1
    s_add_u32 s59, s59, 4096
    buffer_store_dwordx4 v[4:7], v1, s[36:39], s59 offen sc1
    s_add_u32 s59, s59, 4096
    buffer_store_dwordx4 v[4:7], v1, s[36:39], s59 offen sc1
    s_add_u32 s59, s59, 4096
    buffer_store_dwordx4 v[4:7], v1, s[36:39], s59 offen sc1
    s_add_u32 s59, s59, 4096
    buffer_store_dwordx4 v[4:7], v1, s[36:39], s59 offen sc1
    s_add_u32 s59, s59, 4096
    buffer_store_dwordx4 v[4:7], v1, s[36:39], s59 offen sc1
    s_add_u32 s59, s59, 4096
    buffer_store_dwordx4 v[4:7], v1, s[36:39], s59 offen sc1
    s_add_u32 s59, s59, 4096
    buffer_store_dwordx4 v[4:7], v1, s[36:39], s59 offen sc1
    s_add_u32 s59, s59, 4096
    s_waitcnt vmcnt(0)
    s_barrier
    v_mov_b32 v5, 1
    s_mov_b64 exec, 1
    global_store_dword v4, v5, s[32:33] offset:4 sc1
    s_mov_b64 exec, -1
Lnoz_70:
    s_mov_b32 s62, s90
    s_and_b32 s56, s56, 31
    s_sub_u32 s91, s62, 4
    s_branch Lkv_30
Lpost_31:
    s_mov_b32 s40, s14
    s_and_b32 s41, s15, 0xffff
    s_mov_b32 s42, 0x400000
    s_mov_b32 s43, 0x20000
    s_mov_b32 s44, s20
    s_and_b32 s45, s21, 0xffff
    s_mov_b32 s46, 0x1c0000
    s_mov_b32 s47, 0x20000
    s_mov_b32 s48, s22
    s_and_b32 s49, s23, 0xffff
    s_mov_b32 s50, 0x1c0000
    s_mov_b32 s51, 0x20000
    s_mov_b32 s52, s24
    s_and_b32 s53, s25, 0xffff
    s_mov_b32 s54, 0x1c0000
    s_mov_b32 s55, 0x20000
    v_lshrrev_b32 v30, 4, v0
    s_mov_b32 s59, 8192
    v_mul_lo_u32 v28, v30, s59
    v_and_b32 v30, 14, v0
    v_lshl_add_u32 v28, v30, 1, v28
    v_and_b32 v30, 1, v0
    v_cmp_eq_u32 vcc, 1, v30
    v_mov_b32 v29, s66
    v_mov_b32 v30, s67
    v_cndmask_b32 v29, v29, v30, vcc
    s_lshr_b32 s80, s56, 3
    s_and_b32 s81, s56, 7
    s_lshl_b32 s72, s80, 2
    s_add_u32 s72, s72, s57
    s_lshl_b32 s82, s72, 18
    s_lshl_b32 s59, s81, 7
    s_add_u32 s82, s82, s59
    s_add_u32 s59, s82, 0x0
    buffer_load_dword v64, v28, s[40:43], s59 offen
    s_add_u32 s59, s82, 0x400
    buffer_load_dword v65, v28, s[40:43], s59 offen
    s_add_u32 s59, s82, 0x800
    buffer_load_dword v66, v28, s[40:43], s59 offen
    s_add_u32 s59, s82, 0xc00
    buffer_load_dword v67, v28, s[40:43], s59 offen
    s_add_u32 s59, s82, 0x1000
    buffer_load_dword v68, v28, s[40:43], s59 offen
    s_add_u32 s59, s82, 0x1400
    buffer_load_dword v69, v28, s[40:43], s59 offen
    s_add_u32 s59, s82, 0x1800
    buffer_load_dword v70, v28, s[40:43], s59 offen
    s_add_u32 s59, s82, 0x1c00
    buffer_load_dword v71, v28, s[40:43], s59 offen
    s_add_u32 s59, s82, 0x20
    buffer_load_dword v72, v28, s[40:43], s59 offen
    s_add_u32 s59, s82, 0x420
    buffer_load_dword v73, v28, s[40:43], s59 offen
    s_add_u32 s59, s82, 0x820
    buffer_load_dword v74, v28, s[40:43], s59 offen
    s_add_u32 s59, s82, 0xc20
    buffer_load_dword v75, v28, s[40:43], s59 offen
    s_add_u32 s59, s82, 0x1020
    buffer_load_dword v76, v28, s[40:43], s59 offen
    s_add_u32 s59, s82, 0x1420
    buffer_load_dword v77, v28, s[40:43], s59 offen
    s_add_u32 s59, s82, 0x1820
    buffer_load_dword v78, v28, s[40:43], s59 offen
    s_add_u32 s59, s82, 0x1c20
    buffer_load_dword v79, v28, s[40:43], s59 offen
    s_add_u32 s59, s82, 0x40
    buffer_load_dword v80, v28, s[40:43], s59 offen
    s_add_u32 s59, s82, 0x440
    buffer_load_dword v81, v28, s[40:43], s59 offen
    s_add_u32 s59, s82, 0x840
    buffer_load_dword v82, v28, s[40:43], s59 offen
    s_add_u32 s59, s82, 0xc40
    buffer_load_dword v83, v28, s[40:43], s59 offen
    s_add_u32 s59, s82, 0x1040
    buffer_load_dword v84, v28, s[40:43], s59 offen
    s_add_u32 s59, s82, 0x1440
    buffer_load_dword v85, v28, s[40:43], s59 offen
    s_add_u32 s59, s82, 0x1840
    buffer_load_dword v86, v28, s[40:43], s59 offen
    s_add_u32 s59, s82, 0x1c40
    buffer_load_dword v87, v28, s[40:43], s59 offen
    s_add_u32 s59, s82, 0x60
    buffer_load_dword v88, v28, s[40:43], s59 offen
    s_add_u32 s59, s82, 0x460
    buffer_load_dword v89, v28, s[40:43], s59 offen
    s_add_u32 s59, s82, 0x860
    buffer_load_dword v90, v28, s[40:43], s59 offen
    s_add_u32 s59, s82, 0xc60
    buffer_load_dword v91, v28, s[40:43], s59 offen
    s_add_u32 s59, s82, 0x1060
    buffer_load_dword v92, v28, s[40:43], s59 offen
    s_add_u32 s59, s82, 0x1460
    buffer_load_dword v93, v28, s[40:43], s59 offen
    s_add_u32 s59, s82, 0x1860
    buffer_load_dword v94, v28, s[40:43], s59 offen
    s_add_u32 s59, s82, 0x1c60
    buffer_load_dword v95, v28, s[40:43], s59 offen
    s_add_u32 s59, s82, 0x8000
    buffer_load_dword v96, v28, s[40:43], s59 offen
    s_add_u32 s59, s82, 0x8400
    buffer_load_dword v97, v28, s[40:43], s59 offen
    s_add_u32 s59, s82, 0x8800
    buffer_load_dword v98, v28, s[40:43], s59 offen
    s_add_u32 s59, s82, 0x8c00
    buffer_load_dword v99, v28, s[40:43], s59 offen
    s_add_u32 s59, s82, 0x9000
    buffer_load_dword v100, v28, s[40:43], s59 offen
    s_add_u32 s59, s82, 0x9400
    buffer_load_dword v101, v28, s[40:43], s59 offen
    s_add_u32 s59, s82, 0x9800
    buffer_load_dword v102, v28, s[40:43], s59 offen
    s_add_u32 s59, s82, 0x9c00
    buffer_load_dword v103, v28, s[40:43], s59 offen
    s_add_u32 s59, s82, 0x8020
    buffer_load_dword v104, v28, s[40:43], s59 offen
    s_add_u32 s59, s82, 0x8420
    buffer_load_dword v105, v28, s[40:43], s59 offen
    s_add_u32 s59, s82, 0x8820
    buffer_load_dword v106, v28, s[40:43], s59 offen
    s_add_u32 s59, s82, 0x8c20
    buffer_load_dword v107, v28, s[40:43], s59 offen
    s_add_u32 s59, s82, 0x9020
    buffer_load_dword v108, v28, s[40:43], s59 offen
    s_add_u32 s59, s82, 0x9420
    buffer_load_dword v109, v28, s[40:43], s59 offen
    s_add_u32 s59, s82, 0x9820
    buffer_load_dword v110, v28, s[40:43], s59 offen
    s_add_u32 s59, s82, 0x9c20
    buffer_load_dword v111, v28, s[40:43], s59 offen
    s_add_u32 s59, s82, 0x8040
    buffer_load_dword v112, v28, s[40:43], s59 offen
    s_add_u32 s59, s82, 0x8440
    buffer_load_dword v113, v28, s[40:43], s59 offen
    s_add_u32 s59, s82, 0x8840
    buffer_load_dword v114, v28, s[40:43], s59 offen
    s_add_u32 s59, s82, 0x8c40
    buffer_load_dword v115, v28, s[40:43], s59 offen
    s_add_u32 s59, s82, 0x9040
    buffer_load_dword v116, v28, s[40:43], s59 offen
    s_add_u32 s59, s82, 0x9440
    buffer_load_dword v117, v28, s[40:43], s59 offen
    s_add_u32 s59, s82, 0x9840
    buffer_load_dword v118, v28, s[40:43], s59 offen
    s_add_u32 s59, s82, 0x9c40
    buffer_load_dword v119, v28, s[40:43], s59 offen
    s_add_u32 s59, s82, 0x8060
    buffer_load_dword v120, v28, s[40:43], s59 offen
    s_add_u32 s59, s82, 0x8460
    buffer_load_dword v121, v28, s[40:43], s59 offen
    s_add_u32 s59, s82, 0x8860
    buffer_load_dword v122, v28, s[40:43], s59 offen
    s_add_u32 s59, s82, 0x8c60
    buffer_load_dword v123, v28, s[40:43], s59 offen
    s_add_u32 s59, s82, 0x9060
    buffer_load_dword v124, v28, s[40:43], s59 offen
    s_add_u32 s59, s82, 0x9460
    buffer_load_dword v125, v28, s[40:43], s59 offen
    s_add_u32 s59, s82, 0x9860
    buffer_load_dword v126, v28, s[40:43], s59 offen
    s_add_u32 s59, s82, 0x9c60
    buffer_load_dword v127, v28, s[40:43], s59 offen
    s_waitcnt vmcnt(56)
    v_perm_b32 v30, v65, v64, v29
    v_accvgpr_write_b32 a0, v30
    v_perm_b32 v30, v67, v66, v29
    v_accvgpr_write_b32 a1, v30
    v_perm_b32 v30, v69, v68, v29
    v_accvgpr_write_b32 a2, v30
    v_perm_b32 v30, v71, v70, v29
    v_accvgpr_write_b32 a3, v30
    s_add_u32 s59, s82, 0x10000
    buffer_load_dword v64, v28, s[40:43], s59 offen
    s_add_u32 s59, s82, 0x10400
    buffer_load_dword v65, v28, s[40:43], s59 offen
    s_add_u32 s59, s82, 0x10800
    buffer_load_dword v66, v28, s[40:43], s59 offen
    s_add_u32 s59, s82, 0x10c00
    buffer_load_dword v67, v28, s[40:43], s59 offen
    s_add_u32 s59, s82, 0x11000
    buffer_load_dword v68, v28, s[40:43], s59 offen
    s_add_u32 s59, s82, 0x11400
    buffer_load_dword v69, v28, s[40:43], s59 offen
    s_add_u32 s59, s82, 0x11800
    buffer_load_dword v70, v28, s[40:43], s59 offen
    s_add_u32 s59, s82, 0x11c00
    buffer_load_dword v71, v28, s[40:43], s59 offen
    s_waitcnt vmcnt(56)
    v_perm_b32 v30, v73, v72, v29
    v_accvgpr_write_b32 a4, v30
    v_perm_b32 v30, v75, v74, v29
    v_accvgpr_write_b32 a5, v30
    v_perm_b32 v30, v77, v76, v29
    v_accvgpr_write_b32 a6, v30
    v_perm_b32 v30, v79, v78, v29
    v_accvgpr_write_b32 a7, v30
    s_add_u32 s59, s82, 0x10020
    buffer_load_dword v72, v28, s[40:43], s59 offen
    s_add_u32 s59, s82, 0x10420
    buffer_load_dword v73, v28, s[40:43], s59 offen
    s_add_u32 s59, s82, 0x10820
    buffer_load_dword v74, v28, s[40:43], s59 offen
    s_add_u32 s59, s82, 0x10c20
    buffer_load_dword v75, v28, s[40:43], s59 offen
    s_add_u32 s59, s82, 0x11020
    buffer_load_dword v76, v28, s[40:43], s59 offen
    s_add_u32 s59, s82, 0x11420
    buffer_load_dword v77, v28, s[40:43], s59 offen
    s_add_u32 s59, s82, 0x11820
    buffer_load_dword v78, v28, s[40:43], s59 offen
    s_add_u32 s59, s82, 0x11c20
    buffer_load_dword v79, v28, s[40:43], s59 offen
    s_waitcnt vmcnt(56)
    v_perm_b32 v30, v81, v80, v29
    v_accvgpr_write_b32 a8, v30
    v_perm_b32 v30, v83, v82, v29
    v_accvgpr_write_b32 a9, v30
    v_perm_b32 v30, v85, v84, v29
    v_accvgpr_write_b32 a10, v30
    v_perm_b32 v30, v87, v86, v29
    v_accvgpr_write_b32 a11, v30
    s_add_u32 s59, s82, 0x10040
    buffer_load_dword v80, v28, s[40:43], s59 offen
    s_add_u32 s59, s82, 0x10440
    buffer_load_dword v81, v28, s[40:43], s59 offen
    s_add_u32 s59, s82, 0x10840
    buffer_load_dword v82, v28, s[40:43], s59 offen
    s_add_u32 s59, s82, 0x10c40
    buffer_load_dword v83, v28, s[40:43], s59 offen
    s_add_u32 s59, s82, 0x11040
    buffer_load_dword v84, v28, s[40:43], s59 offen
    s_add_u32 s59, s82, 0x11440
    buffer_load_dword v85, v28, s[40:43], s59 offen
    s_add_u32 s59, s82, 0x11840
    buffer_load_dword v86, v28, s[40:43], s59 offen
    s_add_u32 s59, s82, 0x11c40
    buffer_load_dword v87, v28, s[40:43], s59 offen
    s_waitcnt vmcnt(56)
    v_perm_b32 v30, v89, v88, v29
    v_accvgpr_write_b32 a12, v30
    v_perm_b32 v30, v91, v90, v29
    v_accvgpr_write_b32 a13, v30
    v_perm_b32 v30, v93, v92, v29
    v_accvgpr_write_b32 a14, v30
    v_perm_b32 v30, v95, v94, v29
    v_accvgpr_write_b32 a15, v30
    s_add_u32 s59, s82, 0x10060
    buffer_load_dword v88, v28, s[40:43], s59 offen
    s_add_u32 s59, s82, 0x10460
    buffer_load_dword v89, v28, s[40:43], s59 offen
    s_add_u32 s59, s82, 0x10860
    buffer_load_dword v90, v28, s[40:43], s59 offen
    s_add_u32 s59, s82, 0x10c60
    buffer_load_dword v91, v28, s[40:43], s59 offen
    s_add_u32 s59, s82, 0x11060
    buffer_load_dword v92, v28, s[40:43], s59 offen
    s_add_u32 s59, s82, 0x11460
    buffer_load_dword v93, v28, s[40:43], s59 offen
    s_add_u32 s59, s82, 0x11860
    buffer_load_dword v94, v28, s[40:43], s59 offen
    s_add_u32 s59, s82, 0x11c60
    buffer_load_dword v95, v28, s[40:43], s59 offen
    s_waitcnt vmcnt(56)
    v_perm_b32 v30, v97, v96, v29
    v_accvgpr_write_b32 a16, v30
    v_perm_b32 v30, v99, v98, v29
    v_accvgpr_write_b32 a17, v30
    v_perm_b32 v30, v101, v100, v29
    v_accvgpr_write_b32 a18, v30
    v_perm_b32 v30, v103, v102, v29
    v_accvgpr_write_b32 a19, v30
    s_add_u32 s59, s82, 0x18000
    buffer_load_dword v96, v28, s[40:43], s59 offen
    s_add_u32 s59, s82, 0x18400
    buffer_load_dword v97, v28, s[40:43], s59 offen
    s_add_u32 s59, s82, 0x18800
    buffer_load_dword v98, v28, s[40:43], s59 offen
    s_add_u32 s59, s82, 0x18c00
    buffer_load_dword v99, v28, s[40:43], s59 offen
    s_add_u32 s59, s82, 0x19000
    buffer_load_dword v100, v28, s[40:43], s59 offen
    s_add_u32 s59, s82, 0x19400
    buffer_load_dword v101, v28, s[40:43], s59 offen
    s_add_u32 s59, s82, 0x19800
    buffer_load_dword v102, v28, s[40:43], s59 offen
    s_add_u32 s59, s82, 0x19c00
    buffer_load_dword v103, v28, s[40:43], s59 offen
    s_waitcnt vmcnt(56)
    v_perm_b32 v30, v105, v104, v29
    v_accvgpr_write_b32 a20, v30
    v_perm_b32 v30, v107, v106, v29
    v_accvgpr_write_b32 a21, v30
    v_perm_b32 v30, v109, v108, v29
    v_accvgpr_write_b32 a22, v30
    v_perm_b32 v30, v111, v110, v29
    v_accvgpr_write_b32 a23, v30
    s_add_u32 s59, s82, 0x18020
    buffer_load_dword v104, v28, s[40:43], s59 offen
    s_add_u32 s59, s82, 0x18420
    buffer_load_dword v105, v28, s[40:43], s59 offen
    s_add_u32 s59, s82, 0x18820
    buffer_load_dword v106, v28, s[40:43], s59 offen
    s_add_u32 s59, s82, 0x18c20
    buffer_load_dword v107, v28, s[40:43], s59 offen
    s_add_u32 s59, s82, 0x19020
    buffer_load_dword v108, v28, s[40:43], s59 offen
    s_add_u32 s59, s82, 0x19420
    buffer_load_dword v109, v28, s[40:43], s59 offen
    s_add_u32 s59, s82, 0x19820
    buffer_load_dword v110, v28, s[40:43], s59 offen
    s_add_u32 s59, s82, 0x19c20
    buffer_load_dword v111, v28, s[40:43], s59 offen
    s_waitcnt vmcnt(56)
    v_perm_b32 v30, v113, v112, v29
    v_accvgpr_write_b32 a24, v30
    v_perm_b32 v30, v115, v114, v29
    v_accvgpr_write_b32 a25, v30
    v_perm_b32 v30, v117, v116, v29
    v_accvgpr_write_b32 a26, v30
    v_perm_b32 v30, v119, v118, v29
    v_accvgpr_write_b32 a27, v30
    s_add_u32 s59, s82, 0x18040
    buffer_load_dword v112, v28, s[40:43], s59 offen
    s_add_u32 s59, s82, 0x18440
    buffer_load_dword v113, v28, s[40:43], s59 offen
    s_add_u32 s59, s82, 0x18840
    buffer_load_dword v114, v28, s[40:43], s59 offen
    s_add_u32 s59, s82, 0x18c40
    buffer_load_dword v115, v28, s[40:43], s59 offen
    s_add_u32 s59, s82, 0x19040
    buffer_load_dword v116, v28, s[40:43], s59 offen
    s_add_u32 s59, s82, 0x19440
    buffer_load_dword v117, v28, s[40:43], s59 offen
    s_add_u32 s59, s82, 0x19840
    buffer_load_dword v118, v28, s[40:43], s59 offen
    s_add_u32 s59, s82, 0x19c40
    buffer_load_dword v119, v28, s[40:43], s59 offen
    s_waitcnt vmcnt(56)
    v_perm_b32 v30, v121, v120, v29
    v_accvgpr_write_b32 a28, v30
    v_perm_b32 v30, v123, v122, v29
    v_accvgpr_write_b32 a29, v30
    v_perm_b32 v30, v125, v124, v29
    v_accvgpr_write_b32 a30, v30
    v_perm_b32 v30, v127, v126, v29
    v_accvgpr_write_b32 a31, v30
    s_add_u32 s59, s82, 0x18060
    buffer_load_dword v120, v28, s[40:43], s59 offen
    s_add_u32 s59, s82, 0x18460
    buffer_load_dword v121, v28, s[40:43], s59 offen
    s_add_u32 s59, s82, 0x18860
    buffer_load_dword v122, v28, s[40:43], s59 offen
    s_add_u32 s59, s82, 0x18c60
    buffer_load_dword v123, v28, s[40:43], s59 offen
    s_add_u32 s59, s82, 0x19060
    buffer_load_dword v124, v28, s[40:43], s59 offen
    s_add_u32 s59, s82, 0x19460
    buffer_load_dword v125, v28, s[40:43], s59 offen
    s_add_u32 s59, s82, 0x19860
    buffer_load_dword v126, v28, s[40:43], s59 offen
    s_add_u32 s59, s82, 0x19c60
    buffer_load_dword v127, v28, s[40:43], s59 offen
    s_waitcnt vmcnt(56)
    v_perm_b32 v30, v65, v64, v29
    v_accvgpr_write_b32 a32, v30
    v_perm_b32 v30, v67, v66, v29
    v_accvgpr_write_b32 a33, v30
    v_perm_b32 v30, v69, v68, v29
    v_accvgpr_write_b32 a34, v30
    v_perm_b32 v30, v71, v70, v29
    v_accvgpr_write_b32 a35, v30
    s_add_u32 s59, s82, 0x20000
    buffer_load_dword v64, v28, s[40:43], s59 offen
    s_add_u32 s59, s82, 0x20400
    buffer_load_dword v65, v28, s[40:43], s59 offen
    s_add_u32 s59, s82, 0x20800
    buffer_load_dword v66, v28, s[40:43], s59 offen
    s_add_u32 s59, s82, 0x20c00
    buffer_load_dword v67, v28, s[40:43], s59 offen
    s_add_u32 s59, s82, 0x21000
    buffer_load_dword v68, v28, s[40:43], s59 offen
    s_add_u32 s59, s82, 0x21400
    buffer_load_dword v69, v28, s[40:43], s59 offen
    s_add_u32 s59, s82, 0x21800
    buffer_load_dword v70, v28, s[40:43], s59 offen
    s_add_u32 s59, s82, 0x21c00
    buffer_load_dword v71, v28, s[40:43], s59 offen
    s_waitcnt vmcnt(56)
    v_perm_b32 v30, v73, v72, v29
    v_accvgpr_write_b32 a36, v30
    v_perm_b32 v30, v75, v74, v29
    v_accvgpr_write_b32 a37, v30
    v_perm_b32 v30, v77, v76, v29
    v_accvgpr_write_b32 a38, v30
    v_perm_b32 v30, v79, v78, v29
    v_accvgpr_write_b32 a39, v30
    s_add_u32 s59, s82, 0x20020
    buffer_load_dword v72, v28, s[40:43], s59 offen
    s_add_u32 s59, s82, 0x20420
    buffer_load_dword v73, v28, s[40:43], s59 offen
    s_add_u32 s59, s82, 0x20820
    buffer_load_dword v74, v28, s[40:43], s59 offen
    s_add_u32 s59, s82, 0x20c20
    buffer_load_dword v75, v28, s[40:43], s59 offen
    s_add_u32 s59, s82, 0x21020
    buffer_load_dword v76, v28, s[40:43], s59 offen
    s_add_u32 s59, s82, 0x21420
    buffer_load_dword v77, v28, s[40:43], s59 offen
    s_add_u32 s59, s82, 0x21820
    buffer_load_dword v78, v28, s[40:43], s59 offen
    s_add_u32 s59, s82, 0x21c20
    buffer_load_dword v79, v28, s[40:43], s59 offen
    s_waitcnt vmcnt(56)
    v_perm_b32 v30, v81, v80, v29
    v_accvgpr_write_b32 a40, v30
    v_perm_b32 v30, v83, v82, v29
    v_accvgpr_write_b32 a41, v30
    v_perm_b32 v30, v85, v84, v29
    v_accvgpr_write_b32 a42, v30
    v_perm_b32 v30, v87, v86, v29
    v_accvgpr_write_b32 a43, v30
    s_add_u32 s59, s82, 0x20040
    buffer_load_dword v80, v28, s[40:43], s59 offen
    s_add_u32 s59, s82, 0x20440
    buffer_load_dword v81, v28, s[40:43], s59 offen
    s_add_u32 s59, s82, 0x20840
    buffer_load_dword v82, v28, s[40:43], s59 offen
    s_add_u32 s59, s82, 0x20c40
    buffer_load_dword v83, v28, s[40:43], s59 offen
    s_add_u32 s59, s82, 0x21040
    buffer_load_dword v84, v28, s[40:43], s59 offen
    s_add_u32 s59, s82, 0x21440
    buffer_load_dword v85, v28, s[40:43], s59 offen
    s_add_u32 s59, s82, 0x21840
    buffer_load_dword v86, v28, s[40:43], s59 offen
    s_add_u32 s59, s82, 0x21c40
    buffer_load_dword v87, v28, s[40:43], s59 offen
    s_waitcnt vmcnt(56)
    v_perm_b32 v30, v89, v88, v29
    v_accvgpr_write_b32 a44, v30
    v_perm_b32 v30, v91, v90, v29
    v_accvgpr_write_b32 a45, v30
    v_perm_b32 v30, v93, v92, v29
    v_accvgpr_write_b32 a46, v30
    v_perm_b32 v30, v95, v94, v29
    v_accvgpr_write_b32 a47, v30
    s_add_u32 s59, s82, 0x20060
    buffer_load_dword v88, v28, s[40:43], s59 offen
    s_add_u32 s59, s82, 0x20460
    buffer_load_dword v89, v28, s[40:43], s59 offen
    s_add_u32 s59, s82, 0x20860
    buffer_load_dword v90, v28, s[40:43], s59 offen
    s_add_u32 s59, s82, 0x20c60
    buffer_load_dword v91, v28, s[40:43], s59 offen
    s_add_u32 s59, s82, 0x21060
    buffer_load_dword v92, v28, s[40:43], s59 offen
    s_add_u32 s59, s82, 0x21460
    buffer_load_dword v93, v28, s[40:43], s59 offen
    s_add_u32 s59, s82, 0x21860
    buffer_load_dword v94, v28, s[40:43], s59 offen
    s_add_u32 s59, s82, 0x21c60
    buffer_load_dword v95, v28, s[40:43], s59 offen
    s_waitcnt vmcnt(56)
    v_perm_b32 v30, v97, v96, v29
    v_accvgpr_write_b32 a48, v30
    v_perm_b32 v30, v99, v98, v29
    v_accvgpr_write_b32 a49, v30
    v_perm_b32 v30, v101, v100, v29
    v_accvgpr_write_b32 a50, v30
    v_perm_b32 v30, v103, v102, v29
    v_accvgpr_write_b32 a51, v30
    s_add_u32 s59, s82, 0x28000
    buffer_load_dword v96, v28, s[40:43], s59 offen
    s_add_u32 s59, s82, 0x28400
    buffer_load_dword v97, v28, s[40:43], s59 offen
    s_add_u32 s59, s82, 0x28800
    buffer_load_dword v98, v28, s[40:43], s59 offen
    s_add_u32 s59, s82, 0x28c00
    buffer_load_dword v99, v28, s[40:43], s59 offen
    s_add_u32 s59, s82, 0x29000
    buffer_load_dword v100, v28, s[40:43], s59 offen
    s_add_u32 s59, s82, 0x29400
    buffer_load_dword v101, v28, s[40:43], s59 offen
    s_add_u32 s59, s82, 0x29800
    buffer_load_dword v102, v28, s[40:43], s59 offen
    s_add_u32 s59, s82, 0x29c00
    buffer_load_dword v103, v28, s[40:43], s59 offen
    s_waitcnt vmcnt(56)
    v_perm_b32 v30, v105, v104, v29
    v_accvgpr_write_b32 a52, v30
    v_perm_b32 v30, v107, v106, v29
    v_accvgpr_write_b32 a53, v30
    v_perm_b32 v30, v109, v108, v29
    v_accvgpr_write_b32 a54, v30
    v_perm_b32 v30, v111, v110, v29
    v_accvgpr_write_b32 a55, v30
    s_add_u32 s59, s82, 0x28020
    buffer_load_dword v104, v28, s[40:43], s59 offen
    s_add_u32 s59, s82, 0x28420
    buffer_load_dword v105, v28, s[40:43], s59 offen
    s_add_u32 s59, s82, 0x28820
    buffer_load_dword v106, v28, s[40:43], s59 offen
    s_add_u32 s59, s82, 0x28c20
    buffer_load_dword v107, v28, s[40:43], s59 offen
    s_add_u32 s59, s82, 0x29020
    buffer_load_dword v108, v28, s[40:43], s59 offen
    s_add_u32 s59, s82, 0x29420
    buffer_load_dword v109, v28, s[40:43], s59 offen
    s_add_u32 s59, s82, 0x29820
    buffer_load_dword v110, v28, s[40:43], s59 offen
    s_add_u32 s59, s82, 0x29c20
    buffer_load_dword v111, v28, s[40:43], s59 offen
    s_waitcnt vmcnt(56)
    v_perm_b32 v30, v113, v112, v29
    v_accvgpr_write_b32 a56, v30
    v_perm_b32 v30, v115, v114, v29
    v_accvgpr_write_b32 a57, v30
    v_perm_b32 v30, v117, v116, v29
    v_accvgpr_write_b32 a58, v30
    v_perm_b32 v30, v119, v118, v29
    v_accvgpr_write_b32 a59, v30
    s_add_u32 s59, s82, 0x28040
    buffer_load_dword v112, v28, s[40:43], s59 offen
    s_add_u32 s59, s82, 0x28440
    buffer_load_dword v113, v28, s[40:43], s59 offen
    s_add_u32 s59, s82, 0x28840
    buffer_load_dword v114, v28, s[40:43], s59 offen
    s_add_u32 s59, s82, 0x28c40
    buffer_load_dword v115, v28, s[40:43], s59 offen
    s_add_u32 s59, s82, 0x29040
    buffer_load_dword v116, v28, s[40:43], s59 offen
    s_add_u32 s59, s82, 0x29440
    buffer_load_dword v117, v28, s[40:43], s59 offen
    s_add_u32 s59, s82, 0x29840
    buffer_load_dword v118, v28, s[40:43], s59 offen
    s_add_u32 s59, s82, 0x29c40
    buffer_load_dword v119, v28, s[40:43], s59 offen
    s_waitcnt vmcnt(56)
    v_perm_b32 v30, v121, v120, v29
    v_accvgpr_write_b32 a60, v30
    v_perm_b32 v30, v123, v122, v29
    v_accvgpr_write_b32 a61, v30
    v_perm_b32 v30, v125, v124, v29
    v_accvgpr_write_b32 a62, v30
    v_perm_b32 v30, v127, v126, v29
    v_accvgpr_write_b32 a63, v30
    s_add_u32 s59, s82, 0x28060
    buffer_load_dword v120, v28, s[40:43], s59 offen
    s_add_u32 s59, s82, 0x28460
    buffer_load_dword v121, v28, s[40:43], s59 offen
    s_add_u32 s59, s82, 0x28860
    buffer_load_dword v122, v28, s[40:43], s59 offen
    s_add_u32 s59, s82, 0x28c60
    buffer_load_dword v123, v28, s[40:43], s59 offen
    s_add_u32 s59, s82, 0x29060
    buffer_load_dword v124, v28, s[40:43], s59 offen
    s_add_u32 s59, s82, 0x29460
    buffer_load_dword v125, v28, s[40:43], s59 offen
    s_add_u32 s59, s82, 0x29860
    buffer_load_dword v126, v28, s[40:43], s59 offen
    s_add_u32 s59, s82, 0x29c60
    buffer_load_dword v127, v28, s[40:43], s59 offen
    s_waitcnt vmcnt(56)
    v_perm_b32 v30, v65, v64, v29
    v_accvgpr_write_b32 a64, v30
    v_perm_b32 v30, v67, v66, v29
    v_accvgpr_write_b32 a65, v30
    v_perm_b32 v30, v69, v68, v29
    v_accvgpr_write_b32 a66, v30
    v_perm_b32 v30, v71, v70, v29
    v_accvgpr_write_b32 a67, v30
    s_add_u32 s59, s82, 0x30000
    buffer_load_dword v64, v28, s[40:43], s59 offen
    s_add_u32 s59, s82, 0x30400
    buffer_load_dword v65, v28, s[40:43], s59 offen
    s_add_u32 s59, s82, 0x30800
    buffer_load_dword v66, v28, s[40:43], s59 offen
    s_add_u32 s59, s82, 0x30c00
    buffer_load_dword v67, v28, s[40:43], s59 offen
    s_add_u32 s59, s82, 0x31000
    buffer_load_dword v68, v28, s[40:43], s59 offen
    s_add_u32 s59, s82, 0x31400
    buffer_load_dword v69, v28, s[40:43], s59 offen
    s_add_u32 s59, s82, 0x31800
    buffer_load_dword v70, v28, s[40:43], s59 offen
    s_add_u32 s59, s82, 0x31c00
    buffer_load_dword v71, v28, s[40:43], s59 offen
    s_waitcnt vmcnt(56)
    v_perm_b32 v30, v73, v72, v29
    v_accvgpr_write_b32 a68, v30
    v_perm_b32 v30, v75, v74, v29
    v_accvgpr_write_b32 a69, v30
    v_perm_b32 v30, v77, v76, v29
    v_accvgpr_write_b32 a70, v30
    v_perm_b32 v30, v79, v78, v29
    v_accvgpr_write_b32 a71, v30
    s_add_u32 s59, s82, 0x30020
    buffer_load_dword v72, v28, s[40:43], s59 offen
    s_add_u32 s59, s82, 0x30420
    buffer_load_dword v73, v28, s[40:43], s59 offen
    s_add_u32 s59, s82, 0x30820
    buffer_load_dword v74, v28, s[40:43], s59 offen
    s_add_u32 s59, s82, 0x30c20
    buffer_load_dword v75, v28, s[40:43], s59 offen
    s_add_u32 s59, s82, 0x31020
    buffer_load_dword v76, v28, s[40:43], s59 offen
    s_add_u32 s59, s82, 0x31420
    buffer_load_dword v77, v28, s[40:43], s59 offen
    s_add_u32 s59, s82, 0x31820
    buffer_load_dword v78, v28, s[40:43], s59 offen
    s_add_u32 s59, s82, 0x31c20
    buffer_load_dword v79, v28, s[40:43], s59 offen
    s_waitcnt vmcnt(56)
    v_perm_b32 v30, v81, v80, v29
    v_accvgpr_write_b32 a72, v30
    v_perm_b32 v30, v83, v82, v29
    v_accvgpr_write_b32 a73, v30
    v_perm_b32 v30, v85, v84, v29
    v_accvgpr_write_b32 a74, v30
    v_perm_b32 v30, v87, v86, v29
    v_accvgpr_write_b32 a75, v30
    s_add_u32 s59, s82, 0x30040
    buffer_load_dword v80, v28, s[40:43], s59 offen
    s_add_u32 s59, s82, 0x30440
    buffer_load_dword v81, v28, s[40:43], s59 offen
    s_add_u32 s59, s82, 0x30840
    buffer_load_dword v82, v28, s[40:43], s59 offen
    s_add_u32 s59, s82, 0x30c40
    buffer_load_dword v83, v28, s[40:43], s59 offen
    s_add_u32 s59, s82, 0x31040
    buffer_load_dword v84, v28, s[40:43], s59 offen
    s_add_u32 s59, s82, 0x31440
    buffer_load_dword v85, v28, s[40:43], s59 offen
    s_add_u32 s59, s82, 0x31840
    buffer_load_dword v86, v28, s[40:43], s59 offen
    s_add_u32 s59, s82, 0x31c40
    buffer_load_dword v87, v28, s[40:43], s59 offen
    s_waitcnt vmcnt(56)
    v_perm_b32 v30, v89, v88, v29
    v_accvgpr_write_b32 a76, v30
    v_perm_b32 v30, v91, v90, v29
    v_accvgpr_write_b32 a77, v30
    v_perm_b32 v30, v93, v92, v29
    v_accvgpr_write_b32 a78, v30
    v_perm_b32 v30, v95, v94, v29
    v_accvgpr_write_b32 a79, v30
    s_add_u32 s59, s82, 0x30060
    buffer_load_dword v88, v28, s[40:43], s59 offen
    s_add_u32 s59, s82, 0x30460
    buffer_load_dword v89, v28, s[40:43], s59 offen
    s_add_u32 s59, s82, 0x30860
    buffer_load_dword v90, v28, s[40:43], s59 offen
    s_add_u32 s59, s82, 0x30c60
    buffer_load_dword v91, v28, s[40:43], s59 offen
    s_add_u32 s59, s82, 0x31060
    buffer_load_dword v92, v28, s[40:43], s59 offen
    s_add_u32 s59, s82, 0x31460
    buffer_load_dword v93, v28, s[40:43], s59 offen
    s_add_u32 s59, s82, 0x31860
    buffer_load_dword v94, v28, s[40:43], s59 offen
    s_add_u32 s59, s82, 0x31c60
    buffer_load_dword v95, v28, s[40:43], s59 offen
    s_waitcnt vmcnt(56)
    v_perm_b32 v30, v97, v96, v29
    v_accvgpr_write_b32 a80, v30
    v_perm_b32 v30, v99, v98, v29
    v_accvgpr_write_b32 a81, v30
    v_perm_b32 v30, v101, v100, v29
    v_accvgpr_write_b32 a82, v30
    v_perm_b32 v30, v103, v102, v29
    v_accvgpr_write_b32 a83, v30
    s_add_u32 s59, s82, 0x38000
    buffer_load_dword v96, v28, s[40:43], s59 offen
    s_add_u32 s59, s82, 0x38400
    buffer_load_dword v97, v28, s[40:43], s59 offen
    s_add_u32 s59, s82, 0x38800
    buffer_load_dword v98, v28, s[40:43], s59 offen
    s_add_u32 s59, s82, 0x38c00
    buffer_load_dword v99, v28, s[40:43], s59 offen
    s_add_u32 s59, s82, 0x39000
    buffer_load_dword v100, v28, s[40:43], s59 offen
    s_add_u32 s59, s82, 0x39400
    buffer_load_dword v101, v28, s[40:43], s59 offen
    s_add_u32 s59, s82, 0x39800
    buffer_load_dword v102, v28, s[40:43], s59 offen
    s_add_u32 s59, s82, 0x39c00
    buffer_load_dword v103, v28, s[40:43], s59 offen
    s_waitcnt vmcnt(56)
    v_perm_b32 v30, v105, v104, v29
    v_accvgpr_write_b32 a84, v30
    v_perm_b32 v30, v107, v106, v29
    v_accvgpr_write_b32 a85, v30
    v_perm_b32 v30, v109, v108, v29
    v_accvgpr_write_b32 a86, v30
    v_perm_b32 v30, v111, v110, v29
    v_accvgpr_write_b32 a87, v30
    s_add_u32 s59, s82, 0x38020
    buffer_load_dword v104, v28, s[40:43], s59 offen
    s_add_u32 s59, s82, 0x38420
    buffer_load_dword v105, v28, s[40:43], s59 offen
    s_add_u32 s59, s82, 0x38820
    buffer_load_dword v106, v28, s[40:43], s59 offen
    s_add_u32 s59, s82, 0x38c20
    buffer_load_dword v107, v28, s[40:43], s59 offen
    s_add_u32 s59, s82, 0x39020
    buffer_load_dword v108, v28, s[40:43], s59 offen
    s_add_u32 s59, s82, 0x39420
    buffer_load_dword v109, v28, s[40:43], s59 offen
    s_add_u32 s59, s82, 0x39820
    buffer_load_dword v110, v28, s[40:43], s59 offen
    s_add_u32 s59, s82, 0x39c20
    buffer_load_dword v111, v28, s[40:43], s59 offen
    s_waitcnt vmcnt(56)
    v_perm_b32 v30, v113, v112, v29
    v_accvgpr_write_b32 a88, v30
    v_perm_b32 v30, v115, v114, v29
    v_accvgpr_write_b32 a89, v30
    v_perm_b32 v30, v117, v116, v29
    v_accvgpr_write_b32 a90, v30
    v_perm_b32 v30, v119, v118, v29
    v_accvgpr_write_b32 a91, v30
    s_add_u32 s59, s82, 0x38040
    buffer_load_dword v112, v28, s[40:43], s59 offen
    s_add_u32 s59, s82, 0x38440
    buffer_load_dword v113, v28, s[40:43], s59 offen
    s_add_u32 s59, s82, 0x38840
    buffer_load_dword v114, v28, s[40:43], s59 offen
    s_add_u32 s59, s82, 0x38c40
    buffer_load_dword v115, v28, s[40:43], s59 offen
    s_add_u32 s59, s82, 0x39040
    buffer_load_dword v116, v28, s[40:43], s59 offen
    s_add_u32 s59, s82, 0x39440
    buffer_load_dword v117, v28, s[40:43], s59 offen
    s_add_u32 s59, s82, 0x39840
    buffer_load_dword v118, v28, s[40:43], s59 offen
    s_add_u32 s59, s82, 0x39c40
    buffer_load_dword v119, v28, s[40:43], s59 offen
    s_waitcnt vmcnt(56)
    v_perm_b32 v30, v121, v120, v29
    v_accvgpr_write_b32 a92, v30
    v_perm_b32 v30, v123, v122, v29
    v_accvgpr_write_b32 a93, v30
    v_perm_b32 v30, v125, v124, v29
    v_accvgpr_write_b32 a94, v30
    v_perm_b32 v30, v127, v126, v29
    v_accvgpr_write_b32 a95, v30
    s_add_u32 s59, s82, 0x38060
    buffer_load_dword v120, v28, s[40:43], s59 offen
    s_add_u32 s59, s82, 0x38460
    buffer_load_dword v121, v28, s[40:43], s59 offen
    s_add_u32 s59, s82, 0x38860
    buffer_load_dword v122, v28, s[40:43], s59 offen
    s_add_u32 s59, s82, 0x38c60
    buffer_load_dword v123, v28, s[40:43], s59 offen
    s_add_u32 s59, s82, 0x39060
    buffer_load_dword v124, v28, s[40:43], s59 offen
    s_add_u32 s59, s82, 0x39460
    buffer_load_dword v125, v28, s[40:43], s59 offen
    s_add_u32 s59, s82, 0x39860
    buffer_load_dword v126, v28, s[40:43], s59 offen
    s_add_u32 s59, s82, 0x39c60
    buffer_load_dword v127, v28, s[40:43], s59 offen
    s_waitcnt vmcnt(56)
    v_perm_b32 v30, v65, v64, v29
    v_accvgpr_write_b32 a96, v30
    v_perm_b32 v30, v67, v66, v29
    v_accvgpr_write_b32 a97, v30
    v_perm_b32 v30, v69, v68, v29
    v_accvgpr_write_b32 a98, v30
    v_perm_b32 v30, v71, v70, v29
    v_accvgpr_write_b32 a99, v30
    s_waitcnt vmcnt(48)
    v_perm_b32 v30, v73, v72, v29
    v_accvgpr_write_b32 a100, v30
    v_perm_b32 v30, v75, v74, v29
    v_accvgpr_write_b32 a101, v30
    v_perm_b32 v30, v77, v76, v29
    v_accvgpr_write_b32 a102, v30
    v_perm_b32 v30, v79, v78, v29
    v_accvgpr_write_b32 a103, v30
    s_waitcnt vmcnt(40)
    v_perm_b32 v30, v81, v80, v29
    v_accvgpr_write_b32 a104, v30
    v_perm_b32 v30, v83, v82, v29
    v_accvgpr_write_b32 a105, v30
    v_perm_b32 v30, v85, v84, v29
    v_accvgpr_write_b32 a106, v30
    v_perm_b32 v30, v87, v86, v29
    v_accvgpr_write_b32 a107, v30
    s_waitcnt vmcnt(32)
    v_perm_b32 v30, v89, v88, v29
    v_accvgpr_write_b32 a108, v30
    v_perm_b32 v30, v91, v90, v29
    v_accvgpr_write_b32 a109, v30
    v_perm_b32 v30, v93, v92, v29
    v_accvgpr_write_b32 a110, v30
    v_perm_b32 v30, v95, v94, v29
    v_accvgpr_write_b32 a111, v30
    s_waitcnt vmcnt(24)
    v_perm_b32 v30, v97, v96, v29
    v_accvgpr_write_b32 a112, v30
    v_perm_b32 v30, v99, v98, v29
    v_accvgpr_write_b32 a113, v30
    v_perm_b32 v30, v101, v100, v29
    v_accvgpr_write_b32 a114, v30
    v_perm_b32 v30, v103, v102, v29
    v_accvgpr_write_b32 a115, v30
    s_waitcnt vmcnt(16)
    v_perm_b32 v30, v105, v104, v29
    v_accvgpr_write_b32 a116, v30
    v_perm_b32 v30, v107, v106, v29
    v_accvgpr_write_b32 a117, v30
    v_perm_b32 v30, v109, v108, v29
    v_accvgpr_write_b32 a118, v30
    v_perm_b32 v30, v111, v110, v29
    v_accvgpr_write_b32 a119, v30
    s_waitcnt vmcnt(8)
    v_perm_b32 v30, v113, v112, v29
    v_accvgpr_write_b32 a120, v30
    v_perm_b32 v30, v115, v114, v29
    v_accvgpr_write_b32 a121, v30
    v_perm_b32 v30, v117, v116, v29
    v_accvgpr_write_b32 a122, v30
    v_perm_b32 v30, v119, v118, v29
    v_accvgpr_write_b32 a123, v30
    s_waitcnt vmcnt(0)
    v_perm_b32 v30, v121, v120, v29
    v_accvgpr_write_b32 a124, v30
    v_perm_b32 v30, v123, v122, v29
    v_accvgpr_write_b32 a125, v30
    v_perm_b32 v30, v125, v124, v29
    v_accvgpr_write_b32 a126, v30
    v_perm_b32 v30, v127, v126, v29
    v_accvgpr_write_b32 a127, v30
    v_lshrrev_b32 v30, 4, v0
    s_mov_b32 s59, 28672
    v_mul_lo_u32 v28, v30, s59
    v_and_b32 v30, 14, v0
    v_lshl_add_u32 v28, v30, 1, v28
    v_and_b32 v30, 1, v0
    v_cmp_eq_u32 vcc, 1, v30
    v_mov_b32 v29, s66
    v_mov_b32 v30, s67
    v_cndmask_b32 v29, v29, v30, vcc
    s_min_u32 s78, s56, 27
    s_lshl_b32 s82, s78, 7
    s_lshl_b32 s59, s57, 5
    s_add_u32 s82, s82, s59
    s_add_u32 s59, s82, 0x0
    buffer_load_dword v64, v28, s[44:47], s59 offen
    s_add_u32 s59, s82, 0xe00
    buffer_load_dword v65, v28, s[44:47], s59 offen
    s_add_u32 s59, s82, 0x1c00
    buffer_load_dword v66, v28, s[44:47], s59 offen
    s_add_u32 s59, s82, 0x2a00
    buffer_load_dword v67, v28, s[44:47], s59 offen
    s_add_u32 s59, s82, 0x3800
    buffer_load_dword v68, v28, s[44:47], s59 offen
    s_add_u32 s59, s82, 0x4600
    buffer_load_dword v69, v28, s[44:47], s59 offen
    s_add_u32 s59, s82, 0x5400
    buffer_load_dword v70, v28, s[44:47], s59 offen
    s_add_u32 s59, s82, 0x6200
    buffer_load_dword v71, v28, s[44:47], s59 offen
    s_add_u32 s59, s82, 0x1c000
    buffer_load_dword v72, v28, s[44:47], s59 offen
    s_add_u32 s59, s82, 0x1ce00
    buffer_load_dword v73, v28, s[44:47], s59 offen
    s_add_u32 s59, s82, 0x1dc00
    buffer_load_dword v74, v28, s[44:47], s59 offen
    s_add_u32 s59, s82, 0x1ea00
    buffer_load_dword v75, v28, s[44:47], s59 offen
    s_add_u32 s59, s82, 0x1f800
    buffer_load_dword v76, v28, s[44:47], s59 offen
    s_add_u32 s59, s82, 0x20600
    buffer_load_dword v77, v28, s[44:47], s59 offen
    s_add_u32 s59, s82, 0x21400
    buffer_load_dword v78, v28, s[44:47], s59 offen
    s_add_u32 s59, s82, 0x22200
    buffer_load_dword v79, v28, s[44:47], s59 offen
    s_add_u32 s59, s82, 0x38000
    buffer_load_dword v80, v28, s[44:47], s59 offen
    s_add_u32 s59, s82, 0x38e00
    buffer_load_dword v81, v28, s[44:47], s59 offen
    s_add_u32 s59, s82, 0x39c00
    buffer_load_dword v82, v28, s[44:47], s59 offen
    s_add_u32 s59, s82, 0x3aa00
    buffer_load_dword v83, v28, s[44:47], s59 offen
    s_add_u32 s59, s82, 0x3b800
    buffer_load_dword v84, v28, s[44:47], s59 offen
    s_add_u32 s59, s82, 0x3c600
    buffer_load_dword v85, v28, s[44:47], s59 offen
    s_add_u32 s59, s82, 0x3d400
    buffer_load_dword v86, v28, s[44:47], s59 offen
    s_add_u32 s59, s82, 0x3e200
    buffer_load_dword v87, v28, s[44:47], s59 offen
    s_add_u32 s59, s82, 0x54000
    buffer_load_dword v88, v28, s[44:47], s59 offen
    s_add_u32 s59, s82, 0x54e00
    buffer_load_dword v89, v28, s[44:47], s59 offen
    s_add_u32 s59, s82, 0x55c00
    buffer_load_dword v90, v28, s[44:47], s59 offen
    s_add_u32 s59, s82, 0x56a00
    buffer_load_dword v91, v28, s[44:47], s59 offen
    s_add_u32 s59, s82, 0x57800
    buffer_load_dword v92, v28, s[44:47], s59 offen
    s_add_u32 s59, s82, 0x58600
    buffer_load_dword v93, v28, s[44:47], s59 offen
    s_add_u32 s59, s82, 0x59400
    buffer_load_dword v94, v28, s[44:47], s59 offen
    s_add_u32 s59, s82, 0x5a200
    buffer_load_dword v95, v28, s[44:47], s59 offen
    s_add_u32 s59, s82, 0x70000
    buffer_load_dword v96, v28, s[44:47], s59 offen
    s_add_u32 s59, s82, 0x70e00
    buffer_load_dword v97, v28, s[44:47], s59 offen
    s_add_u32 s59, s82, 0x71c00
    buffer_load_dword v98, v28, s[44:47], s59 offen
    s_add_u32 s59, s82, 0x72a00
    buffer_load_dword v99, v28, s[44:47], s59 offen
    s_add_u32 s59, s82, 0x73800
    buffer_load_dword v100, v28, s[44:47], s59 offen
    s_add_u32 s59, s82, 0x74600
    buffer_load_dword v101, v28, s[44:47], s59 offen
    s_add_u32 s59, s82, 0x75400
    buffer_load_dword v102, v28, s[44:47], s59 offen
    s_add_u32 s59, s82, 0x76200
    buffer_load_dword v103, v28, s[44:47], s59 offen
    s_add_u32 s59, s82, 0x8c000
    buffer_load_dword v104, v28, s[44:47], s59 offen
    s_add_u32 s59, s82, 0x8ce00
    buffer_load_dword v105, v28, s[44:47], s59 offen
    s_add_u32 s59, s82, 0x8dc00
    buffer_load_dword v106, v28, s[44:47], s59 offen
    s_add_u32 s59, s82, 0x8ea00
    buffer_load_dword v107, v28, s[44:47], s59 offen
    s_add_u32 s59, s82, 0x8f800
    buffer_load_dword v108, v28, s[44:47], s59 offen
    s_add_u32 s59, s82, 0x90600
    buffer_load_dword v109, v28, s[44:47], s59 offen
    s_add_u32 s59, s82, 0x91400
    buffer_load_dword v110, v28, s[44:47], s59 offen
    s_add_u32 s59, s82, 0x92200
    buffer_load_dword v111, v28, s[44:47], s59 offen
    s_add_u32 s59, s82, 0xa8000
    buffer_load_dword v112, v28, s[44:47], s59 offen
    s_add_u32 s59, s82, 0xa8e00
    buffer_load_dword v113, v28, s[44:47], s59 offen
    s_add_u32 s59, s82, 0xa9c00
    buffer_load_dword v114, v28, s[44:47], s59 offen
    s_add_u32 s59, s82, 0xaaa00
    buffer_load_dword v115, v28, s[44:47], s59 offen
    s_add_u32 s59, s82, 0xab800
    buffer_load_dword v116, v28, s[44:47], s59 offen
    s_add_u32 s59, s82, 0xac600
    buffer_load_dword v117, v28, s[44:47], s59 offen
    s_add_u32 s59, s82, 0xad400
    buffer_load_dword v118, v28, s[44:47], s59 offen
    s_add_u32 s59, s82, 0xae200
    buffer_load_dword v119, v28, s[44:47], s59 offen
    s_add_u32 s59, s82, 0xc4000
    buffer_load_dword v120, v28, s[44:47], s59 offen
    s_add_u32 s59, s82, 0xc4e00
    buffer_load_dword v121, v28, s[44:47], s59 offen
    s_add_u32 s59, s82, 0xc5c00
    buffer_load_dword v122, v28, s[44:47], s59 offen
    s_add_u32 s59, s82, 0xc6a00
    buffer_load_dword v123, v28, s[44:47], s59 offen
    s_add_u32 s59, s82, 0xc7800
    buffer_load_dword v124, v28, s[44:47], s59 offen
    s_add_u32 s59, s82, 0xc8600
    buffer_load_dword v125, v28, s[44:47], s59 offen
    s_add_u32 s59, s82, 0xc9400
    buffer_load_dword v126, v28, s[44:47], s59 offen
    s_add_u32 s59, s82, 0xca200
    buffer_load_dword v127, v28, s[44:47], s59 offen
    s_waitcnt vmcnt(56)
    v_perm_b32 v30, v65, v64, v29
    v_accvgpr_write_b32 a128, v30
    v_perm_b32 v30, v67, v66, v29
    v_accvgpr_write_b32 a129, v30
    v_perm_b32 v30, v69, v68, v29
    v_accvgpr_write_b32 a130, v30
    v_perm_b32 v30, v71, v70, v29
    v_accvgpr_write_b32 a131, v30
    s_add_u32 s59, s82, 0xe0000
    buffer_load_dword v64, v28, s[44:47], s59 offen
    s_add_u32 s59, s82, 0xe0e00
    buffer_load_dword v65, v28, s[44:47], s59 offen
    s_add_u32 s59, s82, 0xe1c00
    buffer_load_dword v66, v28, s[44:47], s59 offen
    s_add_u32 s59, s82, 0xe2a00
    buffer_load_dword v67, v28, s[44:47], s59 offen
    s_add_u32 s59, s82, 0xe3800
    buffer_load_dword v68, v28, s[44:47], s59 offen
    s_add_u32 s59, s82, 0xe4600
    buffer_load_dword v69, v28, s[44:47], s59 offen
    s_add_u32 s59, s82, 0xe5400
    buffer_load_dword v70, v28, s[44:47], s59 offen
    s_add_u32 s59, s82, 0xe6200
    buffer_load_dword v71, v28, s[44:47], s59 offen
    s_waitcnt vmcnt(56)
    v_perm_b32 v30, v73, v72, v29
    v_accvgpr_write_b32 a136, v30
    v_perm_b32 v30, v75, v74, v29
    v_accvgpr_write_b32 a137, v30
    v_perm_b32 v30, v77, v76, v29
    v_accvgpr_write_b32 a138, v30
    v_perm_b32 v30, v79, v78, v29
    v_accvgpr_write_b32 a139, v30
    s_add_u32 s59, s82, 0xfc000
    buffer_load_dword v72, v28, s[44:47], s59 offen
    s_add_u32 s59, s82, 0xfce00
    buffer_load_dword v73, v28, s[44:47], s59 offen
    s_add_u32 s59, s82, 0xfdc00
    buffer_load_dword v74, v28, s[44:47], s59 offen
    s_add_u32 s59, s82, 0xfea00
    buffer_load_dword v75, v28, s[44:47], s59 offen
    s_add_u32 s59, s82, 0xff800
    buffer_load_dword v76, v28, s[44:47], s59 offen
    s_add_u32 s59, s82, 0x100600
    buffer_load_dword v77, v28, s[44:47], s59 offen
    s_add_u32 s59, s82, 0x101400
    buffer_load_dword v78, v28, s[44:47], s59 offen
    s_add_u32 s59, s82, 0x102200
    buffer_load_dword v79, v28, s[44:47], s59 offen
    s_waitcnt vmcnt(56)
    v_perm_b32 v30, v81, v80, v29
    v_accvgpr_write_b32 a144, v30
    v_perm_b32 v30, v83, v82, v29
    v_accvgpr_write_b32 a145, v30
    v_perm_b32 v30, v85, v84, v29
    v_accvgpr_write_b32 a146, v30
    v_perm_b32 v30, v87, v86, v29
    v_accvgpr_write_b32 a147, v30
    s_add_u32 s59, s82, 0x118000
    buffer_load_dword v80, v28, s[44:47], s59 offen
    s_add_u32 s59, s82, 0x118e00
    buffer_load_dword v81, v28, s[44:47], s59 offen
    s_add_u32 s59, s82, 0x119c00
    buffer_load_dword v82, v28, s[44:47], s59 offen
    s_add_u32 s59, s82, 0x11aa00
    buffer_load_dword v83, v28, s[44:47], s59 offen
    s_add_u32 s59, s82, 0x11b800
    buffer_load_dword v84, v28, s[44:47], s59 offen
    s_add_u32 s59, s82, 0x11c600
    buffer_load_dword v85, v28, s[44:47], s59 offen
    s_add_u32 s59, s82, 0x11d400
    buffer_load_dword v86, v28, s[44:47], s59 offen
    s_add_u32 s59, s82, 0x11e200
    buffer_load_dword v87, v28, s[44:47], s59 offen
    s_waitcnt vmcnt(56)
    v_perm_b32 v30, v89, v88, v29
    v_accvgpr_write_b32 a152, v30
    v_perm_b32 v30, v91, v90, v29
    v_accvgpr_write_b32 a153, v30
    v_perm_b32 v30, v93, v92, v29
    v_accvgpr_write_b32 a154, v30
    v_perm_b32 v30, v95, v94, v29
    v_accvgpr_write_b32 a155, v30
    s_add_u32 s59, s82, 0x134000
    buffer_load_dword v88, v28, s[44:47], s59 offen
    s_add_u32 s59, s82, 0x134e00
    buffer_load_dword v89, v28, s[44:47], s59 offen
    s_add_u32 s59, s82, 0x135c00
    buffer_load_dword v90, v28, s[44:47], s59 offen
    s_add_u32 s59, s82, 0x136a00
    buffer_load_dword v91, v28, s[44:47], s59 offen
    s_add_u32 s59, s82, 0x137800
    buffer_load_dword v92, v28, s[44:47], s59 offen
    s_add_u32 s59, s82, 0x138600
    buffer_load_dword v93, v28, s[44:47], s59 offen
    s_add_u32 s59, s82, 0x139400
    buffer_load_dword v94, v28, s[44:47], s59 offen
    s_add_u32 s59, s82, 0x13a200
    buffer_load_dword v95, v28, s[44:47], s59 offen
    s_waitcnt vmcnt(56)
    v_perm_b32 v30, v97, v96, v29
    v_accvgpr_write_b32 a160, v30
    v_perm_b32 v30, v99, v98, v29
    v_accvgpr_write_b32 a161, v30
    v_perm_b32 v30, v101, v100, v29
    v_accvgpr_write_b32 a162, v30
    v_perm_b32 v30, v103, v102, v29
    v_accvgpr_write_b32 a163, v30
    s_add_u32 s59, s82, 0x150000
    buffer_load_dword v96, v28, s[44:47], s59 offen
    s_add_u32 s59, s82, 0x150e00
    buffer_load_dword v97, v28, s[44:47], s59 offen
    s_add_u32 s59, s82, 0x151c00
    buffer_load_dword v98, v28, s[44:47], s59 offen
    s_add_u32 s59, s82, 0x152a00
    buffer_load_dword v99, v28, s[44:47], s59 offen
    s_add_u32 s59, s82, 0x153800
    buffer_load_dword v100, v28, s[44:47], s59 offen
    s_add_u32 s59, s82, 0x154600
    buffer_load_dword v101, v28, s[44:47], s59 offen
    s_add_u32 s59, s82, 0x155400
    buffer_load_dword v102, v28, s[44:47], s59 offen
    s_add_u32 s59, s82, 0x156200
    buffer_load_dword v103, v28, s[44:47], s59 offen
    s_waitcnt vmcnt(56)
    v_perm_b32 v30, v105, v104, v29
    v_accvgpr_write_b32 a168, v30
    v_perm_b32 v30, v107, v106, v29
    v_accvgpr_write_b32 a169, v30
    v_perm_b32 v30, v109, v108, v29
    v_accvgpr_write_b32 a170, v30
    v_perm_b32 v30, v111, v110, v29
    v_accvgpr_write_b32 a171, v30
    s_add_u32 s59, s82, 0x16c000
    buffer_load_dword v104, v28, s[44:47], s59 offen
    s_add_u32 s59, s82, 0x16ce00
    buffer_load_dword v105, v28, s[44:47], s59 offen
    s_add_u32 s59, s82, 0x16dc00
    buffer_load_dword v106, v28, s[44:47], s59 offen
    s_add_u32 s59, s82, 0x16ea00
    buffer_load_dword v107, v28, s[44:47], s59 offen
    s_add_u32 s59, s82, 0x16f800
    buffer_load_dword v108, v28, s[44:47], s59 offen
    s_add_u32 s59, s82, 0x170600
    buffer_load_dword v109, v28, s[44:47], s59 offen
    s_add_u32 s59, s82, 0x171400
    buffer_load_dword v110, v28, s[44:47], s59 offen
    s_add_u32 s59, s82, 0x172200
    buffer_load_dword v111, v28, s[44:47], s59 offen
    s_waitcnt vmcnt(56)
    v_perm_b32 v30, v113, v112, v29
    v_accvgpr_write_b32 a176, v30
    v_perm_b32 v30, v115, v114, v29
    v_accvgpr_write_b32 a177, v30
    v_perm_b32 v30, v117, v116, v29
    v_accvgpr_write_b32 a178, v30
    v_perm_b32 v30, v119, v118, v29
    v_accvgpr_write_b32 a179, v30
    s_add_u32 s59, s82, 0x188000
    buffer_load_dword v112, v28, s[44:47], s59 offen
    s_add_u32 s59, s82, 0x188e00
    buffer_load_dword v113, v28, s[44:47], s59 offen
    s_add_u32 s59, s82, 0x189c00
    buffer_load_dword v114, v28, s[44:47], s59 offen
    s_add_u32 s59, s82, 0x18aa00
    buffer_load_dword v115, v28, s[44:47], s59 offen
    s_add_u32 s59, s82, 0x18b800
    buffer_load_dword v116, v28, s[44:47], s59 offen
    s_add_u32 s59, s82, 0x18c600
    buffer_load_dword v117, v28, s[44:47], s59 offen
    s_add_u32 s59, s82, 0x18d400
    buffer_load_dword v118, v28, s[44:47], s59 offen
    s_add_u32 s59, s82, 0x18e200
    buffer_load_dword v119, v28, s[44:47], s59 offen
    s_waitcnt vmcnt(56)
    v_perm_b32 v30, v121, v120, v29
    v_accvgpr_write_b32 a184, v30
    v_perm_b32 v30, v123, v122, v29
    v_accvgpr_write_b32 a185, v30
    v_perm_b32 v30, v125, v124, v29
    v_accvgpr_write_b32 a186, v30
    v_perm_b32 v30, v127, v126, v29
    v_accvgpr_write_b32 a187, v30
    s_add_u32 s59, s82, 0x1a4000
    buffer_load_dword v120, v28, s[44:47], s59 offen
    s_add_u32 s59, s82, 0x1a4e00
    buffer_load_dword v121, v28, s[44:47], s59 offen
    s_add_u32 s59, s82, 0x1a5c00
    buffer_load_dword v122, v28, s[44:47], s59 offen
    s_add_u32 s59, s82, 0x1a6a00
    buffer_load_dword v123, v28, s[44:47], s59 offen
    s_add_u32 s59, s82, 0x1a7800
    buffer_load_dword v124, v28, s[44:47], s59 offen
    s_add_u32 s59, s82, 0x1a8600
    buffer_load_dword v125, v28, s[44:47], s59 offen
    s_add_u32 s59, s82, 0x1a9400
    buffer_load_dword v126, v28, s[44:47], s59 offen
    s_add_u32 s59, s82, 0x1aa200
    buffer_load_dword v127, v28, s[44:47], s59 offen
    s_waitcnt vmcnt(56)
    v_perm_b32 v30, v65, v64, v29
    v_accvgpr_write_b32 a192, v30
    v_perm_b32 v30, v67, v66, v29
    v_accvgpr_write_b32 a193, v30
    v_perm_b32 v30, v69, v68, v29
    v_accvgpr_write_b32 a194, v30
    v_perm_b32 v30, v71, v70, v29
    v_accvgpr_write_b32 a195, v30
    s_add_u32 s59, s82, 0x0
    buffer_load_dword v64, v28, s[48:51], s59 offen
    s_add_u32 s59, s82, 0xe00
    buffer_load_dword v65, v28, s[48:51], s59 offen
    s_add_u32 s59, s82, 0x1c00
    buffer_load_dword v66, v28, s[48:51], s59 offen
    s_add_u32 s59, s82, 0x2a00
    buffer_load_dword v67, v28, s[48:51], s59 offen
    s_add_u32 s59, s82, 0x3800
    buffer_load_dword v68, v28, s[48:51], s59 offen
    s_add_u32 s59, s82, 0x4600
    buffer_load_dword v69, v28, s[48:51], s59 offen
    s_add_u32 s59, s82, 0x5400
    buffer_load_dword v70, v28, s[48:51], s59 offen
    s_add_u32 s59, s82, 0x6200
    buffer_load_dword v71, v28, s[48:51], s59 offen
    s_waitcnt vmcnt(56)
    v_perm_b32 v30, v73, v72, v29
    v_accvgpr_write_b32 a200, v30
    v_perm_b32 v30, v75, v74, v29
    v_accvgpr_write_b32 a201, v30
    v_perm_b32 v30, v77, v76, v29
    v_accvgpr_write_b32 a202, v30
    v_perm_b32 v30, v79, v78, v29
    v_accvgpr_write_b32 a203, v30
    s_add_u32 s59, s82, 0x1c000
    buffer_load_dword v72, v28, s[48:51], s59 offen
    s_add_u32 s59, s82, 0x1ce00
    buffer_load_dword v73, v28, s[48:51], s59 offen
    s_add_u32 s59, s82, 0x1dc00
    buffer_load_dword v74, v28, s[48:51], s59 offen
    s_add_u32 s59, s82, 0x1ea00
    buffer_load_dword v75, v28, s[48:51], s59 offen
    s_add_u32 s59, s82, 0x1f800
    buffer_load_dword v76, v28, s[48:51], s59 offen
    s_add_u32 s59, s82, 0x20600
    buffer_load_dword v77, v28, s[48:51], s59 offen
    s_add_u32 s59, s82, 0x21400
    buffer_load_dword v78, v28, s[48:51], s59 offen
    s_add_u32 s59, s82, 0x22200
    buffer_load_dword v79, v28, s[48:51], s59 offen
    s_waitcnt vmcnt(56)
    v_perm_b32 v30, v81, v80, v29
    v_accvgpr_write_b32 a208, v30
    v_perm_b32 v30, v83, v82, v29
    v_accvgpr_write_b32 a209, v30
    v_perm_b32 v30, v85, v84, v29
    v_accvgpr_write_b32 a210, v30
    v_perm_b32 v30, v87, v86, v29
    v_accvgpr_write_b32 a211, v30
    s_add_u32 s59, s82, 0x38000
    buffer_load_dword v80, v28, s[48:51], s59 offen
    s_add_u32 s59, s82, 0x38e00
    buffer_load_dword v81, v28, s[48:51], s59 offen
    s_add_u32 s59, s82, 0x39c00
    buffer_load_dword v82, v28, s[48:51], s59 offen
    s_add_u32 s59, s82, 0x3aa00
    buffer_load_dword v83, v28, s[48:51], s59 offen
    s_add_u32 s59, s82, 0x3b800
    buffer_load_dword v84, v28, s[48:51], s59 offen
    s_add_u32 s59, s82, 0x3c600
    buffer_load_dword v85, v28, s[48:51], s59 offen
    s_add_u32 s59, s82, 0x3d400
    buffer_load_dword v86, v28, s[48:51], s59 offen
    s_add_u32 s59, s82, 0x3e200
    buffer_load_dword v87, v28, s[48:51], s59 offen
    s_waitcnt vmcnt(56)
    v_perm_b32 v30, v89, v88, v29
    v_accvgpr_write_b32 a216, v30
    v_perm_b32 v30, v91, v90, v29
    v_accvgpr_write_b32 a217, v30
    v_perm_b32 v30, v93, v92, v29
    v_accvgpr_write_b32 a218, v30
    v_perm_b32 v30, v95, v94, v29
    v_accvgpr_write_b32 a219, v30
    s_add_u32 s59, s82, 0x54000
    buffer_load_dword v88, v28, s[48:51], s59 offen
    s_add_u32 s59, s82, 0x54e00
    buffer_load_dword v89, v28, s[48:51], s59 offen
    s_add_u32 s59, s82, 0x55c00
    buffer_load_dword v90, v28, s[48:51], s59 offen
    s_add_u32 s59, s82, 0x56a00
    buffer_load_dword v91, v28, s[48:51], s59 offen
    s_add_u32 s59, s82, 0x57800
    buffer_load_dword v92, v28, s[48:51], s59 offen
    s_add_u32 s59, s82, 0x58600
    buffer_load_dword v93, v28, s[48:51], s59 offen
    s_add_u32 s59, s82, 0x59400
    buffer_load_dword v94, v28, s[48:51], s59 offen
    s_add_u32 s59, s82, 0x5a200
    buffer_load_dword v95, v28, s[48:51], s59 offen
    s_waitcnt vmcnt(56)
    v_perm_b32 v30, v97, v96, v29
    v_accvgpr_write_b32 a224, v30
    v_perm_b32 v30, v99, v98, v29
    v_accvgpr_write_b32 a225, v30
    v_perm_b32 v30, v101, v100, v29
    v_accvgpr_write_b32 a226, v30
    v_perm_b32 v30, v103, v102, v29
    v_accvgpr_write_b32 a227, v30
    s_add_u32 s59, s82, 0x70000
    buffer_load_dword v96, v28, s[48:51], s59 offen
    s_add_u32 s59, s82, 0x70e00
    buffer_load_dword v97, v28, s[48:51], s59 offen
    s_add_u32 s59, s82, 0x71c00
    buffer_load_dword v98, v28, s[48:51], s59 offen
    s_add_u32 s59, s82, 0x72a00
    buffer_load_dword v99, v28, s[48:51], s59 offen
    s_add_u32 s59, s82, 0x73800
    buffer_load_dword v100, v28, s[48:51], s59 offen
    s_add_u32 s59, s82, 0x74600
    buffer_load_dword v101, v28, s[48:51], s59 offen
    s_add_u32 s59, s82, 0x75400
    buffer_load_dword v102, v28, s[48:51], s59 offen
    s_add_u32 s59, s82, 0x76200
    buffer_load_dword v103, v28, s[48:51], s59 offen
    s_waitcnt vmcnt(56)
    v_perm_b32 v30, v105, v104, v29
    v_accvgpr_write_b32 a232, v30
    v_perm_b32 v30, v107, v106, v29
    v_accvgpr_write_b32 a233, v30
    v_perm_b32 v30, v109, v108, v29
    v_accvgpr_write_b32 a234, v30
    v_perm_b32 v30, v111, v110, v29
    v_accvgpr_write_b32 a235, v30
    s_add_u32 s59, s82, 0x8c000
    buffer_load_dword v104, v28, s[48:51], s59 offen
    s_add_u32 s59, s82, 0x8ce00
    buffer_load_dword v105, v28, s[48:51], s59 offen
    s_add_u32 s59, s82, 0x8dc00
    buffer_load_dword v106, v28, s[48:51], s59 offen
    s_add_u32 s59, s82, 0x8ea00
    buffer_load_dword v107, v28, s[48:51], s59 offen
    s_add_u32 s59, s82, 0x8f800
    buffer_load_dword v108, v28, s[48:51], s59 offen
    s_add_u32 s59, s82, 0x90600
    buffer_load_dword v109, v28, s[48:51], s59 offen
    s_add_u32 s59, s82, 0x91400
    buffer_load_dword v110, v28, s[48:51], s59 offen
    s_add_u32 s59, s82, 0x92200
    buffer_load_dword v111, v28, s[48:51], s59 offen
    s_waitcnt vmcnt(56)
    v_perm_b32 v30, v113, v112, v29
    v_accvgpr_write_b32 a240, v30
    v_perm_b32 v30, v115, v114, v29
    v_accvgpr_write_b32 a241, v30
    v_perm_b32 v30, v117, v116, v29
    v_accvgpr_write_b32 a242, v30
    v_perm_b32 v30, v119, v118, v29
    v_accvgpr_write_b32 a243, v30
    s_add_u32 s59, s82, 0xa8000
    buffer_load_dword v112, v28, s[48:51], s59 offen
    s_add_u32 s59, s82, 0xa8e00
    buffer_load_dword v113, v28, s[48:51], s59 offen
    s_add_u32 s59, s82, 0xa9c00
    buffer_load_dword v114, v28, s[48:51], s59 offen
    s_add_u32 s59, s82, 0xaaa00
    buffer_load_dword v115, v28, s[48:51], s59 offen
    s_add_u32 s59, s82, 0xab800
    buffer_load_dword v116, v28, s[48:51], s59 offen
    s_add_u32 s59, s82, 0xac600
    buffer_load_dword v117, v28, s[48:51], s59 offen
    s_add_u32 s59, s82, 0xad400
    buffer_load_dword v118, v28, s[48:51], s59 offen
    s_add_u32 s59, s82, 0xae200
    buffer_load_dword v119, v28, s[48:51], s59 offen
    s_waitcnt vmcnt(56)
    v_perm_b32 v30, v121, v120, v29
    v_accvgpr_write_b32 a248, v30
    v_perm_b32 v30, v123, v122, v29
    v_accvgpr_write_b32 a249, v30
    v_perm_b32 v30, v125, v124, v29
    v_accvgpr_write_b32 a250, v30
    v_perm_b32 v30, v127, v126, v29
    v_accvgpr_write_b32 a251, v30
    s_add_u32 s59, s82, 0xc4000
    buffer_load_dword v120, v28, s[48:51], s59 offen
    s_add_u32 s59, s82, 0xc4e00
    buffer_load_dword v121, v28, s[48:51], s59 offen
    s_add_u32 s59, s82, 0xc5c00
    buffer_load_dword v122, v28, s[48:51], s59 offen
    s_add_u32 s59, s82, 0xc6a00
    buffer_load_dword v123, v28, s[48:51], s59 offen
    s_add_u32 s59, s82, 0xc7800
    buffer_load_dword v124, v28, s[48:51], s59 offen
    s_add_u32 s59, s82, 0xc8600
    buffer_load_dword v125, v28, s[48:51], s59 offen
    s_add_u32 s59, s82, 0xc9400
    buffer_load_dword v126, v28, s[48:51], s59 offen
    s_add_u32 s59, s82, 0xca200
    buffer_load_dword v127, v28, s[48:51], s59 offen
    s_waitcnt vmcnt(56)
    v_perm_b32 v30, v65, v64, v29
    v_accvgpr_write_b32 a132, v30
    v_perm_b32 v30, v67, v66, v29
    v_accvgpr_write_b32 a133, v30
    v_perm_b32 v30, v69, v68, v29
    v_accvgpr_write_b32 a134, v30
    v_perm_b32 v30, v71, v70, v29
    v_accvgpr_write_b32 a135, v30
    s_add_u32 s59, s82, 0xe0000
    buffer_load_dword v64, v28, s[48:51], s59 offen
    s_add_u32 s59, s82, 0xe0e00
    buffer_load_dword v65, v28, s[48:51], s59 offen
    s_add_u32 s59, s82, 0xe1c00
    buffer_load_dword v66, v28, s[48:51], s59 offen
    s_add_u32 s59, s82, 0xe2a00
    buffer_load_dword v67, v28, s[48:51], s59 offen
    s_add_u32 s59, s82, 0xe3800
    buffer_load_dword v68, v28, s[48:51], s59 offen
    s_add_u32 s59, s82, 0xe4600
    buffer_load_dword v69, v28, s[48:51], s59 offen
    s_add_u32 s59, s82, 0xe5400
    buffer_load_dword v70, v28, s[48:51], s59 offen
    s_add_u32 s59, s82, 0xe6200
    buffer_load_dword v71, v28, s[48:51], s59 offen
    s_waitcnt vmcnt(56)
    v_perm_b32 v30, v73, v72, v29
    v_accvgpr_write_b32 a140, v30
    v_perm_b32 v30, v75, v74, v29
    v_accvgpr_write_b32 a141, v30
    v_perm_b32 v30, v77, v76, v29
    v_accvgpr_write_b32 a142, v30
    v_perm_b32 v30, v79, v78, v29
    v_accvgpr_write_b32 a143, v30
    s_add_u32 s59, s82, 0xfc000
    buffer_load_dword v72, v28, s[48:51], s59 offen
    s_add_u32 s59, s82, 0xfce00
    buffer_load_dword v73, v28, s[48:51], s59 offen
    s_add_u32 s59, s82, 0xfdc00
    buffer_load_dword v74, v28, s[48:51], s59 offen
    s_add_u32 s59, s82, 0xfea00
    buffer_load_dword v75, v28, s[48:51], s59 offen
    s_add_u32 s59, s82, 0xff800
    buffer_load_dword v76, v28, s[48:51], s59 offen
    s_add_u32 s59, s82, 0x100600
    buffer_load_dword v77, v28, s[48:51], s59 offen
    s_add_u32 s59, s82, 0x101400
    buffer_load_dword v78, v28, s[48:51], s59 offen
    s_add_u32 s59, s82, 0x102200
    buffer_load_dword v79, v28, s[48:51], s59 offen
    s_waitcnt vmcnt(56)
    v_perm_b32 v30, v81, v80, v29
    v_accvgpr_write_b32 a148, v30
    v_perm_b32 v30, v83, v82, v29
    v_accvgpr_write_b32 a149, v30
    v_perm_b32 v30, v85, v84, v29
    v_accvgpr_write_b32 a150, v30
    v_perm_b32 v30, v87, v86, v29
    v_accvgpr_write_b32 a151, v30
    s_add_u32 s59, s82, 0x118000
    buffer_load_dword v80, v28, s[48:51], s59 offen
    s_add_u32 s59, s82, 0x118e00
    buffer_load_dword v81, v28, s[48:51], s59 offen
    s_add_u32 s59, s82, 0x119c00
    buffer_load_dword v82, v28, s[48:51], s59 offen
    s_add_u32 s59, s82, 0x11aa00
    buffer_load_dword v83, v28, s[48:51], s59 offen
    s_add_u32 s59, s82, 0x11b800
    buffer_load_dword v84, v28, s[48:51], s59 offen
    s_add_u32 s59, s82, 0x11c600
    buffer_load_dword v85, v28, s[48:51], s59 offen
    s_add_u32 s59, s82, 0x11d400
    buffer_load_dword v86, v28, s[48:51], s59 offen
    s_add_u32 s59, s82, 0x11e200
    buffer_load_dword v87, v28, s[48:51], s59 offen
    s_waitcnt vmcnt(56)
    v_perm_b32 v30, v89, v88, v29
    v_accvgpr_write_b32 a156, v30
    v_perm_b32 v30, v91, v90, v29
    v_accvgpr_write_b32 a157, v30
    v_perm_b32 v30, v93, v92, v29
    v_accvgpr_write_b32 a158, v30
    v_perm_b32 v30, v95, v94, v29
    v_accvgpr_write_b32 a159, v30
    s_add_u32 s59, s82, 0x134000
    buffer_load_dword v88, v28, s[48:51], s59 offen
    s_add_u32 s59, s82, 0x134e00
    buffer_load_dword v89, v28, s[48:51], s59 offen
    s_add_u32 s59, s82, 0x135c00
    buffer_load_dword v90, v28, s[48:51], s59 offen
    s_add_u32 s59, s82, 0x136a00
    buffer_load_dword v91, v28, s[48:51], s59 offen
    s_add_u32 s59, s82, 0x137800
    buffer_load_dword v92, v28, s[48:51], s59 offen
    s_add_u32 s59, s82, 0x138600
    buffer_load_dword v93, v28, s[48:51], s59 offen
    s_add_u32 s59, s82, 0x139400
    buffer_load_dword v94, v28, s[48:51], s59 offen
    s_add_u32 s59, s82, 0x13a200
    buffer_load_dword v95, v28, s[48:51], s59 offen
    s_waitcnt vmcnt(56)
    v_perm_b32 v30, v97, v96, v29
    v_accvgpr_write_b32 a164, v30
    v_perm_b32 v30, v99, v98, v29
    v_accvgpr_write_b32 a165, v30
    v_perm_b32 v30, v101, v100, v29
    v_accvgpr_write_b32 a166, v30
    v_perm_b32 v30, v103, v102, v29
    v_accvgpr_write_b32 a167, v30
    s_add_u32 s59, s82, 0x150000
    buffer_load_dword v96, v28, s[48:51], s59 offen
    s_add_u32 s59, s82, 0x150e00
    buffer_load_dword v97, v28, s[48:51], s59 offen
    s_add_u32 s59, s82, 0x151c00
    buffer_load_dword v98, v28, s[48:51], s59 offen
    s_add_u32 s59, s82, 0x152a00
    buffer_load_dword v99, v28, s[48:51], s59 offen
    s_add_u32 s59, s82, 0x153800
    buffer_load_dword v100, v28, s[48:51], s59 offen
    s_add_u32 s59, s82, 0x154600
    buffer_load_dword v101, v28, s[48:51], s59 offen
    s_add_u32 s59, s82, 0x155400
    buffer_load_dword v102, v28, s[48:51], s59 offen
    s_add_u32 s59, s82, 0x156200
    buffer_load_dword v103, v28, s[48:51], s59 offen
    s_waitcnt vmcnt(56)
    v_perm_b32 v30, v105, v104, v29
    v_accvgpr_write_b32 a172, v30
    v_perm_b32 v30, v107, v106, v29
    v_accvgpr_write_b32 a173, v30
    v_perm_b32 v30, v109, v108, v29
    v_accvgpr_write_b32 a174, v30
    v_perm_b32 v30, v111, v110, v29
    v_accvgpr_write_b32 a175, v30
    s_add_u32 s59, s82, 0x16c000
    buffer_load_dword v104, v28, s[48:51], s59 offen
    s_add_u32 s59, s82, 0x16ce00
    buffer_load_dword v105, v28, s[48:51], s59 offen
    s_add_u32 s59, s82, 0x16dc00
    buffer_load_dword v106, v28, s[48:51], s59 offen
    s_add_u32 s59, s82, 0x16ea00
    buffer_load_dword v107, v28, s[48:51], s59 offen
    s_add_u32 s59, s82, 0x16f800
    buffer_load_dword v108, v28, s[48:51], s59 offen
    s_add_u32 s59, s82, 0x170600
    buffer_load_dword v109, v28, s[48:51], s59 offen
    s_add_u32 s59, s82, 0x171400
    buffer_load_dword v110, v28, s[48:51], s59 offen
    s_add_u32 s59, s82, 0x172200
    buffer_load_dword v111, v28, s[48:51], s59 offen
    s_waitcnt vmcnt(56)
    v_perm_b32 v30, v113, v112, v29
    v_accvgpr_write_b32 a180, v30
    v_perm_b32 v30, v115, v114, v29
    v_accvgpr_write_b32 a181, v30
    v_perm_b32 v30, v117, v116, v29
    v_accvgpr_write_b32 a182, v30
    v_perm_b32 v30, v119, v118, v29
    v_accvgpr_write_b32 a183, v30
    s_add_u32 s59, s82, 0x188000
    buffer_load_dword v112, v28, s[48:51], s59 offen
    s_add_u32 s59, s82, 0x188e00
    buffer_load_dword v113, v28, s[48:51], s59 offen
    s_add_u32 s59, s82, 0x189c00
    buffer_load_dword v114, v28, s[48:51], s59 offen
    s_add_u32 s59, s82, 0x18aa00
    buffer_load_dword v115, v28, s[48:51], s59 offen
    s_add_u32 s59, s82, 0x18b800
    buffer_load_dword v116, v28, s[48:51], s59 offen
    s_add_u32 s59, s82, 0x18c600
    buffer_load_dword v117, v28, s[48:51], s59 offen
    s_add_u32 s59, s82, 0x18d400
    buffer_load_dword v118, v28, s[48:51], s59 offen
    s_add_u32 s59, s82, 0x18e200
    buffer_load_dword v119, v28, s[48:51], s59 offen
    s_waitcnt vmcnt(56)
    v_perm_b32 v30, v121, v120, v29
    v_accvgpr_write_b32 a188, v30
    v_perm_b32 v30, v123, v122, v29
    v_accvgpr_write_b32 a189, v30
    v_perm_b32 v30, v125, v124, v29
    v_accvgpr_write_b32 a190, v30
    v_perm_b32 v30, v127, v126, v29
    v_accvgpr_write_b32 a191, v30
    s_add_u32 s59, s82, 0x1a4000
    buffer_load_dword v120, v28, s[48:51], s59 offen
    s_add_u32 s59, s82, 0x1a4e00
    buffer_load_dword v121, v28, s[48:51], s59 offen
    s_add_u32 s59, s82, 0x1a5c00
    buffer_load_dword v122, v28, s[48:51], s59 offen
    s_add_u32 s59, s82, 0x1a6a00
    buffer_load_dword v123, v28, s[48:51], s59 offen
    s_add_u32 s59, s82, 0x1a7800
    buffer_load_dword v124, v28, s[48:51], s59 offen
    s_add_u32 s59, s82, 0x1a8600
    buffer_load_dword v125, v28, s[48:51], s59 offen
    s_add_u32 s59, s82, 0x1a9400
    buffer_load_dword v126, v28, s[48:51], s59 offen
    s_add_u32 s59, s82, 0x1aa200
    buffer_load_dword v127, v28, s[48:51], s59 offen
    s_waitcnt vmcnt(56)
    v_perm_b32 v30, v65, v64, v29
    v_accvgpr_write_b32 a196, v30
    v_perm_b32 v30, v67, v66, v29
    v_accvgpr_write_b32 a197, v30
    v_perm_b32 v30, v69, v68, v29
    v_accvgpr_write_b32 a198, v30
    v_perm_b32 v30, v71, v70, v29
    v_accvgpr_write_b32 a199, v30
    s_waitcnt vmcnt(48)
    v_perm_b32 v30, v73, v72, v29
    v_accvgpr_write_b32 a204, v30
    v_perm_b32 v30, v75, v74, v29
    v_accvgpr_write_b32 a205, v30
    v_perm_b32 v30, v77, v76, v29
    v_accvgpr_write_b32 a206, v30
    v_perm_b32 v30, v79, v78, v29
    v_accvgpr_write_b32 a207, v30
    s_waitcnt vmcnt(40)
    v_perm_b32 v30, v81, v80, v29
    v_accvgpr_write_b32 a212, v30
    v_perm_b32 v30, v83, v82, v29
    v_accvgpr_write_b32 a213, v30
    v_perm_b32 v30, v85, v84, v29
    v_accvgpr_write_b32 a214, v30
    v_perm_b32 v30, v87, v86, v29
    v_accvgpr_write_b32 a215, v30
    s_waitcnt vmcnt(32)
    v_perm_b32 v30, v89, v88, v29
    v_accvgpr_write_b32 a220, v30
    v_perm_b32 v30, v91, v90, v29
    v_accvgpr_write_b32 a221, v30
    v_perm_b32 v30, v93, v92, v29
    v_accvgpr_write_b32 a222, v30
    v_perm_b32 v30, v95, v94, v29
    v_accvgpr_write_b32 a223, v30
    s_waitcnt vmcnt(24)
    v_perm_b32 v30, v97, v96, v29
    v_accvgpr_write_b32 a228, v30
    v_perm_b32 v30, v99, v98, v29
    v_accvgpr_write_b32 a229, v30
    v_perm_b32 v30, v101, v100, v29
    v_accvgpr_write_b32 a230, v30
    v_perm_b32 v30, v103, v102, v29
    v_accvgpr_write_b32 a231, v30
    s_waitcnt vmcnt(16)
    v_perm_b32 v30, v105, v104, v29
    v_accvgpr_write_b32 a236, v30
    v_perm_b32 v30, v107, v106, v29
    v_accvgpr_write_b32 a237, v30
    v_perm_b32 v30, v109, v108, v29
    v_accvgpr_write_b32 a238, v30
    v_perm_b32 v30, v111, v110, v29
    v_accvgpr_write_b32 a239, v30
    s_waitcnt vmcnt(8)
    v_perm_b32 v30, v113, v112, v29
    v_accvgpr_write_b32 a244, v30
    v_perm_b32 v30, v115, v114, v29
    v_accvgpr_write_b32 a245, v30
    v_perm_b32 v30, v117, v116, v29
    v_accvgpr_write_b32 a246, v30
    v_perm_b32 v30, v119, v118, v29
    v_accvgpr_write_b32 a247, v30
    s_waitcnt vmcnt(0)
    v_perm_b32 v30, v121, v120, v29
    v_accvgpr_write_b32 a252, v30
    v_perm_b32 v30, v123, v122, v29
    v_accvgpr_write_b32 a253, v30
    v_perm_b32 v30, v125, v124, v29
    v_accvgpr_write_b32 a254, v30
    v_perm_b32 v30, v127, v126, v29
    v_accvgpr_write_b32 a255, v30
    v_lshrrev_b32 v30, 4, v0
    s_mov_b32 s59, 8192
    v_mul_lo_u32 v28, v30, s59
    v_and_b32 v30, 15, v0
    v_mul_u32_u24 v30, 4, v30
    v_add_u32 v28, v28, v30
    s_lshr_b32 s83, s56, 1
    s_and_b32 s84, s56, 1
    s_mul_i32 s82, s57, 458752
    s_lshl_b32 s59, s83, 6
    s_add_u32 s82, s82, s59
    s_add_u32 s59, s82, 0x0
    buffer_load_dword v64, v28, s[52:55], s59 offen
    s_add_u32 s59, s82, 0x400
    buffer_load_dword v65, v28, s[52:55], s59 offen
    s_add_u32 s59, s82, 0x800
    buffer_load_dword v66, v28, s[52:55], s59 offen
    s_add_u32 s59, s82, 0xc00
    buffer_load_dword v67, v28, s[52:55], s59 offen
    s_add_u32 s59, s82, 0x1000
    buffer_load_dword v68, v28, s[52:55], s59 offen
    s_add_u32 s59, s82, 0x1400
    buffer_load_dword v69, v28, s[52:55], s59 offen
    s_add_u32 s59, s82, 0x1800
    buffer_load_dword v70, v28, s[52:55], s59 offen
    s_add_u32 s59, s82, 0x1c00
    buffer_load_dword v71, v28, s[52:55], s59 offen
    s_add_u32 s59, s82, 0x8000
    buffer_load_dword v72, v28, s[52:55], s59 offen
    s_add_u32 s59, s82, 0x8400
    buffer_load_dword v73, v28, s[52:55], s59 offen
    s_add_u32 s59, s82, 0x8800
    buffer_load_dword v74, v28, s[52:55], s59 offen
    s_add_u32 s59, s82, 0x8c00
    buffer_load_dword v75, v28, s[52:55], s59 offen
    s_add_u32 s59, s82, 0x9000
    buffer_load_dword v76, v28, s[52:55], s59 offen
    s_add_u32 s59, s82, 0x9400
    buffer_load_dword v77, v28, s[52:55], s59 offen
    s_add_u32 s59, s82, 0x9800
    buffer_load_dword v78, v28, s[52:55], s59 offen
    s_add_u32 s59, s82, 0x9c00
    buffer_load_dword v79, v28, s[52:55], s59 offen
    s_add_u32 s59, s82, 0x10000
    buffer_load_dword v80, v28, s[52:55], s59 offen
    s_add_u32 s59, s82, 0x10400
    buffer_load_dword v81, v28, s[52:55], s59 offen
    s_add_u32 s59, s82, 0x10800
    buffer_load_dword v82, v28, s[52:55], s59 offen
    s_add_u32 s59, s82, 0x10c00
    buffer_load_dword v83, v28, s[52:55], s59 offen
    s_add_u32 s59, s82, 0x11000
    buffer_load_dword v84, v28, s[52:55], s59 offen
    s_add_u32 s59, s82, 0x11400
    buffer_load_dword v85, v28, s[52:55], s59 offen
    s_add_u32 s59, s82, 0x11800
    buffer_load_dword v86, v28, s[52:55], s59 offen
    s_add_u32 s59, s82, 0x11c00
    buffer_load_dword v87, v28, s[52:55], s59 offen
    s_add_u32 s59, s82, 0x18000
    buffer_load_dword v88, v28, s[52:55], s59 offen
    s_add_u32 s59, s82, 0x18400
    buffer_load_dword v89, v28, s[52:55], s59 offen
    s_add_u32 s59, s82, 0x18800
    buffer_load_dword v90, v28, s[52:55], s59 offen
    s_add_u32 s59, s82, 0x18c00
    buffer_load_dword v91, v28, s[52:55], s59 offen
    s_add_u32 s59, s82, 0x19000
    buffer_load_dword v92, v28, s[52:55], s59 offen
    s_add_u32 s59, s82, 0x19400
    buffer_load_dword v93, v28, s[52:55], s59 offen
    s_add_u32 s59, s82, 0x19800
    buffer_load_dword v94, v28, s[52:55], s59 offen
    s_add_u32 s59, s82, 0x19c00
    buffer_load_dword v95, v28, s[52:55], s59 offen
    s_add_u32 s59, s82, 0x20000
    buffer_load_dword v96, v28, s[52:55], s59 offen
    s_add_u32 s59, s82, 0x20400
    buffer_load_dword v97, v28, s[52:55], s59 offen
    s_add_u32 s59, s82, 0x20800
    buffer_load_dword v98, v28, s[52:55], s59 offen
    s_add_u32 s59, s82, 0x20c00
    buffer_load_dword v99, v28, s[52:55], s59 offen
    s_add_u32 s59, s82, 0x21000
    buffer_load_dword v100, v28, s[52:55], s59 offen
    s_add_u32 s59, s82, 0x21400
    buffer_load_dword v101, v28, s[52:55], s59 offen
    s_add_u32 s59, s82, 0x21800
    buffer_load_dword v102, v28, s[52:55], s59 offen
    s_add_u32 s59, s82, 0x21c00
    buffer_load_dword v103, v28, s[52:55], s59 offen
    s_add_u32 s59, s82, 0x28000
    buffer_load_dword v104, v28, s[52:55], s59 offen
    s_add_u32 s59, s82, 0x28400
    buffer_load_dword v105, v28, s[52:55], s59 offen
    s_add_u32 s59, s82, 0x28800
    buffer_load_dword v106, v28, s[52:55], s59 offen
    s_add_u32 s59, s82, 0x28c00
    buffer_load_dword v107, v28, s[52:55], s59 offen
    s_add_u32 s59, s82, 0x29000
    buffer_load_dword v108, v28, s[52:55], s59 offen
    s_add_u32 s59, s82, 0x29400
    buffer_load_dword v109, v28, s[52:55], s59 offen
    s_add_u32 s59, s82, 0x29800
    buffer_load_dword v110, v28, s[52:55], s59 offen
    s_add_u32 s59, s82, 0x29c00
    buffer_load_dword v111, v28, s[52:55], s59 offen
    s_add_u32 s59, s82, 0x30000
    buffer_load_dword v112, v28, s[52:55], s59 offen
    s_add_u32 s59, s82, 0x30400
    buffer_load_dword v113, v28, s[52:55], s59 offen
    s_add_u32 s59, s82, 0x30800
    buffer_load_dword v114, v28, s[52:55], s59 offen
    s_add_u32 s59, s82, 0x30c00
    buffer_load_dword v115, v28, s[52:55], s59 offen
    s_add_u32 s59, s82, 0x31000
    buffer_load_dword v116, v28, s[52:55], s59 offen
    s_add_u32 s59, s82, 0x31400
    buffer_load_dword v117, v28, s[52:55], s59 offen
    s_add_u32 s59, s82, 0x31800
    buffer_load_dword v118, v28, s[52:55], s59 offen
    s_add_u32 s59, s82, 0x31c00
    buffer_load_dword v119, v28, s[52:55], s59 offen
    s_add_u32 s59, s82, 0x38000
    buffer_load_dword v120, v28, s[52:55], s59 offen
    s_add_u32 s59, s82, 0x38400
    buffer_load_dword v121, v28, s[52:55], s59 offen
    s_add_u32 s59, s82, 0x38800
    buffer_load_dword v122, v28, s[52:55], s59 offen
    s_add_u32 s59, s82, 0x38c00
    buffer_load_dword v123, v28, s[52:55], s59 offen
    s_add_u32 s59, s82, 0x39000
    buffer_load_dword v124, v28, s[52:55], s59 offen
    s_add_u32 s59, s82, 0x39400
    buffer_load_dword v125, v28, s[52:55], s59 offen
    s_add_u32 s59, s82, 0x39800
    buffer_load_dword v126, v28, s[52:55], s59 offen
    s_add_u32 s59, s82, 0x39c00
    buffer_load_dword v127, v28, s[52:55], s59 offen
    s_waitcnt vmcnt(56)
    v_perm_b32 v128, v65, v64, s66
    v_perm_b32 v132, v65, v64, s67
    v_perm_b32 v129, v67, v66, s66
    v_perm_b32 v133, v67, v66, s67
    v_perm_b32 v130, v69, v68, s66
    v_perm_b32 v134, v69, v68, s67
    v_perm_b32 v131, v71, v70, s66
    v_perm_b32 v135, v71, v70, s67
    s_add_u32 s59, s82, 0x40000
    buffer_load_dword v64, v28, s[52:55], s59 offen
    s_add_u32 s59, s82, 0x40400
    buffer_load_dword v65, v28, s[52:55], s59 offen
    s_add_u32 s59, s82, 0x40800
    buffer_load_dword v66, v28, s[52:55], s59 offen
    s_add_u32 s59, s82, 0x40c00
    buffer_load_dword v67, v28, s[52:55], s59 offen
    s_add_u32 s59, s82, 0x41000
    buffer_load_dword v68, v28, s[52:55], s59 offen
    s_add_u32 s59, s82, 0x41400
    buffer_load_dword v69, v28, s[52:55], s59 offen
    s_add_u32 s59, s82, 0x41800
    buffer_load_dword v70, v28, s[52:55], s59 offen
    s_add_u32 s59, s82, 0x41c00
    buffer_load_dword v71, v28, s[52:55], s59 offen
    s_waitcnt vmcnt(56)
    v_perm_b32 v136, v73, v72, s66
    v_perm_b32 v140, v73, v72, s67
    v_perm_b32 v137, v75, v74, s66
    v_perm_b32 v141, v75, v74, s67
    v_perm_b32 v138, v77, v76, s66
    v_perm_b32 v142, v77, v76, s67
    v_perm_b32 v139, v79, v78, s66
    v_perm_b32 v143, v79, v78, s67
    s_add_u32 s59, s82, 0x48000
    buffer_load_dword v72, v28, s[52:55], s59 offen
    s_add_u32 s59, s82, 0x48400
    buffer_load_dword v73, v28, s[52:55], s59 offen
    s_add_u32 s59, s82, 0x48800
    buffer_load_dword v74, v28, s[52:55], s59 offen
    s_add_u32 s59, s82, 0x48c00
    buffer_load_dword v75, v28, s[52:55], s59 offen
    s_add_u32 s59, s82, 0x49000
    buffer_load_dword v76, v28, s[52:55], s59 offen
    s_add_u32 s59, s82, 0x49400
    buffer_load_dword v77, v28, s[52:55], s59 offen
    s_add_u32 s59, s82, 0x49800
    buffer_load_dword v78, v28, s[52:55], s59 offen
    s_add_u32 s59, s82, 0x49c00
    buffer_load_dword v79, v28, s[52:55], s59 offen
    s_waitcnt vmcnt(56)
    v_perm_b32 v144, v81, v80, s66
    v_perm_b32 v148, v81, v80, s67
    v_perm_b32 v145, v83, v82, s66
    v_perm_b32 v149, v83, v82, s67
    v_perm_b32 v146, v85, v84, s66
    v_perm_b32 v150, v85, v84, s67
    v_perm_b32 v147, v87, v86, s66
    v_perm_b32 v151, v87, v86, s67
    s_add_u32 s59, s82, 0x50000
    buffer_load_dword v80, v28, s[52:55], s59 offen
    s_add_u32 s59, s82, 0x50400
    buffer_load_dword v81, v28, s[52:55], s59 offen
    s_add_u32 s59, s82, 0x50800
    buffer_load_dword v82, v28, s[52:55], s59 offen
    s_add_u32 s59, s82, 0x50c00
    buffer_load_dword v83, v28, s[52:55], s59 offen
    s_add_u32 s59, s82, 0x51000
    buffer_load_dword v84, v28, s[52:55], s59 offen
    s_add_u32 s59, s82, 0x51400
    buffer_load_dword v85, v28, s[52:55], s59 offen
    s_add_u32 s59, s82, 0x51800
    buffer_load_dword v86, v28, s[52:55], s59 offen
    s_add_u32 s59, s82, 0x51c00
    buffer_load_dword v87, v28, s[52:55], s59 offen
    s_waitcnt vmcnt(56)
    v_perm_b32 v152, v89, v88, s66
    v_perm_b32 v156, v89, v88, s67
    v_perm_b32 v153, v91, v90, s66
    v_perm_b32 v157, v91, v90, s67
    v_perm_b32 v154, v93, v92, s66
    v_perm_b32 v158, v93, v92, s67
    v_perm_b32 v155, v95, v94, s66
    v_perm_b32 v159, v95, v94, s67
    s_add_u32 s59, s82, 0x58000
    buffer_load_dword v88, v28, s[52:55], s59 offen
    s_add_u32 s59, s82, 0x58400
    buffer_load_dword v89, v28, s[52:55], s59 offen
    s_add_u32 s59, s82, 0x58800
    buffer_load_dword v90, v28, s[52:55], s59 offen
    s_add_u32 s59, s82, 0x58c00
    buffer_load_dword v91, v28, s[52:55], s59 offen
    s_add_u32 s59, s82, 0x59000
    buffer_load_dword v92, v28, s[52:55], s59 offen
    s_add_u32 s59, s82, 0x59400
    buffer_load_dword v93, v28, s[52:55], s59 offen
    s_add_u32 s59, s82, 0x59800
    buffer_load_dword v94, v28, s[52:55], s59 offen
    s_add_u32 s59, s82, 0x59c00
    buffer_load_dword v95, v28, s[52:55], s59 offen
    s_waitcnt vmcnt(56)
    v_perm_b32 v160, v97, v96, s66
    v_perm_b32 v164, v97, v96, s67
    v_perm_b32 v161, v99, v98, s66
    v_perm_b32 v165, v99, v98, s67
    v_perm_b32 v162, v101, v100, s66
    v_perm_b32 v166, v101, v100, s67
    v_perm_b32 v163, v103, v102, s66
    v_perm_b32 v167, v103, v102, s67
    s_add_u32 s59, s82, 0x60000
    buffer_load_dword v96, v28, s[52:55], s59 offen
    s_add_u32 s59, s82, 0x60400
    buffer_load_dword v97, v28, s[52:55], s59 offen
    s_add_u32 s59, s82, 0x60800
    buffer_load_dword v98, v28, s[52:55], s59 offen
    s_add_u32 s59, s82, 0x60c00
    buffer_load_dword v99, v28, s[52:55], s59 offen
    s_add_u32 s59, s82, 0x61000
    buffer_load_dword v100, v28, s[52:55], s59 offen
    s_add_u32 s59, s82, 0x61400
    buffer_load_dword v101, v28, s[52:55], s59 offen
    s_add_u32 s59, s82, 0x61800
    buffer_load_dword v102, v28, s[52:55], s59 offen
    s_add_u32 s59, s82, 0x61c00
    buffer_load_dword v103, v28, s[52:55], s59 offen
    s_waitcnt vmcnt(56)
    v_perm_b32 v168, v105, v104, s66
    v_perm_b32 v172, v105, v104, s67
    v_perm_b32 v169, v107, v106, s66
    v_perm_b32 v173, v107, v106, s67
    v_perm_b32 v170, v109, v108, s66
    v_perm_b32 v174, v109, v108, s67
    v_perm_b32 v171, v111, v110, s66
    v_perm_b32 v175, v111, v110, s67
    s_add_u32 s59, s82, 0x68000
    buffer_load_dword v104, v28, s[52:55], s59 offen
    s_add_u32 s59, s82, 0x68400
    buffer_load_dword v105, v28, s[52:55], s59 offen
    s_add_u32 s59, s82, 0x68800
    buffer_load_dword v106, v28, s[52:55], s59 offen
    s_add_u32 s59, s82, 0x68c00
    buffer_load_dword v107, v28, s[52:55], s59 offen
    s_add_u32 s59, s82, 0x69000
    buffer_load_dword v108, v28, s[52:55], s59 offen
    s_add_u32 s59, s82, 0x69400
    buffer_load_dword v109, v28, s[52:55], s59 offen
    s_add_u32 s59, s82, 0x69800
    buffer_load_dword v110, v28, s[52:55], s59 offen
    s_add_u32 s59, s82, 0x69c00
    buffer_load_dword v111, v28, s[52:55], s59 offen
    s_waitcnt vmcnt(56)
    v_perm_b32 v176, v113, v112, s66
    v_perm_b32 v180, v113, v112, s67
    v_perm_b32 v177, v115, v114, s66
    v_perm_b32 v181, v115, v114, s67
    v_perm_b32 v178, v117, v116, s66
    v_perm_b32 v182, v117, v116, s67
    v_perm_b32 v179, v119, v118, s66
    v_perm_b32 v183, v119, v118, s67
    s_waitcnt vmcnt(48)
    v_perm_b32 v184, v121, v120, s66
    v_perm_b32 v188, v121, v120, s67
    v_perm_b32 v185, v123, v122, s66
    v_perm_b32 v189, v123, v122, s67
    v_perm_b32 v186, v125, v124, s66
    v_perm_b32 v190, v125, v124, s67
    v_perm_b32 v187, v127, v126, s66
    v_perm_b32 v191, v127, v126, s67
    s_waitcnt vmcnt(40)
    v_perm_b32 v192, v65, v64, s66
    v_perm_b32 v196, v65, v64, s67
    v_perm_b32 v193, v67, v66, s66
    v_perm_b32 v197, v67, v66, s67
    v_perm_b32 v194, v69, v68, s66
    v_perm_b32 v198, v69, v68, s67
    v_perm_b32 v195, v71, v70, s66
    v_perm_b32 v199, v71, v70, s67
    s_waitcnt vmcnt(32)
    v_perm_b32 v200, v73, v72, s66
    v_perm_b32 v204, v73, v72, s67
    v_perm_b32 v201, v75, v74, s66
    v_perm_b32 v205, v75, v74, s67
    v_perm_b32 v202, v77, v76, s66
    v_perm_b32 v206, v77, v76, s67
    v_perm_b32 v203, v79, v78, s66
    v_perm_b32 v207, v79, v78, s67
    s_waitcnt vmcnt(24)
    v_perm_b32 v208, v81, v80, s66
    v_perm_b32 v212, v81, v80, s67
    v_perm_b32 v209, v83, v82, s66
    v_perm_b32 v213, v83, v82, s67
    v_perm_b32 v210, v85, v84, s66
    v_perm_b32 v214, v85, v84, s67
    v_perm_b32 v211, v87, v86, s66
    v_perm_b32 v215, v87, v86, s67
    s_waitcnt vmcnt(16)
    v_perm_b32 v216, v89, v88, s66
    v_perm_b32 v220, v89, v88, s67
    v_perm_b32 v217, v91, v90, s66
    v_perm_b32 v221, v91, v90, s67
    v_perm_b32 v218, v93, v92, s66
    v_perm_b32 v222, v93, v92, s67
    v_perm_b32 v219, v95, v94, s66
    v_perm_b32 v223, v95, v94, s67
    s_waitcnt vmcnt(8)
    v_perm_b32 v224, v97, v96, s66
    v_perm_b32 v228, v97, v96, s67
    v_perm_b32 v225, v99, v98, s66
    v_perm_b32 v229, v99, v98, s67
    v_perm_b32 v226, v101, v100, s66
    v_perm_b32 v230, v101, v100, s67
    v_perm_b32 v227, v103, v102, s66
    v_perm_b32 v231, v103, v102, s67
    s_waitcnt vmcnt(0)
    v_perm_b32 v232, v105, v104, s66
    v_perm_b32 v236, v105, v104, s67
    v_perm_b32 v233, v107, v106, s66
    v_perm_b32 v237, v107, v106, s67
    v_perm_b32 v234, v109, v108, s66
    v_perm_b32 v238, v109, v108, s67
    v_perm_b32 v235, v111, v110, s66
    v_perm_b32 v239, v111, v110, s67
    s_mov_b32 s40, s4
    s_and_b32 s41, s5, 0xffff
    s_mov_b32 s42, 0x200000
    s_mov_b32 s43, 0x20000
    s_mov_b32 s44, s30
    s_and_b32 s45, s31, 0xffff
    s_mov_b32 s46, 0x200000
    s_mov_b32 s47, 0x20000
    v_mov_b32 v28, 0
    s_nop 1
Lrdy_73:
    global_load_dword v29, v28, s[32:33] offset:4 sc1
    s_waitcnt vmcnt(0)
    v_cmp_ne_u32 vcc, 0, v29
    s_nop 0
    s_cmp_eq_u64 vcc, exec
    s_nop 1
    s_cbranch_scc0 Lrdy_73
    v_min_u32 v28, 47, v0
    v_lshlrev_b32 v28, 7, v28
    v_add_u32 v28, 0x624800, v28
    s_mov_b32 s61, 1
    s_nop 0
Lw_74:
    buffer_load_dword v29, v28, s[36:39], 0 offen sc1
    s_waitcnt vmcnt(0)
    v_cmp_le_u32 vcc, s61, v29
    s_nop 0
    s_cmp_eq_u64 vcc, exec
    s_nop 1
    s_cbranch_scc1 Lwd_75
    s_sleep 1
    s_branch Lw_74
Lwd_75:
    v_lshrrev_b32 v28, 4, v0
    v_and_b32 v29, 15, v0
    v_lshlrev_b32 v2, 9, v28
    v_lshl_add_u32 v2, v29, 4, v2
    v_lshlrev_b32 v23, 5, v0
    v_lshlrev_b32 v5, 11, v29
    v_lshl_add_u32 v5, v28, 4, v5
    s_lshl_b32 s59, s81, 8
    s_lshl_b32 s60, s57, 6
    s_add_u32 s59, s59, s60
    s_lshl_b32 s60, s80, 16
    s_add_u32 s59, s59, s60
    s_add_u32 s73, s59, 0x4000000
    s_lshl_b32 s59, s57, 13
    s_add_u32 s59, s59, 65536
    v_add_u32 v3, s59, v1
    s_lshl_b32 s59, s57, 11
    s_add_u32 s59, s59, 65536
    v_add_u32 v4, s59, v1
    v_and_b32 v30, 1, v0
    v_lshlrev_b32 v30, 8, v30
    s_lshl_b32 s59, s72, 9
    s_add_u32 s59, s59, 0x616800
    v_add_u32 v6, s59, v30
    s_lshl_b32 s74, s72, 14
    s_add_u32 s74, s74, 0x3000000
    s_mul_i32 s77, s90, 12288
    s_add_u32 s77, s77, 0x62c000
    v_and_b32 v7, 31, v0
    v_lshlrev_b32 v7, 7, v7
    v_add_u32 v7, s77, v7
    v_and_b32 v22, 7, v0
    v_min_u32 v22, 6, v22
    v_lshlrev_b32 v22, 7, v22
    s_mul_i32 s59, s57, 896
    s_add_u32 s59, s59, s77
    s_add_u32 s59, s59, 8192
    v_add_u32 v22, s59, v22
    s_lshl_b32 s59, s56, 7
    s_add_u32 s77, s77, s59
    s_and_b32 s59, s57, 1
    s_lshl_b32 s60, s59, 7
    v_xor_b32 v10, s60, v1
    v_and_b32 v18, 15, v0
    v_lshrrev_b32 v17, 4, v0
    v_xor_b32 v17, v17, v18
    v_lshlrev_b32 v17, 4, v17
    v_lshl_or_b32 v18, v18, 10, v17
    v_xor_b32 v11, 0, v18
    v_xor_b32 v12, 64, v18
    v_xor_b32 v13, 128, v18
    v_xor_b32 v14, 192, v18
    v_xor_b32 v18, 0x4000, v14
    v_xor_b32 v17, 0x4000, v13
    v_xor_b32 v16, 0x4000, v12
    v_xor_b32 v15, 0x4000, v11
    v_lshrrev_b32 v19, 5, v0
    v_lshlrev_b32 v19, 9, v19
    v_lshl_add_u32 v19, v29, 4, v19
    v_bfe_u32 v30, v0, 4, 1
    v_lshl_add_u32 v19, v30, 3, v19
    s_lshl_b32 s75, s78, 12
    s_lshl_b32 s59, s57, 10
    s_add_u32 s75, s75, s59
    s_add_u32 s75, s75, 0x5000000
    v_lshlrev_b32 v20, 10, v29
    v_lshl_add_u32 v20, v28, 4, v20
    s_lshl_b32 s59, s84, 14
    s_lshl_b32 s60, s83, 6
    s_add_u32 s59, s59, s60
    s_lshl_b32 s60, s57, 2
    s_add_u32 s59, s59, s60
    v_add_u32 v20, s59, v20
    s_add_u32 s59, s60, 65536
    v_add_u32 v21, s59, v1
    s_mul_i32 s76, s57, 28672
    s_lshl_b32 s59, s84, 8
    s_add_u32 s76, s76, s59
    s_add_u32 s76, s76, 0x5000000
    v_lshlrev_b32 v30, 5, v28
    s_lshl_b32 s59, s83, 7
    s_lshl_b32 s60, s57, 3
    s_add_u32 s59, s59, s60
    s_add_u32 s59, s59, 0x602800
    buffer_load_dwordx2 v[24:25], v30, s[36:39], s59 offen sc1
    s_mov_b32 s59, 0x601000
    buffer_load_dwordx4 v[240:243], v23, s[36:39], s59 offen sc1
    buffer_load_dwordx4 v[244:247], v23, s[36:39], s59 offen offset:16 sc1
    s_mov_b32 s59, 0x602000
    buffer_load_dwordx4 v[248:251], v23, s[36:39], s59 offen sc1
    buffer_load_dwordx4 v[252:255], v23, s[36:39], s59 offen offset:16 sc1
    s_mov_b32 s59, 0x601800
    buffer_load_dwordx4 v[32:35], v23, s[36:39], s59 offen sc1
    buffer_load_dwordx4 v[36:39], v23, s[36:39], s59 offen offset:16 sc1
    s_waitcnt vmcnt(0)
    v_add_f32 v248, 1.0, v248
    v_add_f32 v249, 1.0, v249
    v_add_f32 v250, 1.0, v250
    v_add_f32 v251, 1.0, v251
    v_add_f32 v252, 1.0, v252
    v_add_f32 v253, 1.0, v253
    v_add_f32 v254, 1.0, v254
    v_add_f32 v255, 1.0, v255
    v_cvt_pk_bf16_f32 v8, v248, v249
    v_lshlrev_b32 v248, 16, v8
    v_and_b32 v249, s68, v8
    v_cvt_pk_bf16_f32 v8, v250, v251
    v_lshlrev_b32 v250, 16, v8
    v_and_b32 v251, s68, v8
    v_cvt_pk_bf16_f32 v8, v252, v253
    v_lshlrev_b32 v252, 16, v8
    v_and_b32 v253, s68, v8
    v_cvt_pk_bf16_f32 v8, v254, v255
    v_lshlrev_b32 v254, 16, v8
    v_and_b32 v255, s68, v8
    v_add_u32 v26, 131072, v23
    ds_write_b128 v26, v[32:35]
    ds_write_b128 v26, v[36:39] offset:16
    s_waitcnt lgkmcnt(0)
    s_mov_b32 s92, 0x1084210f
    s_mov_b32 s93, 0x84210842
    s_cmp_eq_u32 s90, 1
    s_cselect_b32 s92, 0x21084210, s92
    s_cselect_b32 s93, 0x8421084, s93
    s_cmp_eq_u32 s90, 2
    s_cselect_b32 s92, 0x42108420, s92
    s_cselect_b32 s93, 0x10842108, s93
    s_cmp_eq_u32 s90, 3
    s_cselect_b32 s92, 0x84210840, s92
    s_cselect_b32 s93, 0x21084210, s93
    s_cmp_eq_u32 s90, 4
    s_cselect_b32 s92, 0x8421080, s92
    s_cselect_b32 s93, 0x42108421, s93
PStop_76:
    s_ff1_i32_b64 s58, s[92:93]
    s_bitset0_b64 s[92:93], s58
    s_add_u32 s61, s58, 1
    s_lshl_b32 s79, s58, 5
    s_add_u32 s79, s79, s56
    s_lshl_b32 s79, s79, 10
    buffer_load_dwordx4 v[28:31], v1, s[40:43], s79 offen
    s_lshl_b32 s88, s90, 5
    s_add_u32 s88, s88, s56
    s_lshl_b32 s88, s88, 10
    s_and_b32 s59, s58, 1
    s_lshl_b32 s59, s59, 7
    v_add_u32 v27, s59, v6
    s_nop 1
Lw_77:
    buffer_load_dword v8, v27, s[36:39], 0 offen sc1
    s_waitcnt vmcnt(0)
    v_cmp_le_u32 vcc, s61, v8
    s_nop 0
    s_cmp_eq_u64 vcc, exec
    s_nop 1
    s_cbranch_scc1 Lwd_78
    s_sleep 1
    s_branch Lw_77
Lwd_78:
    s_lshl_b32 s59, s58, 18
    s_add_u32 s59, s59, s74
    s_add_u32 s60, s59, 4096
    s_add_u32 s62, s59, 8192
    s_add_u32 s63, s59, 12288
    buffer_load_dwordx4 v[32:35], v2, s[36:39], s59 offen offset:0 sc1
    buffer_load_dwordx4 v[40:43], v2, s[36:39], s59 offen offset:2048 sc1
    buffer_load_dwordx4 v[48:51], v2, s[36:39], s60 offen offset:0 sc1
    buffer_load_dwordx4 v[56:59], v2, s[36:39], s60 offen offset:2048 sc1
    buffer_load_dwordx4 v[64:67], v2, s[36:39], s62 offen offset:0 sc1
    buffer_load_dwordx4 v[72:75], v2, s[36:39], s62 offen offset:2048 sc1
    buffer_load_dwordx4 v[80:83], v2, s[36:39], s63 offen offset:0 sc1
    buffer_load_dwordx4 v[88:91], v2, s[36:39], s63 offen offset:2048 sc1
    buffer_load_dwordx4 v[36:39], v2, s[36:39], s59 offen offset:256 sc1
    buffer_load_dwordx4 v[44:47], v2, s[36:39], s59 offen offset:2304 sc1
    buffer_load_dwordx4 v[52:55], v2, s[36:39], s60 offen offset:256 sc1
    buffer_load_dwordx4 v[60:63], v2, s[36:39], s60 offen offset:2304 sc1
    buffer_load_dwordx4 v[68:71], v2, s[36:39], s62 offen offset:256 sc1
    buffer_load_dwordx4 v[76:79], v2, s[36:39], s62 offen offset:2304 sc1
    buffer_load_dwordx4 v[84:87], v2, s[36:39], s63 offen offset:256 sc1
    buffer_load_dwordx4 v[92:95], v2, s[36:39], s63 offen offset:2304 sc1
    s_waitcnt vmcnt(15)
    v_mfma_f32_16x16x32_bf16 v[96:99], a[0:3], v[32:35], 0
    v_mfma_f32_16x16x32_bf16 v[104:107], a[4:7], v[32:35], 0
    v_mfma_f32_16x16x32_bf16 v[112:115], a[8:11], v[32:35], 0
    v_mfma_f32_16x16x32_bf16 v[120:123], a[12:15], v[32:35], 0
    s_waitcnt vmcnt(14)
    v_mfma_f32_16x16x32_bf16 v[96:99], a[16:19], v[40:43], v[96:99]
    v_mfma_f32_16x16x32_bf16 v[104:107], a[20:23], v[40:43], v[104:107]
    v_mfma_f32_16x16x32_bf16 v[112:115], a[24:27], v[40:43], v[112:115]
    v_mfma_f32_16x16x32_bf16 v[120:123], a[28:31], v[40:43], v[120:123]
    s_waitcnt vmcnt(13)
    v_mfma_f32_16x16x32_bf16 v[96:99], a[32:35], v[48:51], v[96:99]
    v_mfma_f32_16x16x32_bf16 v[104:107], a[36:39], v[48:51], v[104:107]
    v_mfma_f32_16x16x32_bf16 v[112:115], a[40:43], v[48:51], v[112:115]
    v_mfma_f32_16x16x32_bf16 v[120:123], a[44:47], v[48:51], v[120:123]
    s_waitcnt vmcnt(12)
    v_mfma_f32_16x16x32_bf16 v[96:99], a[48:51], v[56:59], v[96:99]
    v_mfma_f32_16x16x32_bf16 v[104:107], a[52:55], v[56:59], v[104:107]
    v_mfma_f32_16x16x32_bf16 v[112:115], a[56:59], v[56:59], v[112:115]
    v_mfma_f32_16x16x32_bf16 v[120:123], a[60:63], v[56:59], v[120:123]
    s_waitcnt vmcnt(11)
    v_mfma_f32_16x16x32_bf16 v[96:99], a[64:67], v[64:67], v[96:99]
    v_mfma_f32_16x16x32_bf16 v[104:107], a[68:71], v[64:67], v[104:107]
    v_mfma_f32_16x16x32_bf16 v[112:115], a[72:75], v[64:67], v[112:115]
    v_mfma_f32_16x16x32_bf16 v[120:123], a[76:79], v[64:67], v[120:123]
    s_waitcnt vmcnt(10)
    v_mfma_f32_16x16x32_bf16 v[96:99], a[80:83], v[72:75], v[96:99]
    v_mfma_f32_16x16x32_bf16 v[104:107], a[84:87], v[72:75], v[104:107]
    v_mfma_f32_16x16x32_bf16 v[112:115], a[88:91], v[72:75], v[112:115]
    v_mfma_f32_16x16x32_bf16 v[120:123], a[92:95], v[72:75], v[120:123]
    s_waitcnt vmcnt(9)
    v_mfma_f32_16x16x32_bf16 v[96:99], a[96:99], v[80:83], v[96:99]
    v_mfma_f32_16x16x32_bf16 v[104:107], a[100:103], v[80:83], v[104:107]
    v_mfma_f32_16x16x32_bf16 v[112:115], a[104:107], v[80:83], v[112:115]
    v_mfma_f32_16x16x32_bf16 v[120:123], a[108:111], v[80:83], v[120:123]
    s_waitcnt vmcnt(8)
    v_mfma_f32_16x16x32_bf16 v[96:99], a[112:115], v[88:91], v[96:99]
    v_mfma_f32_16x16x32_bf16 v[104:107], a[116:119], v[88:91], v[104:107]
    v_mfma_f32_16x16x32_bf16 v[112:115], a[120:123], v[88:91], v[112:115]
    v_mfma_f32_16x16x32_bf16 v[120:123], a[124:127], v[88:91], v[120:123]
    s_waitcnt vmcnt(7)
    v_mfma_f32_16x16x32_bf16 v[100:103], a[0:3], v[36:39], 0
    v_mfma_f32_16x16x32_bf16 v[108:111], a[4:7], v[36:39], 0
    v_mfma_f32_16x16x32_bf16 v[116:119], a[8:11], v[36:39], 0
    v_mfma_f32_16x16x32_bf16 v[124:127], a[12:15], v[36:39], 0
    s_waitcnt vmcnt(6)
    v_mfma_f32_16x16x32_bf16 v[100:103], a[16:19], v[44:47], v[100:103]
    v_mfma_f32_16x16x32_bf16 v[108:111], a[20:23], v[44:47], v[108:111]
    v_mfma_f32_16x16x32_bf16 v[116:119], a[24:27], v[44:47], v[116:119]
    v_mfma_f32_16x16x32_bf16 v[124:127], a[28:31], v[44:47], v[124:127]
    ds_write_b128 v3, v[96:99] offset:0
    s_waitcnt vmcnt(5)
    v_mfma_f32_16x16x32_bf16 v[100:103], a[32:35], v[52:55], v[100:103]
    v_mfma_f32_16x16x32_bf16 v[108:111], a[36:39], v[52:55], v[108:111]
    v_mfma_f32_16x16x32_bf16 v[116:119], a[40:43], v[52:55], v[116:119]
    v_mfma_f32_16x16x32_bf16 v[124:127], a[44:47], v[52:55], v[124:127]
    ds_write_b128 v3, v[104:107] offset:2048
    s_waitcnt vmcnt(4)
    v_mfma_f32_16x16x32_bf16 v[100:103], a[48:51], v[60:63], v[100:103]
    v_mfma_f32_16x16x32_bf16 v[108:111], a[52:55], v[60:63], v[108:111]
    v_mfma_f32_16x16x32_bf16 v[116:119], a[56:59], v[60:63], v[116:119]
    v_mfma_f32_16x16x32_bf16 v[124:127], a[60:63], v[60:63], v[124:127]
    ds_write_b128 v3, v[112:115] offset:4096
    s_waitcnt vmcnt(3)
    v_mfma_f32_16x16x32_bf16 v[100:103], a[64:67], v[68:71], v[100:103]
    v_mfma_f32_16x16x32_bf16 v[108:111], a[68:71], v[68:71], v[108:111]
    v_mfma_f32_16x16x32_bf16 v[116:119], a[72:75], v[68:71], v[116:119]
    v_mfma_f32_16x16x32_bf16 v[124:127], a[76:79], v[68:71], v[124:127]
    ds_write_b128 v3, v[120:123] offset:6144
    s_waitcnt vmcnt(2)
    v_mfma_f32_16x16x32_bf16 v[100:103], a[80:83], v[76:79], v[100:103]
    v_mfma_f32_16x16x32_bf16 v[108:111], a[84:87], v[76:79], v[108:111]
    v_mfma_f32_16x16x32_bf16 v[116:119], a[88:91], v[76:79], v[116:119]
    v_mfma_f32_16x16x32_bf16 v[124:127], a[92:95], v[76:79], v[124:127]
    s_waitcnt vmcnt(1)
    v_mfma_f32_16x16x32_bf16 v[100:103], a[96:99], v[84:87], v[100:103]
    v_mfma_f32_16x16x32_bf16 v[108:111], a[100:103], v[84:87], v[108:111]
    v_mfma_f32_16x16x32_bf16 v[116:119], a[104:107], v[84:87], v[116:119]
    v_mfma_f32_16x16x32_bf16 v[124:127], a[108:111], v[84:87], v[124:127]
    s_waitcnt vmcnt(0)
    v_mfma_f32_16x16x32_bf16 v[100:103], a[112:115], v[92:95], v[100:103]
    v_mfma_f32_16x16x32_bf16 v[108:111], a[116:119], v[92:95], v[108:111]
    v_mfma_f32_16x16x32_bf16 v[116:119], a[120:123], v[92:95], v[116:119]
    v_mfma_f32_16x16x32_bf16 v[124:127], a[124:127], v[92:95], v[124:127]
    s_nop 4
    ds_write_b128 v3, v[100:103] offset:1024
    ds_write_b128 v3, v[108:111] offset:3072
    ds_write_b128 v3, v[116:119] offset:5120
    ds_write_b128 v3, v[124:127] offset:7168
    s_waitcnt lgkmcnt(0)
    s_barrier
    ds_read_b128 v[32:35], v4 offset:0
    ds_read_b128 v[36:39], v4 offset:8192
    ds_read_b128 v[40:43], v4 offset:16384
    ds_read_b128 v[44:47], v4 offset:24576
    ds_read_b128 v[48:51], v4 offset:1024
    ds_read_b128 v[52:55], v4 offset:9216
    ds_read_b128 v[56:59], v4 offset:17408
    ds_read_b128 v[60:63], v4 offset:25600
    s_lshl_b32 s59, s90, 18
    s_add_u32 s59, s59, s73
    s_add_u32 s60, s59, 32768
    s_waitcnt lgkmcnt(4)
    v_pk_add_f32 v[32:33], v[32:33], v[36:37]
    v_pk_add_f32 v[40:41], v[40:41], v[44:45]
    v_pk_add_f32 v[34:35], v[34:35], v[38:39]
    v_pk_add_f32 v[42:43], v[42:43], v[46:47]
    v_pk_add_f32 v[32:33], v[32:33], v[40:41]
    v_pk_add_f32 v[34:35], v[34:35], v[42:43]
    buffer_store_dwordx4 v[32:35], v5, s[36:39], s59 offen
    s_waitcnt lgkmcnt(0)
    v_pk_add_f32 v[48:49], v[48:49], v[52:53]
    v_pk_add_f32 v[56:57], v[56:57], v[60:61]
    v_pk_add_f32 v[50:51], v[50:51], v[54:55]
    v_pk_add_f32 v[58:59], v[58:59], v[62:63]
    v_pk_add_f32 v[48:49], v[48:49], v[56:57]
    v_pk_add_f32 v[50:51], v[50:51], v[58:59]
    buffer_store_dwordx4 v[48:51], v5, s[36:39], s60 offen
    s_waitcnt vmcnt(0)
    s_barrier
    s_cmp_lg_u32 s57, 0
    s_cbranch_scc1 PSpub_79
    v_mov_b32 v8, s61
    s_add_u32 s59, s77, 0
    s_mov_b64 exec, 1
    buffer_store_dword v8, off, s[36:39], s59
    s_mov_b64 exec, -1
PSpub_79:
    s_cmp_lg_u32 s57, 1
    s_cbranch_scc1 PSf1_80
    ds_read_b128 v[96:99], v26
    ds_read_b128 v[100:103], v26 offset:16
    s_mov_b32 s59, 0
PSw_81:
    buffer_load_dword v8, v7, s[36:39], s59 offen sc1
    s_waitcnt vmcnt(0)
    v_cmp_le_u32 vcc, s61, v8
    s_nop 0
    s_cmp_eq_u64 vcc, exec
    s_nop 1
    s_cbranch_scc0 PSw_81
    s_lshl_b32 s59, s90, 18
    s_lshl_b32 s60, s56, 11
    s_add_u32 s59, s59, s60
    s_add_u32 s59, s59, 0x4000000
    buffer_load_dwordx4 v[64:67], v23, s[36:39], s59 offen sc1
    buffer_load_dwordx4 v[68:71], v23, s[36:39], s59 offen offset:16 sc1
    s_add_u32 s59, s59, 0x10000
    buffer_load_dwordx4 v[72:75], v23, s[36:39], s59 offen sc1
    buffer_load_dwordx4 v[76:79], v23, s[36:39], s59 offen offset:16 sc1
    s_add_u32 s59, s59, 0x10000
    buffer_load_dwordx4 v[80:83], v23, s[36:39], s59 offen sc1
    buffer_load_dwordx4 v[84:87], v23, s[36:39], s59 offen offset:16 sc1
    s_add_u32 s59, s59, 0x10000
    buffer_load_dwordx4 v[88:91], v23, s[36:39], s59 offen sc1
    buffer_load_dwordx4 v[92:95], v23, s[36:39], s59 offen offset:16 sc1
    v_lshlrev_b32 v32, 16, v28
    v_and_b32 v33, s68, v28
    v_lshlrev_b32 v34, 16, v29
    v_and_b32 v35, s68, v29
    v_lshlrev_b32 v36, 16, v30
    v_and_b32 v37, s68, v30
    v_lshlrev_b32 v38, 16, v31
    v_and_b32 v39, s68, v31
    s_waitcnt vmcnt(0) lgkmcnt(0)
    v_pk_add_f32 v[64:65], v[64:65], v[72:73]
    v_pk_add_f32 v[80:81], v[80:81], v[88:89]
    v_pk_add_f32 v[66:67], v[66:67], v[74:75]
    v_pk_add_f32 v[82:83], v[82:83], v[90:91]
    v_pk_add_f32 v[68:69], v[68:69], v[76:77]
    v_pk_add_f32 v[84:85], v[84:85], v[92:93]
    v_pk_add_f32 v[70:71], v[70:71], v[78:79]
    v_pk_add_f32 v[86:87], v[86:87], v[94:95]
    v_pk_add_f32 v[64:65], v[64:65], v[80:81]
    v_pk_add_f32 v[66:67], v[66:67], v[82:83]
    v_pk_add_f32 v[68:69], v[68:69], v[84:85]
    v_pk_add_f32 v[70:71], v[70:71], v[86:87]
    v_cvt_pk_bf16_f32 v64, 0, v64
    v_cvt_pk_bf16_f32 v65, 0, v65
    v_cvt_pk_bf16_f32 v66, 0, v66
    v_cvt_pk_bf16_f32 v67, 0, v67
    v_cvt_pk_bf16_f32 v68, 0, v68
    v_cvt_pk_bf16_f32 v69, 0, v69
    v_cvt_pk_bf16_f32 v70, 0, v70
    v_cvt_pk_bf16_f32 v71, 0, v71
    v_mul_f32 v64, v64, v240
    v_mul_f32 v65, v65, v241
    v_mul_f32 v66, v66, v242
    v_mul_f32 v67, v67, v243
    v_mul_f32 v68, v68, v244
    v_mul_f32 v69, v69, v245
    v_mul_f32 v70, v70, v246
    v_mul_f32 v71, v71, v247
    v_cvt_pk_bf16_f32 v64, 0, v64
    v_cvt_pk_bf16_f32 v65, 0, v65
    v_cvt_pk_bf16_f32 v66, 0, v66
    v_cvt_pk_bf16_f32 v67, 0, v67
    v_cvt_pk_bf16_f32 v68, 0, v68
    v_cvt_pk_bf16_f32 v69, 0, v69
    v_cvt_pk_bf16_f32 v70, 0, v70
    v_cvt_pk_bf16_f32 v71, 0, v71
    v_add_f32 v32, v32, v64
    v_add_f32 v33, v33, v65
    v_add_f32 v34, v34, v66
    v_add_f32 v35, v35, v67
    v_add_f32 v36, v36, v68
    v_add_f32 v37, v37, v69
    v_add_f32 v38, v38, v70
    v_add_f32 v39, v39, v71
    v_cvt_pk_bf16_f32 v28, v32, v33
    v_cvt_pk_bf16_f32 v29, v34, v35
    v_cvt_pk_bf16_f32 v30, v36, v37
    v_cvt_pk_bf16_f32 v31, v38, v39
    s_add_u32 s59, s88, 0x400000
    buffer_store_dwordx4 v[28:31], v1, s[36:39], s59 offen
    v_cvt_pk_bf16_f32 v32, 0, v32
    v_cvt_pk_bf16_f32 v33, 0, v33
    v_cvt_pk_bf16_f32 v34, 0, v34
    v_cvt_pk_bf16_f32 v35, 0, v35
    v_cvt_pk_bf16_f32 v36, 0, v36
    v_cvt_pk_bf16_f32 v37, 0, v37
    v_cvt_pk_bf16_f32 v38, 0, v38
    v_cvt_pk_bf16_f32 v39, 0, v39
    v_add_f32 v40, v32, v33
    v_add_f32 v41, v34, v35
    v_add_f32 v42, v36, v37
    v_add_f32 v43, v38, v39
    v_add_f32 v40, v40, v41
    v_add_f32 v42, v42, v43
    v_add_f32 v40, v40, v42
    s_nop 1
    v_add_f32_dpp v40, v40, v40 row_shr:1 row_mask:0xf bank_mask:0xf bound_ctrl:0
    s_nop 1
    v_add_f32_dpp v40, v40, v40 row_shr:2 row_mask:0xf bank_mask:0xf bound_ctrl:0
    s_nop 1
    v_add_f32_dpp v40, v40, v40 row_shr:4 row_mask:0xf bank_mask:0xf bound_ctrl:0
    s_nop 1
    v_add_f32_dpp v40, v40, v40 row_shr:8 row_mask:0xf bank_mask:0xf bound_ctrl:0
    s_nop 1
    v_add_f32_dpp v40, v40, v40 row_bcast:15 row_mask:0xa bank_mask:0xf
    s_nop 1
    v_add_f32_dpp v40, v40, v40 row_bcast:31 row_mask:0xc bank_mask:0xf
    s_nop 0
    v_readlane_b32 s63, v40, 63
    v_mov_b32 v48, 0x3b000000
    s_nop 0
    v_mul_f32 v49, s63, v48
    v_sub_f32 v40, v32, v49
    v_sub_f32 v41, v33, v49
    v_sub_f32 v42, v34, v49
    v_sub_f32 v43, v35, v49
    v_sub_f32 v44, v36, v49
    v_sub_f32 v45, v37, v49
    v_sub_f32 v46, v38, v49
    v_sub_f32 v47, v39, v49
    v_mul_f32 v40, v40, v40
    v_mul_f32 v41, v41, v41
    v_fmac_f32 v40, v42, v42
    v_fmac_f32 v41, v43, v43
    v_fmac_f32 v40, v44, v44
    v_fmac_f32 v41, v45, v45
    v_fmac_f32 v40, v46, v46
    v_fmac_f32 v41, v47, v47
    v_add_f32 v40, v40, v41
    s_nop 1
    v_add_f32_dpp v40, v40, v40 row_shr:1 row_mask:0xf bank_mask:0xf bound_ctrl:0
    s_nop 1
    v_add_f32_dpp v40, v40, v40 row_shr:2 row_mask:0xf bank_mask:0xf bound_ctrl:0
    s_nop 1
    v_add_f32_dpp v40, v40, v40 row_shr:4 row_mask:0xf bank_mask:0xf bound_ctrl:0
    s_nop 1
    v_add_f32_dpp v40, v40, v40 row_shr:8 row_mask:0xf bank_mask:0xf bound_ctrl:0
    s_nop 1
    v_add_f32_dpp v40, v40, v40 row_bcast:15 row_mask:0xa bank_mask:0xf
    s_nop 1
    v_add_f32_dpp v40, v40, v40 row_bcast:31 row_mask:0xc bank_mask:0xf
    s_nop 0
    v_readlane_b32 s63, v40, 63
    s_nop 1
    v_mul_f32 v48, s63, v48
    v_cvt_pk_bf16_f32 v40, v48, v49
    v_lshlrev_b32 v48, 16, v40
    v_and_b32 v49, s68, v40
    v_add_f32 v48, 0x3727c5ac, v48
    v_cvt_pk_bf16_f32 v48, v48, v48
    v_lshlrev_b32 v48, 16, v48
    v_sqrt_f32 v48, v48
    s_nop 0
    v_cvt_pk_bf16_f32 v48, v48, v48
    v_lshlrev_b32 v48, 16, v48
    v_rcp_f32 v48, v48
    v_sub_f32 v32, v32, v49
    v_sub_f32 v33, v33, v49
    v_sub_f32 v34, v34, v49
    v_sub_f32 v35, v35, v49
    v_sub_f32 v36, v36, v49
    v_sub_f32 v37, v37, v49
    v_sub_f32 v38, v38, v49
    v_sub_f32 v39, v39, v49
    v_cvt_pk_bf16_f32 v40, v32, v33
    v_lshlrev_b32 v32, 16, v40
    v_and_b32 v33, s68, v40
    v_cvt_pk_bf16_f32 v41, v34, v35
    v_lshlrev_b32 v34, 16, v41
    v_and_b32 v35, s68, v41
    v_cvt_pk_bf16_f32 v42, v36, v37
    v_lshlrev_b32 v36, 16, v42
    v_and_b32 v37, s68, v42
    v_cvt_pk_bf16_f32 v43, v38, v39
    v_lshlrev_b32 v38, 16, v43
    v_and_b32 v39, s68, v43
    v_mul_f32 v32, v32, v48
    v_mul_f32 v33, v33, v48
    v_mul_f32 v34, v34, v48
    v_mul_f32 v35, v35, v48
    v_mul_f32 v36, v36, v48
    v_mul_f32 v37, v37, v48
    v_mul_f32 v38, v38, v48
    v_mul_f32 v39, v39, v48
    v_cvt_pk_bf16_f32 v40, v32, v33
    v_lshlrev_b32 v32, 16, v40
    v_and_b32 v33, s68, v40
    v_cvt_pk_bf16_f32 v41, v34, v35
    v_lshlrev_b32 v34, 16, v41
    v_and_b32 v35, s68, v41
    v_cvt_pk_bf16_f32 v42, v36, v37
    v_lshlrev_b32 v36, 16, v42
    v_and_b32 v37, s68, v42
    v_cvt_pk_bf16_f32 v43, v38, v39
    v_lshlrev_b32 v38, 16, v43
    v_and_b32 v39, s68, v43
    v_mul_f32 v32, v32, v248
    v_mul_f32 v33, v33, v249
    v_mul_f32 v34, v34, v250
    v_mul_f32 v35, v35, v251
    v_mul_f32 v36, v36, v252
    v_mul_f32 v37, v37, v253
    v_mul_f32 v38, v38, v254
    v_mul_f32 v39, v39, v255
    v_cvt_pk_bf16_f32 v40, v32, v33
    v_lshlrev_b32 v32, 16, v40
    v_and_b32 v33, s68, v40
    v_cvt_pk_bf16_f32 v41, v34, v35
    v_lshlrev_b32 v34, 16, v41
    v_and_b32 v35, s68, v41
    v_cvt_pk_bf16_f32 v42, v36, v37
    v_lshlrev_b32 v36, 16, v42
    v_and_b32 v37, s68, v42
    v_cvt_pk_bf16_f32 v43, v38, v39
    v_lshlrev_b32 v38, 16, v43
    v_and_b32 v39, s68, v43
    v_add_f32 v32, v32, v96
    v_add_f32 v33, v33, v97
    v_add_f32 v34, v34, v98
    v_add_f32 v35, v35, v99
    v_add_f32 v36, v36, v100
    v_add_f32 v37, v37, v101
    v_add_f32 v38, v38, v102
    v_add_f32 v39, v39, v103
    v_cvt_pk_bf16_f32 v52, v32, v33
    v_cvt_pk_bf16_f32 v53, v34, v35
    v_cvt_pk_bf16_f32 v54, v36, v37
    v_cvt_pk_bf16_f32 v55, v38, v39
    s_add_u32 s59, s88, 0x200000
    buffer_store_dwordx4 v[52:55], v1, s[36:39], s59 offen
    s_waitcnt vmcnt(0)
    v_mov_b32 v8, s61
    s_add_u32 s59, s77, 4096
    s_mov_b64 exec, 1
    buffer_store_dword v8, off, s[36:39], s59
    s_mov_b64 exec, -1
PSf1_80:
    s_cmp_ge_u32 s56, 28
    s_cbranch_scc1 PSf2_83
    v_and_b32 v27, 7, v0
    v_lshlrev_b32 v27, 7, v27
    s_lshl_b32 s60, s56, 7
    s_sub_u32 s60, s77, s60
    s_lshl_b32 s59, s57, 10
    s_add_u32 s60, s60, s59
    v_add_u32 v27, s60, v27
    s_mov_b32 s59, 4096
    s_nop 0
PSw_84:
    buffer_load_dword v8, v27, s[36:39], s59 offen sc1
    s_waitcnt vmcnt(0)
    v_cmp_le_u32 vcc, s61, v8
    s_nop 0
    s_cmp_eq_u64 vcc, exec
    s_nop 1
    s_cbranch_scc0 PSw_84
    s_lshl_b32 s85, s90, 15
    s_add_u32 s85, s85, 0x200000
    s_mov_b32 s86, 0
    s_lshl_b32 s59, s57, 13
    s_add_u32 s60, s59, s85
    s_add_u32 s59, s59, s86
    s_mov_b32 m0, s59
    v_xor_b32 v8, 0, v10
    buffer_load_dwordx4 v8, s[36:39], s60 offen offset:0 sc1 lds
    v_xor_b32 v9, 16, v10
    buffer_load_dwordx4 v9, s[36:39], s60 offen offset:1024 sc1 lds
    v_xor_b32 v8, 32, v10
    buffer_load_dwordx4 v8, s[36:39], s60 offen offset:2048 sc1 lds
    v_xor_b32 v9, 48, v10
    buffer_load_dwordx4 v9, s[36:39], s60 offen offset:3072 sc1 lds
    s_add_u32 s59, s59, 4096
    s_add_u32 s60, s60, 4096
    s_mov_b32 m0, s59
    v_xor_b32 v8, 64, v10
    buffer_load_dwordx4 v8, s[36:39], s60 offen offset:0 sc1 lds
    v_xor_b32 v9, 80, v10
    buffer_load_dwordx4 v9, s[36:39], s60 offen offset:1024 sc1 lds
    v_xor_b32 v8, 96, v10
    buffer_load_dwordx4 v8, s[36:39], s60 offen offset:2048 sc1 lds
    v_xor_b32 v9, 112, v10
    buffer_load_dwordx4 v9, s[36:39], s60 offen offset:3072 sc1 lds
    s_waitcnt vmcnt(0)
    s_barrier
    ds_read_b128 v[32:35], v11 offset:0
    ds_read_b128 v[36:39], v15 offset:0
    ds_read_b128 v[40:43], v12 offset:0
    ds_read_b128 v[44:47], v16 offset:0
    ds_read_b128 v[48:51], v13 offset:0
    ds_read_b128 v[52:55], v17 offset:0
    ds_read_b128 v[56:59], v14 offset:0
    ds_read_b128 v[60:63], v18 offset:0
    s_waitcnt lgkmcnt(6)
    v_mfma_f32_16x16x32_bf16 v[64:67], a[128:131], v[32:35], 0
    v_mfma_f32_16x16x32_bf16 v[68:71], a[128:131], v[36:39], 0
    v_mfma_f32_16x16x32_bf16 v[72:75], a[132:135], v[32:35], 0
    v_mfma_f32_16x16x32_bf16 v[76:79], a[132:135], v[36:39], 0
    ds_read_b128 v[32:35], v11 offset:256
    ds_read_b128 v[36:39], v15 offset:256
    s_waitcnt lgkmcnt(6)
    v_mfma_f32_16x16x32_bf16 v[64:67], a[136:139], v[40:43], v[64:67]
    v_mfma_f32_16x16x32_bf16 v[68:71], a[136:139], v[44:47], v[68:71]
    v_mfma_f32_16x16x32_bf16 v[72:75], a[140:143], v[40:43], v[72:75]
    v_mfma_f32_16x16x32_bf16 v[76:79], a[140:143], v[44:47], v[76:79]
    ds_read_b128 v[40:43], v12 offset:256
    ds_read_b128 v[44:47], v16 offset:256
    s_waitcnt lgkmcnt(6)
    v_mfma_f32_16x16x32_bf16 v[64:67], a[144:147], v[48:51], v[64:67]
    v_mfma_f32_16x16x32_bf16 v[68:71], a[144:147], v[52:55], v[68:71]
    v_mfma_f32_16x16x32_bf16 v[72:75], a[148:151], v[48:51], v[72:75]
    v_mfma_f32_16x16x32_bf16 v[76:79], a[148:151], v[52:55], v[76:79]
    ds_read_b128 v[48:51], v13 offset:256
    ds_read_b128 v[52:55], v17 offset:256
    s_waitcnt lgkmcnt(6)
    v_mfma_f32_16x16x32_bf16 v[64:67], a[152:155], v[56:59], v[64:67]
    v_mfma_f32_16x16x32_bf16 v[68:71], a[152:155], v[60:63], v[68:71]
    v_mfma_f32_16x16x32_bf16 v[72:75], a[156:159], v[56:59], v[72:75]
    v_mfma_f32_16x16x32_bf16 v[76:79], a[156:159], v[60:63], v[76:79]
    ds_read_b128 v[56:59], v14 offset:256
    ds_read_b128 v[60:63], v18 offset:256
    s_waitcnt lgkmcnt(6)
    v_mfma_f32_16x16x32_bf16 v[64:67], a[160:163], v[32:35], v[64:67]
    v_mfma_f32_16x16x32_bf16 v[68:71], a[160:163], v[36:39], v[68:71]
    v_mfma_f32_16x16x32_bf16 v[72:75], a[164:167], v[32:35], v[72:75]
    v_mfma_f32_16x16x32_bf16 v[76:79], a[164:167], v[36:39], v[76:79]
    ds_read_b128 v[32:35], v11 offset:512
    ds_read_b128 v[36:39], v15 offset:512
    s_waitcnt lgkmcnt(6)
    v_mfma_f32_16x16x32_bf16 v[64:67], a[168:171], v[40:43], v[64:67]
    v_mfma_f32_16x16x32_bf16 v[68:71], a[168:171], v[44:47], v[68:71]
    v_mfma_f32_16x16x32_bf16 v[72:75], a[172:175], v[40:43], v[72:75]
    v_mfma_f32_16x16x32_bf16 v[76:79], a[172:175], v[44:47], v[76:79]
    ds_read_b128 v[40:43], v12 offset:512
    ds_read_b128 v[44:47], v16 offset:512
    s_waitcnt lgkmcnt(6)
    v_mfma_f32_16x16x32_bf16 v[64:67], a[176:179], v[48:51], v[64:67]
    v_mfma_f32_16x16x32_bf16 v[68:71], a[176:179], v[52:55], v[68:71]
    v_mfma_f32_16x16x32_bf16 v[72:75], a[180:183], v[48:51], v[72:75]
    v_mfma_f32_16x16x32_bf16 v[76:79], a[180:183], v[52:55], v[76:79]
    ds_read_b128 v[48:51], v13 offset:512
    ds_read_b128 v[52:55], v17 offset:512
    s_waitcnt lgkmcnt(6)
    v_mfma_f32_16x16x32_bf16 v[64:67], a[184:187], v[56:59], v[64:67]
    v_mfma_f32_16x16x32_bf16 v[68:71], a[184:187], v[60:63], v[68:71]
    v_mfma_f32_16x16x32_bf16 v[72:75], a[188:191], v[56:59], v[72:75]
    v_mfma_f32_16x16x32_bf16 v[76:79], a[188:191], v[60:63], v[76:79]
    ds_read_b128 v[56:59], v14 offset:512
    ds_read_b128 v[60:63], v18 offset:512
    s_waitcnt lgkmcnt(6)
    v_mfma_f32_16x16x32_bf16 v[64:67], a[192:195], v[32:35], v[64:67]
    v_mfma_f32_16x16x32_bf16 v[68:71], a[192:195], v[36:39], v[68:71]
    v_mfma_f32_16x16x32_bf16 v[72:75], a[196:199], v[32:35], v[72:75]
    v_mfma_f32_16x16x32_bf16 v[76:79], a[196:199], v[36:39], v[76:79]
    ds_read_b128 v[32:35], v11 offset:768
    ds_read_b128 v[36:39], v15 offset:768
    s_waitcnt lgkmcnt(6)
    v_mfma_f32_16x16x32_bf16 v[64:67], a[200:203], v[40:43], v[64:67]
    v_mfma_f32_16x16x32_bf16 v[68:71], a[200:203], v[44:47], v[68:71]
    v_mfma_f32_16x16x32_bf16 v[72:75], a[204:207], v[40:43], v[72:75]
    v_mfma_f32_16x16x32_bf16 v[76:79], a[204:207], v[44:47], v[76:79]
    ds_read_b128 v[40:43], v12 offset:768
    ds_read_b128 v[44:47], v16 offset:768
    s_waitcnt lgkmcnt(6)
    v_mfma_f32_16x16x32_bf16 v[64:67], a[208:211], v[48:51], v[64:67]
    v_mfma_f32_16x16x32_bf16 v[68:71], a[208:211], v[52:55], v[68:71]
    v_mfma_f32_16x16x32_bf16 v[72:75], a[212:215], v[48:51], v[72:75]
    v_mfma_f32_16x16x32_bf16 v[76:79], a[212:215], v[52:55], v[76:79]
    ds_read_b128 v[48:51], v13 offset:768
    ds_read_b128 v[52:55], v17 offset:768
    s_waitcnt lgkmcnt(6)
    v_mfma_f32_16x16x32_bf16 v[64:67], a[216:219], v[56:59], v[64:67]
    v_mfma_f32_16x16x32_bf16 v[68:71], a[216:219], v[60:63], v[68:71]
    v_mfma_f32_16x16x32_bf16 v[72:75], a[220:223], v[56:59], v[72:75]
    v_mfma_f32_16x16x32_bf16 v[76:79], a[220:223], v[60:63], v[76:79]
    ds_read_b128 v[56:59], v14 offset:768
    ds_read_b128 v[60:63], v18 offset:768
    s_waitcnt lgkmcnt(6)
    v_mfma_f32_16x16x32_bf16 v[64:67], a[224:227], v[32:35], v[64:67]
    v_mfma_f32_16x16x32_bf16 v[68:71], a[224:227], v[36:39], v[68:71]
    v_mfma_f32_16x16x32_bf16 v[72:75], a[228:231], v[32:35], v[72:75]
    v_mfma_f32_16x16x32_bf16 v[76:79], a[228:231], v[36:39], v[76:79]
    s_waitcnt lgkmcnt(4)
    v_mfma_f32_16x16x32_bf16 v[64:67], a[232:235], v[40:43], v[64:67]
    v_mfma_f32_16x16x32_bf16 v[68:71], a[232:235], v[44:47], v[68:71]
    v_mfma_f32_16x16x32_bf16 v[72:75], a[236:239], v[40:43], v[72:75]
    v_mfma_f32_16x16x32_bf16 v[76:79], a[236:239], v[44:47], v[76:79]
    s_waitcnt lgkmcnt(2)
    v_mfma_f32_16x16x32_bf16 v[64:67], a[240:243], v[48:51], v[64:67]
    v_mfma_f32_16x16x32_bf16 v[68:71], a[240:243], v[52:55], v[68:71]
    v_mfma_f32_16x16x32_bf16 v[72:75], a[244:247], v[48:51], v[72:75]
    v_mfma_f32_16x16x32_bf16 v[76:79], a[244:247], v[52:55], v[76:79]
    s_waitcnt lgkmcnt(0)
    v_mfma_f32_16x16x32_bf16 v[64:67], a[248:251], v[56:59], v[64:67]
    v_mfma_f32_16x16x32_bf16 v[68:71], a[248:251], v[60:63], v[68:71]
    v_mfma_f32_16x16x32_bf16 v[72:75], a[252:255], v[56:59], v[72:75]
    v_mfma_f32_16x16x32_bf16 v[76:79], a[252:255], v[60:63], v[76:79]
    s_nop 4
    v_cvt_pk_bf16_f32 v64, 0, v64
    v_cvt_pk_bf16_f32 v65, 0, v65
    v_cvt_pk_bf16_f32 v66, 0, v66
    v_cvt_pk_bf16_f32 v67, 0, v67
    v_cvt_pk_bf16_f32 v68, 0, v68
    v_cvt_pk_bf16_f32 v69, 0, v69
    v_cvt_pk_bf16_f32 v70, 0, v70
    v_cvt_pk_bf16_f32 v71, 0, v71
    v_mul_f32 v88, s69, v64
    v_mul_f32 v89, s69, v65
    v_mul_f32 v90, s69, v66
    v_mul_f32 v91, s69, v67
    v_mul_f32 v92, s69, v68
    v_mul_f32 v93, s69, v69
    v_mul_f32 v94, s69, v70
    v_mul_f32 v95, s69, v71
    v_exp_f32 v88, -v88
    v_exp_f32 v89, -v89
    v_exp_f32 v90, -v90
    v_exp_f32 v91, -v91
    v_exp_f32 v92, -v92
    v_exp_f32 v93, -v93
    v_exp_f32 v94, -v94
    v_exp_f32 v95, -v95
    v_cvt_pk_bf16_f32 v72, 0, v72
    v_cvt_pk_bf16_f32 v73, 0, v73
    v_cvt_pk_bf16_f32 v74, 0, v74
    v_cvt_pk_bf16_f32 v75, 0, v75
    v_cvt_pk_bf16_f32 v76, 0, v76
    v_cvt_pk_bf16_f32 v77, 0, v77
    v_cvt_pk_bf16_f32 v78, 0, v78
    v_cvt_pk_bf16_f32 v79, 0, v79
    v_add_f32 v88, 1.0, v88
    v_add_f32 v89, 1.0, v89
    v_add_f32 v90, 1.0, v90
    v_add_f32 v91, 1.0, v91
    v_add_f32 v92, 1.0, v92
    v_add_f32 v93, 1.0, v93
    v_add_f32 v94, 1.0, v94
    v_add_f32 v95, 1.0, v95
    v_rcp_f32 v88, v88
    v_rcp_f32 v89, v89
    v_rcp_f32 v90, v90
    v_rcp_f32 v91, v91
    v_rcp_f32 v92, v92
    v_rcp_f32 v93, v93
    v_rcp_f32 v94, v94
    v_rcp_f32 v95, v95
    v_mul_f32 v64, v64, v88
    v_mul_f32 v65, v65, v89
    v_mul_f32 v66, v66, v90
    v_mul_f32 v67, v67, v91
    v_mul_f32 v68, v68, v92
    v_mul_f32 v69, v69, v93
    v_mul_f32 v70, v70, v94
    v_mul_f32 v71, v71, v95
    v_cvt_pk_bf16_f32 v64, 0, v64
    v_cvt_pk_bf16_f32 v65, 0, v65
    v_cvt_pk_bf16_f32 v66, 0, v66
    v_cvt_pk_bf16_f32 v67, 0, v67
    v_cvt_pk_bf16_f32 v68, 0, v68
    v_cvt_pk_bf16_f32 v69, 0, v69
    v_cvt_pk_bf16_f32 v70, 0, v70
    v_cvt_pk_bf16_f32 v71, 0, v71
    v_mul_f32 v64, v64, v72
    v_mul_f32 v65, v65, v73
    v_mul_f32 v66, v66, v74
    v_mul_f32 v67, v67, v75
    v_mul_f32 v68, v68, v76
    v_mul_f32 v69, v69, v77
    v_mul_f32 v70, v70, v78
    v_mul_f32 v71, v71, v79
    v_cvt_pk_bf16_f32 v80, v64, v65
    v_cvt_pk_bf16_f32 v81, v66, v67
    v_cvt_pk_bf16_f32 v82, v68, v69
    v_cvt_pk_bf16_f32 v83, v70, v71
    s_mul_i32 s59, s90, 114688
    s_add_u32 s59, s59, s75
    buffer_store_dwordx2 v[80:81], v19, s[36:39], s59 offen offset:0
    buffer_store_dwordx2 v[82:83], v19, s[36:39], s59 offen offset:256
    s_waitcnt vmcnt(0)
    s_barrier
    s_cmp_lg_u32 s57, 0
    s_cbranch_scc1 PSpub_86
    v_mov_b32 v8, s61
    s_add_u32 s59, s77, 8192
    s_mov_b64 exec, 1
    buffer_store_dword v8, off, s[36:39], s59
    s_mov_b64 exec, -1
PSpub_86:
PSf2_83:
    s_mov_b32 s59, 0
PSw_87:
    buffer_load_dword v8, v22, s[36:39], s59 offen sc1
    s_waitcnt vmcnt(0)
    v_cmp_le_u32 vcc, s61, v8
    s_nop 0
    s_cmp_eq_u64 vcc, exec
    s_nop 1
    s_cbranch_scc0 PSw_87
    s_mul_i32 s59, s90, 114688
    s_add_u32 s59, s59, s76
    buffer_load_dwordx4 v[32:35], v2, s[36:39], s59 offen offset:0 sc1
    buffer_load_dwordx4 v[36:39], v2, s[36:39], s59 offen offset:2048 sc1
    s_add_u32 s59, s59, 4096
    buffer_load_dwordx4 v[40:43], v2, s[36:39], s59 offen offset:0 sc1
    buffer_load_dwordx4 v[44:47], v2, s[36:39], s59 offen offset:2048 sc1
    s_add_u32 s59, s59, 4096
    buffer_load_dwordx4 v[48:51], v2, s[36:39], s59 offen offset:0 sc1
    buffer_load_dwordx4 v[52:55], v2, s[36:39], s59 offen offset:2048 sc1
    s_add_u32 s59, s59, 4096
    buffer_load_dwordx4 v[56:59], v2, s[36:39], s59 offen offset:0 sc1
    buffer_load_dwordx4 v[60:63], v2, s[36:39], s59 offen offset:2048 sc1
    s_add_u32 s59, s59, 4096
    buffer_load_dwordx4 v[64:67], v2, s[36:39], s59 offen offset:0 sc1
    buffer_load_dwordx4 v[68:71], v2, s[36:39], s59 offen offset:2048 sc1
    s_add_u32 s59, s59, 4096
    buffer_load_dwordx4 v[72:75], v2, s[36:39], s59 offen offset:0 sc1
    buffer_load_dwordx4 v[76:79], v2, s[36:39], s59 offen offset:2048 sc1
    s_add_u32 s59, s59, 4096
    buffer_load_dwordx4 v[80:83], v2, s[36:39], s59 offen offset:0 sc1
    buffer_load_dwordx4 v[84:87], v2, s[36:39], s59 offen offset:2048 sc1
    s_lshl_b32 s85, s58, 15
    s_lshl_b32 s59, s90, 15
    s_add_u32 s59, s59, 0x400000
    buffer_load_dword v112, v20, s[36:39], s59 offen sc1
    s_waitcnt vmcnt(14)
    v_mfma_f32_16x16x32_bf16 v[96:99], v[128:131], v[32:35], 0
    v_mfma_f32_16x16x32_bf16 v[100:103], v[132:135], v[32:35], 0
    s_waitcnt vmcnt(13)
    v_mfma_f32_16x16x32_bf16 v[96:99], v[136:139], v[36:39], v[96:99]
    v_mfma_f32_16x16x32_bf16 v[100:103], v[140:143], v[36:39], v[100:103]
    s_waitcnt vmcnt(12)
    v_mfma_f32_16x16x32_bf16 v[96:99], v[144:147], v[40:43], v[96:99]
    v_mfma_f32_16x16x32_bf16 v[100:103], v[148:151], v[40:43], v[100:103]
    s_waitcnt vmcnt(11)
    v_mfma_f32_16x16x32_bf16 v[96:99], v[152:155], v[44:47], v[96:99]
    v_mfma_f32_16x16x32_bf16 v[100:103], v[156:159], v[44:47], v[100:103]
    s_waitcnt vmcnt(10)
    v_mfma_f32_16x16x32_bf16 v[96:99], v[160:163], v[48:51], v[96:99]
    v_mfma_f32_16x16x32_bf16 v[100:103], v[164:167], v[48:51], v[100:103]
    s_waitcnt vmcnt(9)
    v_mfma_f32_16x16x32_bf16 v[96:99], v[168:171], v[52:55], v[96:99]
    v_mfma_f32_16x16x32_bf16 v[100:103], v[172:175], v[52:55], v[100:103]
    s_waitcnt vmcnt(8)
    v_mfma_f32_16x16x32_bf16 v[96:99], v[176:179], v[56:59], v[96:99]
    v_mfma_f32_16x16x32_bf16 v[100:103], v[180:183], v[56:59], v[100:103]
    s_waitcnt vmcnt(7)
    v_mfma_f32_16x16x32_bf16 v[96:99], v[184:187], v[60:63], v[96:99]
    v_mfma_f32_16x16x32_bf16 v[100:103], v[188:191], v[60:63], v[100:103]
    s_waitcnt vmcnt(6)
    v_mfma_f32_16x16x32_bf16 v[96:99], v[192:195], v[64:67], v[96:99]
    v_mfma_f32_16x16x32_bf16 v[100:103], v[196:199], v[64:67], v[100:103]
    s_waitcnt vmcnt(5)
    v_mfma_f32_16x16x32_bf16 v[96:99], v[200:203], v[68:71], v[96:99]
    v_mfma_f32_16x16x32_bf16 v[100:103], v[204:207], v[68:71], v[100:103]
    s_waitcnt vmcnt(4)
    v_mfma_f32_16x16x32_bf16 v[96:99], v[208:211], v[72:75], v[96:99]
    v_mfma_f32_16x16x32_bf16 v[100:103], v[212:215], v[72:75], v[100:103]
    s_waitcnt vmcnt(3)
    v_mfma_f32_16x16x32_bf16 v[96:99], v[216:219], v[76:79], v[96:99]
    v_mfma_f32_16x16x32_bf16 v[100:103], v[220:223], v[76:79], v[100:103]
    s_waitcnt vmcnt(2)
    v_mfma_f32_16x16x32_bf16 v[96:99], v[224:227], v[80:83], v[96:99]
    v_mfma_f32_16x16x32_bf16 v[100:103], v[228:231], v[80:83], v[100:103]
    s_waitcnt vmcnt(1)
    v_mfma_f32_16x16x32_bf16 v[96:99], v[232:235], v[84:87], v[96:99]
    v_mfma_f32_16x16x32_bf16 v[100:103], v[236:239], v[84:87], v[100:103]
    s_nop 6
    ds_write_b128 v3, v[96:99] offset:0
    ds_write_b128 v3, v[100:103] offset:1024
    s_waitcnt lgkmcnt(0)
    s_barrier
    ds_read_b32 v104, v21 offset:0
    ds_read_b32 v105, v21 offset:8192
    ds_read_b32 v106, v21 offset:16384
    ds_read_b32 v107, v21 offset:24576
    ds_read_b32 v108, v21 offset:1024
    ds_read_b32 v109, v21 offset:9216
    ds_read_b32 v110, v21 offset:17408
    ds_read_b32 v111, v21 offset:25600
    s_waitcnt vmcnt(0) lgkmcnt(0)
    s_barrier
    v_pk_add_f32 v[104:105], v[104:105], v[106:107]
    v_add_f32 v104, v104, v105
    v_pk_add_f32 v[108:109], v[108:109], v[110:111]
    v_add_f32 v108, v108, v109
    v_cvt_pk_bf16_f32 v104, 0, v104
    v_cvt_pk_bf16_f32 v108, 0, v108
    v_mul_f32 v104, v104, v24
    v_mul_f32 v108, v108, v25
    v_cvt_pk_bf16_f32 v104, 0, v104
    v_cvt_pk_bf16_f32 v108, 0, v108
    v_lshlrev_b32 v105, 16, v112
    v_and_b32 v106, s68, v112
    v_add_f32 v104, v104, v105
    v_add_f32 v108, v108, v106
    v_cvt_pk_bf16_f32 v112, v104, v108
    buffer_store_dword v112, v20, s[44:47], s85 offen
    s_cmp_lg_u64 s[92:93], 0
    s_cbranch_scc1 PStop_76
Lend_1:
    s_endpgm
Lcode_end:
.section .rodata,"a"
.p2align 6
.amdhsa_kernel main_kernel
  .amdhsa_next_free_vgpr 512
  .amdhsa_next_free_sgpr 102
  .amdhsa_accum_offset 256
  .amdhsa_group_segment_fixed_size 0
  .amdhsa_kernarg_size 128
  .amdhsa_user_sgpr_count 2
  .amdhsa_user_sgpr_kernarg_segment_ptr 1
  .amdhsa_system_sgpr_workgroup_id_x 1
  .amdhsa_float_denorm_mode_32 3
.end_amdhsa_kernel
.text
```
